```python
import torch

def _softmax(x, axis=-1):
    return torch.softmax(x, dim=axis)

def _gelu(x):
    return torch.nn.functional.gelu(x, approximate='tanh')

def _silu(x):
    return torch.nn.functional.silu(x)

def _sigmoid(x):
    return torch.sigmoid(x)

def _layernorm(x, axis=-1, eps=1e-05):
    m = x.mean(dim=axis, keepdim=True)
    v = x.var(dim=axis, keepdim=True, unbiased=False)
    return (x - m) / torch.sqrt(v + eps)

def _scatter_add(tgt, idx, src, axis=0):
    return tgt.clone().index_add_(axis, idx, src)

def _segment_sum(src, seg, n):
    out = torch.zeros((n,) + src.shape[1:], dtype=src.dtype)
    return out.index_add_(0, seg, src)

def _pad(x, pw):
    flat = tuple((v for pair in reversed(pw) for v in pair))
    return torch.nn.functional.pad(x, flat)
kernel_name = 'adaLN_cond__linear_kernel_hedgehog__mixer_gmlp__prompt'

def setup_inputs():

    _w = lambda a: (lambda t: t.to(torch.bfloat16) if t.is_floating_point() else t)(torch.as_tensor(a))

    def _A_setup():
        B, S, D, H = (1, 2048, 640, 32)
        Dh = D // H
        return {'x': _w((lambda *s: torch.randn(*s, dtype=torch.bfloat16) * 0.05)(B, S, D)), 'wqkv': _w((lambda *s: torch.randn(*s, dtype=torch.bfloat16) * 0.4)(D, 3 * D)), 'w_phi': _w((lambda *s: torch.randn(*s, dtype=torch.bfloat16) * 0.4)(H, Dh, Dh) * Dh ** (-0.5)), 'wo': _w((lambda *s: torch.randn(*s, dtype=torch.bfloat16) * 0.05)(D, D))}
    _A_in = _A_setup()

    def _B_setup():
        B, S, D, F = (1, 2048, 640, 1536)
        Fh = F // 2
        return {'x': _w((lambda *s: torch.randn(*s, dtype=torch.bfloat16) * 0.05)(B, S, D)), 'w_in': _w((lambda *s: torch.randn(*s, dtype=torch.bfloat16) * 0.2)(D, 2 * Fh)), 'w_sp': _w(0.01 * (lambda *s: torch.randn(*s, dtype=torch.bfloat16) * 0.2)(S, S)), 'b_sp': _w(1.0 + 0.01 * (lambda *s: torch.randn(*s, dtype=torch.bfloat16) * 0.05)(S)), 'w_out': _w((lambda *s: torch.randn(*s, dtype=torch.bfloat16) * 0.05)(Fh, D))}
    _B_in = _B_setup()
    return {'A_x': _A_in['x'], 'A_wqkv': _A_in['wqkv'], 'A_w_phi': _A_in['w_phi'], 'A_wo': _A_in['wo'], 'B_x': _B_in['x'], 'B_w_in': _B_in['w_in'], 'B_w_sp': _B_in['w_sp'], 'B_b_sp': _B_in['b_sp'], 'B_w_out': _B_in['w_out'], 'c': _w((lambda *s: torch.randn(*s, dtype=torch.bfloat16) * 0.1)(1, 640) * 8.0), 'w_mod': _w((lambda *s: torch.randn(*s, dtype=torch.bfloat16) * 0.1)(640, 6 * 640) * 640 ** (-0.5) * 8.0)}

def reference(A_x, A_wqkv, A_w_phi, A_wo, B_x, B_w_in, B_w_sp, B_b_sp, B_w_out, c, w_mod):

    def _A_ref(x, wqkv, w_phi, wo):
        B, S, D = x.shape
        H = 32
        Dh = D // H
        qkv = (lambda x, *d: x.permute(*d))((x @ wqkv).reshape(B, S, 3, H, Dh), 2, 0, 3, 1, 4)
        q, k, v = (qkv[0], qkv[1], qkv[2])
        pq = torch.einsum('bhsd,hdf->bhsf', q, w_phi)
        pk = torch.einsum('bhsd,hdf->bhsf', k, w_phi)
        phi_q = torch.concatenate([_softmax(pq, axis=-1), _softmax(-pq, axis=-1)], axis=-1)
        phi_k = torch.concatenate([_softmax(pk, axis=-1), _softmax(-pk, axis=-1)], axis=-1)
        kv = torch.einsum('bhsf,bhsd->bhfd', phi_k, v)
        z = torch.einsum('bhsf->bhf', phi_k)
        num = torch.einsum('bhqf,bhfd->bhqd', phi_q, kv)
        den = torch.einsum('bhqf,bhf->bhq', phi_q, z)[..., None] + 1e-06
        o = num / den
        return (lambda x, *d: x.permute(*d))(o, 0, 2, 1, 3).reshape(B, S, D) @ wo

    def _B_ref(x, w_in, w_sp, b_sp, w_out):
        B, S, D = x.shape
        F = w_in.shape[-1]
        Fh = F // 2
        z = _gelu(torch.einsum('bsd,df->bsf', x, w_in))
        z1 = z[..., :Fh].clone()
        z2 = _layernorm(z[..., Fh:], axis=-1)
        g = torch.einsum('ts,bsf->btf', w_sp, z2) + b_sp[None, :, None]
        return torch.einsum('bsf,fd->bsd', z1 * g, w_out)
    x = A_x
    mod = (_silu(c) @ w_mod).reshape(c.shape[0], 6, 1, -1)
    sa, ca, ga, sb, cb, gb = (mod[:, 0].clone(), mod[:, 1].clone(), mod[:, 2].clone(), mod[:, 3].clone(), mod[:, 4].clone(), mod[:, 5].clone())
    h = _layernorm(x, axis=-1) * (1 + ca) + sa
    x = x + ga * _A_ref(h, A_wqkv, A_w_phi, A_wo)
    h = _layernorm(x, axis=-1) * (1 + cb) + sb
    x = x + gb * _B_ref(h, B_w_in, B_w_sp, B_b_sp, B_w_out)
    return x
```

```asm
; @launch grid=(256,1,1) block=(256,1,1) lds=163840
.amdgcn_target "amdgcn-amd-amdhsa--gfx950"
.text
.globl adaLN_cond__linear_kernel_hedgehog__mixer_gmlp__prompt_kernel
.p2align 8
.type adaLN_cond__linear_kernel_hedgehog__mixer_gmlp__prompt_kernel,@function
adaLN_cond__linear_kernel_hedgehog__mixer_gmlp__prompt_kernel:
    s_cmp_ge_u32 s2, 256
    s_cbranch_scc1 L_end
    s_load_dwordx4 s[40:43], s[0:1], 96
    s_load_dwordx8 s[32:39], s[0:1], 64
    s_load_dwordx16 s[16:31], s[0:1], 0
    s_and_b32 s48, s2, 7
    s_lshr_b32 s49, s2, 3
    s_lshl_b32 s3, s48, 5
    s_add_u32 s46, s3, s49
    v_and_b32 v2, 63, v0
    v_lshrrev_b32 v4, 6, v0
    v_lshlrev_b32 v1, 4, v2
    v_readfirstlane_b32 s47, v4
    s_mov_b32 s96, 0x20000
    s_lshr_b32 s50, s46, 4
    s_and_b32 s51, s46, 15
    s_lshr_b32 s52, s46, 3
    s_and_b32 s53, s46, 7
    s_mov_b32 s100, 400000
    v_and_b32 v8, 7, v2
    v_lshrrev_b32 v9, 3, v0
    v_mul_u32_u24 v10, 1280, v8
    v_lshl_add_u32 v10, v9, 4, v10
    s_cmp_lt_u32 s49, 10
    s_cbranch_scc0 L_iw1
    s_mul_i32 s77, s48, 10
    s_add_u32 s77, s77, s49
    s_and_b32 s55, s77, 3
    s_mul_i32 s56, s55, 1228800
    s_mul_i32 s57, s55, 320
    s_lshr_b32 s55, s77, 2
    s_lshl_b32 s55, s55, 7
    s_add_u32 s56, s56, s55
    v_mul_u32_u24 v5, 7680, v9
    v_lshl_add_u32 v5, v8, 4, v5
    v_lshlrev_b32 v6, 1, v9
    s_waitcnt lgkmcnt(0)
    s_mov_b32 s8, s36
    s_mov_b32 s9, s37
    s_mov_b32 s10, 4915200
    s_mov_b32 s11, s96
    buffer_load_dwordx4 v[136:139], v5, s[8:11], s56 offen nt
    s_add_u32 s56, s56, 245760
    buffer_load_dwordx4 v[140:143], v5, s[8:11], s56 offen nt
    s_add_u32 s56, s56, 245760
    buffer_load_dwordx4 v[144:147], v5, s[8:11], s56 offen nt
    s_add_u32 s56, s56, 245760
    buffer_load_dwordx4 v[148:151], v5, s[8:11], s56 offen nt
    s_add_u32 s56, s56, 245760
    buffer_load_dwordx4 v[152:155], v5, s[8:11], s56 offen nt
    s_mov_b32 s12, s34
    s_mov_b32 s13, s35
    s_mov_b32 s14, 1280
    s_mov_b32 s15, s96
    buffer_load_ushort v156, v6, s[12:15], s57 offen offset:0
    buffer_load_ushort v157, v6, s[12:15], s57 offen offset:64
    buffer_load_ushort v158, v6, s[12:15], s57 offen offset:128
    buffer_load_ushort v159, v6, s[12:15], s57 offen offset:192
    buffer_load_ushort v160, v6, s[12:15], s57 offen offset:256
    s_branch L_icommon
L_iw1:
    s_mul_i32 s77, s48, 20
    s_add_u32 s77, s77, s49
    s_sub_u32 s77, s77, 12
    v_min_u32 v12, 59, v2
    v_mul_u32_u24 v13, 13, v12
    v_lshrrev_b32 v13, 8, v13
    v_mul_u32_u24 v14, 960, v13
    v_lshl_add_u32 v14, v12, 4, v14
    v_add_u32 v14, 1280, v14
    v_subrev_u32 v15, 3840, v14
    v_cmp_eq_u32 vcc, 2, v13
    s_nop 1
    v_cndmask_b32 v14, v14, v15, vcc
    s_lshr_b32 s55, s77, 2
    s_lshl_b32 s55, s55, 4
    s_add_u32 s55, s55, s47
    s_mul_i32 s55, s55, 3840
    s_and_b32 s56, s77, 3
    s_mul_i32 s56, s56, 320
    s_add_u32 s55, s55, s56
    s_cmp_ge_u32 s49, 12
    s_cselect_b32 s55, s55, 1073741824
    s_cselect_b32 s101, 0, 1073741824
    s_lshl_b32 s56, s47, 10
    s_add_u32 s56, s56, 122880
    s_waitcnt lgkmcnt(0)
    s_mov_b32 s8, s18
    s_mov_b32 s9, s19
    s_mov_b32 s10, 2457600
    s_mov_b32 m0, s56
    s_mov_b32 s11, s96
    buffer_load_dwordx4 v14, s[8:11], s55 offen nt lds
    s_add_u32 s55, s55, 15360
    s_add_u32 s56, s56, 4096
    s_mov_b32 m0, s56
    s_nop 0
    buffer_load_dwordx4 v14, s[8:11], s55 offen nt lds
    s_add_u32 s55, s55, 15360
    s_add_u32 s56, s56, 4096
    s_mov_b32 m0, s56
    s_nop 0
    buffer_load_dwordx4 v14, s[8:11], s55 offen nt lds
    s_add_u32 s55, s55, 15360
    s_add_u32 s56, s56, 4096
    s_mov_b32 m0, s56
    s_nop 0
    buffer_load_dwordx4 v14, s[8:11], s55 offen nt lds
    s_mov_b32 s12, s22
    s_mov_b32 s13, s23
    s_mov_b32 s14, 819200
    s_mov_b32 s15, s96
    v_and_b32 v11, 15, v2
    v_min_u32 v12, 9, v11
    v_lshlrev_b32 v12, 4, v12
    v_lshrrev_b32 v13, 4, v0
    v_and_b32 v15, 7, v13
    v_lshrrev_b32 v13, 3, v13
    s_lshr_b32 s55, s77, 3
    s_lshl_b32 s55, s55, 2
    s_and_b32 s57, s77, 7
    s_mul_i32 s57, s57, 160
    s_add_u32 s57, s57, s101
    s_lshl_b32 s56, s47, 10
    s_add_u32 s56, s56, 139264
    v_add_u32 v31, s55, v13
    v_mul_u32_u24 v32, 205, v31
    v_lshrrev_b32 v32, 10, v32
    v_mul_u32_u24 v33, 5, v32
    v_sub_u32 v33, v31, v33
    v_lshl_add_u32 v34, v33, 3, v15
    v_add_u32 v35, 4, v34
    v_cmp_lt_u32 vcc, 1, v33
    s_nop 1
    v_cndmask_b32 v34, v34, v35, vcc
    v_add_u32 v35, 16, v15
    v_add_u32 v36, 32, v15
    v_cmp_lt_u32 vcc, 3, v15
    s_nop 1
    v_cndmask_b32 v35, v35, v36, vcc
    v_cmp_eq_u32 vcc, 4, v33
    s_nop 1
    v_cndmask_b32 v34, v34, v35, vcc
    v_mul_u32_u24 v32, 40, v32
    v_add_u32 v34, v34, v32
    v_mul_u32_u24 v34, 1280, v34
    s_mov_b32 m0, s56
    v_add_u32 v34, v34, v12
    buffer_load_dwordx4 v34, s[12:15], s57 offen nt lds
    s_add_u32 s55, s55, 2
    s_add_u32 s56, s56, 4096
    v_add_u32 v31, s55, v13
    v_mul_u32_u24 v32, 205, v31
    v_lshrrev_b32 v32, 10, v32
    v_mul_u32_u24 v33, 5, v32
    v_sub_u32 v33, v31, v33
    v_lshl_add_u32 v34, v33, 3, v15
    v_add_u32 v35, 4, v34
    v_cmp_lt_u32 vcc, 1, v33
    s_nop 1
    v_cndmask_b32 v34, v34, v35, vcc
    v_add_u32 v35, 16, v15
    v_add_u32 v36, 32, v15
    v_cmp_lt_u32 vcc, 3, v15
    s_nop 1
    v_cndmask_b32 v35, v35, v36, vcc
    v_cmp_eq_u32 vcc, 4, v33
    s_nop 1
    v_cndmask_b32 v34, v34, v35, vcc
    v_mul_u32_u24 v32, 40, v32
    v_add_u32 v34, v34, v32
    v_mul_u32_u24 v34, 1280, v34
    s_mov_b32 m0, s56
    v_add_u32 v34, v34, v12
    buffer_load_dwordx4 v34, s[12:15], s57 offen nt lds
L_icommon:
    s_waitcnt lgkmcnt(0)
    s_load_dword s44, s[42:43], 0
    s_mov_b32 s8, s16
    s_mov_b32 s9, s17
    s_mov_b32 s10, 2621440
    s_mov_b32 s11, s96
    s_mul_i32 s55, s46, 10240
    s_cmp_lt_u32 s47, 2
    s_cselect_b32 s56, s55, 1073741824
    buffer_load_dwordx4 v[48:51], v10, s[8:11], s55 offen offset:0
    buffer_load_dwordx4 v[52:55], v10, s[8:11], s55 offen offset:512
    buffer_load_dwordx4 v[56:59], v10, s[8:11], s56 offen offset:1024
    s_getpc_b64 s[98:99]
    s_lshl_b32 s55, s49, 2
    s_add_u32 s55, s55, s47
    s_lshl_b32 s55, s55, 9
    v_and_b32 v7, 3, v2
    v_lshlrev_b32 v7, 7, v7
    v_add_u32 v7, s55, v7
    v_min_u32 v7, (L_end-L_pc0), v7
L_pc0:
    global_load_dword v63, v7, s[98:99]
    s_mov_b32 s4, s42
    s_mov_b32 s5, s43
    s_mov_b32 s6, 46137344
    s_mov_b32 s7, s96
    s_mov_b32 s12, s20
    s_mov_b32 s13, s21
    s_mov_b32 s14, 25600
    s_mov_b32 s15, s96
    v_lshlrev_b32 v31, 4, v0
    v_min_u32 v31, 1584, v31
    s_mul_i32 s55, s51, 1600
    s_lshl_b32 s56, s47, 10
    s_cmp_lt_u32 s47, 2
    s_cselect_b32 s56, s56, 4294962176
    s_add_u32 s56, s56, 156672
    s_mov_b32 m0, s56
    s_nop 0
    buffer_load_dwordx4 v31, s[12:15], s55 offen lds
    v_lshlrev_b32 v12, 9, v9
    v_lshl_add_u32 v12, v8, 4, v12
    s_lshr_b32 s82, s46, 2
    s_mul_i32 s82, s82, 40960
    s_and_b32 s83, s46, 3
    s_lshl_b32 s83, s83, 7
    s_add_u32 s82, s82, s83
    s_add_u32 s82, s82, 1048576
    s_add_u32 s83, s82, 16384
    s_add_u32 s84, s82, 32768
    s_cmp_lt_u32 s47, 2
    s_cselect_b32 s84, s84, 1073741824
    v_mov_b32 v46, 0
    v_mov_b32 v47, 0
    v_lshlrev_b32 v45, 3, v0
    v_add_u32 v45, 160768, v45
    ds_write_b64 v45, v[46:47]
    s_waitcnt lgkmcnt(0)
    s_mul_i32 s44, s44, 0x2c1b3c6d
    s_add_u32 s44, s44, 0x297a2d39
    s_mov_b32 s45, s44
    s_mov_b32 s54, 0
    s_getreg_b32 s55, hwreg(HW_REG_XCC_ID, 0, 4)
    s_lshl_b32 s56, s46, 2
    s_add_u32 s56, s56, 4096
    s_add_u32 s24, s55, s44
    s_add_u32 s24, s24, 1
    s_cmp_eq_u32 s47, 0
    s_cselect_b32 s56, s56, 1073741824
    v_mov_b32 v45, s24
    s_mov_b64 exec, 1
    buffer_store_dword v45, v46, s[4:7], s56 offen sc1
    s_mov_b64 exec, -1
    v_bfe_u32 v41, v2, 4, 1
    v_bfe_u32 v42, v2, 1, 1
    v_lshl_add_u32 v41, v41, 1, v42
    v_lshlrev_b32 v41, 2, v41
    v_and_b32 v42, 1, v2
    v_bfe_u32 v43, v2, 2, 2
    v_lshrrev_b32 v44, 5, v2
    s_cmp_lt_u32 s49, 10
    s_cbranch_scc0 L_rw1
    s_waitcnt vmcnt(6)
    v_lshlrev_b32 v156, 16, v156
    v_mul_f32 v167, 0xbfb8aa3b, v156
    v_exp_f32 v167, v167
    s_nop 0
    v_add_f32 v167, 1.0, v167
    v_rcp_f32 v167, v167
    s_nop 0
    v_mul_f32 v167, v156, v167
    v_cvt_pk_bf16_f32 v168, v167, 0
    v_lshlrev_b32 v169, 16, v168
    v_lshlrev_b32 v157, 16, v157
    v_mul_f32 v167, 0xbfb8aa3b, v157
    v_exp_f32 v167, v167
    s_nop 0
    v_add_f32 v167, 1.0, v167
    v_rcp_f32 v167, v167
    s_nop 0
    v_mul_f32 v167, v157, v167
    v_cvt_pk_bf16_f32 v170, v167, 0
    v_lshlrev_b32 v171, 16, v170
    v_lshlrev_b32 v158, 16, v158
    v_mul_f32 v167, 0xbfb8aa3b, v158
    v_exp_f32 v167, v167
    s_nop 0
    v_add_f32 v167, 1.0, v167
    v_rcp_f32 v167, v167
    s_nop 0
    v_mul_f32 v167, v158, v167
    v_cvt_pk_bf16_f32 v172, v167, 0
    v_lshlrev_b32 v173, 16, v172
    v_lshlrev_b32 v159, 16, v159
    v_mul_f32 v167, 0xbfb8aa3b, v159
    v_exp_f32 v167, v167
    s_nop 0
    v_add_f32 v167, 1.0, v167
    v_rcp_f32 v167, v167
    s_nop 0
    v_mul_f32 v167, v159, v167
    v_cvt_pk_bf16_f32 v174, v167, 0
    v_lshlrev_b32 v175, 16, v174
    v_lshlrev_b32 v160, 16, v160
    v_mul_f32 v167, 0xbfb8aa3b, v160
    v_exp_f32 v167, v167
    s_nop 0
    v_add_f32 v167, 1.0, v167
    v_rcp_f32 v167, v167
    s_nop 0
    v_mul_f32 v167, v160, v167
    v_cvt_pk_bf16_f32 v176, v167, 0
    v_lshlrev_b32 v177, 16, v176
    v_mov_b32 v180, 0
    v_mov_b32 v181, 0
    v_mov_b32 v182, 0
    v_mov_b32 v183, 0
    v_mov_b32 v184, 0
    v_mov_b32 v185, 0
    v_mov_b32 v186, 0
    v_mov_b32 v187, 0
    v_dot2c_f32_bf16 v180, v136, v168
    v_dot2c_f32_bf16 v181, v136, v169
    v_dot2c_f32_bf16 v182, v137, v168
    v_dot2c_f32_bf16 v183, v137, v169
    v_dot2c_f32_bf16 v184, v138, v168
    v_dot2c_f32_bf16 v185, v138, v169
    v_dot2c_f32_bf16 v186, v139, v168
    v_dot2c_f32_bf16 v187, v139, v169
    v_dot2c_f32_bf16 v180, v140, v170
    v_dot2c_f32_bf16 v181, v140, v171
    v_dot2c_f32_bf16 v182, v141, v170
    v_dot2c_f32_bf16 v183, v141, v171
    v_dot2c_f32_bf16 v184, v142, v170
    v_dot2c_f32_bf16 v185, v142, v171
    v_dot2c_f32_bf16 v186, v143, v170
    v_dot2c_f32_bf16 v187, v143, v171
    v_dot2c_f32_bf16 v180, v144, v172
    v_dot2c_f32_bf16 v181, v144, v173
    v_dot2c_f32_bf16 v182, v145, v172
    v_dot2c_f32_bf16 v183, v145, v173
    v_dot2c_f32_bf16 v184, v146, v172
    v_dot2c_f32_bf16 v185, v146, v173
    v_dot2c_f32_bf16 v186, v147, v172
    v_dot2c_f32_bf16 v187, v147, v173
    v_dot2c_f32_bf16 v180, v148, v174
    v_dot2c_f32_bf16 v181, v148, v175
    v_dot2c_f32_bf16 v182, v149, v174
    v_dot2c_f32_bf16 v183, v149, v175
    v_dot2c_f32_bf16 v184, v150, v174
    v_dot2c_f32_bf16 v185, v150, v175
    v_dot2c_f32_bf16 v186, v151, v174
    v_dot2c_f32_bf16 v187, v151, v175
    v_dot2c_f32_bf16 v180, v152, v176
    v_dot2c_f32_bf16 v181, v152, v177
    v_dot2c_f32_bf16 v182, v153, v176
    v_dot2c_f32_bf16 v183, v153, v177
    v_dot2c_f32_bf16 v184, v154, v176
    v_dot2c_f32_bf16 v185, v154, v177
    v_dot2c_f32_bf16 v186, v155, v176
    v_dot2c_f32_bf16 v187, v155, v177
    v_permlane32_swap_b32 v180, v182
    v_permlane32_swap_b32 v181, v183
    v_permlane32_swap_b32 v184, v186
    v_permlane32_swap_b32 v185, v187
    v_add_f32 v180, v180, v182
    v_add_f32 v181, v181, v183
    v_add_f32 v184, v184, v186
    v_add_f32 v185, v185, v187
    v_permlane16_swap_b32 v180, v181
    s_nop 0
    v_permlane16_swap_b32 v184, v185
    v_add_f32 v180, v180, v181
    v_add_f32 v184, v184, v185
    s_nop 0
    v_add_f32_dpp v180, v180, v180 row_ror:8 row_mask:0xf bank_mask:0xf
    v_add_f32_dpp v184, v184, v184 row_ror:8 row_mask:0xf bank_mask:0xf
    v_and_b32 v167, 7, v2
    v_lshrrev_b32 v168, 4, v2
    v_lshl_add_u32 v167, v167, 3, v168
    v_lshlrev_b32 v167, 2, v167
    s_lshl_b32 s55, s47, 8
    s_add_u32 s55, s55, 152576
    v_add_u32 v167, s55, v167
    ds_write_b32 v167, v180
    ds_write_b32 v167, v184 offset:16
    v_min_u32 v167, 21, v2
    v_mul_u32_u24 v168, 12, v167
    v_add_u32 v168, 152576, v168
    s_mul_i32 s57, s77, 384
    s_add_u32 s57, s57, 65536
    s_waitcnt lgkmcnt(0)
    s_barrier
    ds_read2_b32 v[170:171], v168 offset0:0 offset1:1
    ds_read_b32 v172, v168 offset:8
    ds_read2_b32 v[174:175], v168 offset0:64 offset1:65
    ds_read_b32 v176, v168 offset:264
    ds_read2_b32 v[178:179], v168 offset0:128 offset1:129
    ds_read_b32 v180, v168 offset:520
    ds_read2_b32 v[182:183], v168 offset0:192 offset1:193
    ds_read_b32 v184, v168 offset:776
    s_cmp_eq_u32 s47, 0
    s_cselect_b32 s57, s57, 1073741824
    v_lshlrev_b32 v167, 4, v167
    v_mov_b32 v191, s44
    s_waitcnt lgkmcnt(0)
    v_add_f32 v170, v170, v174
    v_add_f32 v178, v178, v182
    v_add_f32 v171, v171, v175
    v_add_f32 v179, v179, v183
    v_add_f32 v172, v172, v176
    v_add_f32 v180, v180, v184
    v_add_f32 v188, v170, v178
    v_add_f32 v189, v171, v179
    v_add_f32 v190, v172, v180
    s_mov_b32 exec_lo, 0x3fffff
    s_mov_b32 exec_hi, 0
    buffer_store_dwordx4 v[188:191], v167, s[4:7], s57 offen sc1
    s_mov_b64 exec, -1
    s_waitcnt vmcnt(2)
    s_mov_b32 s61, 1073741824
    s_mov_b32 s62, 1073741824
    s_branch L_rcommon
L_rw1:
    v_lshl_add_u32 v35, v44, 3, v43
    v_lshlrev_b32 v35, 10, v35
    v_mul_u32_u24 v36, 40, v42
    s_mul_i32 s55, s47, 80
    s_add_u32 s55, s55, 122880
    v_add3_u32 v35, v35, v36, s55
    v_add_u32 v36, 0, v41
    v_mul_u32_u24 v37, 13, v36
    v_lshrrev_b32 v37, 8, v37
    v_mul_u32_u24 v37, 280, v37
    v_lshl_add_u32 v37, v36, 1, v37
    v_add_u32 v16, v37, v35
    v_add_u32 v36, 16, v41
    v_mul_u32_u24 v37, 13, v36
    v_lshrrev_b32 v37, 8, v37
    v_mul_u32_u24 v37, 280, v37
    v_lshl_add_u32 v37, v36, 1, v37
    v_add_u32 v17, v37, v35
    v_add_u32 v36, 32, v41
    v_mul_u32_u24 v37, 13, v36
    v_lshrrev_b32 v37, 8, v37
    v_mul_u32_u24 v37, 280, v37
    v_lshl_add_u32 v37, v36, 1, v37
    v_add_u32 v18, v37, v35
    v_add_u32 v36, 48, v41
    v_mul_u32_u24 v37, 13, v36
    v_lshrrev_b32 v37, 8, v37
    v_mul_u32_u24 v37, 280, v37
    v_lshl_add_u32 v37, v36, 1, v37
    v_add_u32 v19, v37, v35
    v_lshrrev_b32 v31, 4, v2
    v_bfe_u32 v32, v2, 2, 2
    v_lshl_add_u32 v31, v31, 3, v32
    v_lshlrev_b32 v31, 8, v31
    v_and_b32 v32, 3, v2
    s_lshl_b32 s55, s47, 3
    s_add_u32 s55, s55, 139264
    v_lshl_add_u32 v33, v32, 5, v31
    v_add_u32 v33, s55, v33
    v_lshl_add_u32 v34, v32, 3, v31
    v_add_u32 v34, 139392, v34
    s_and_b32 s55, s77, 3
    s_lshl_b32 s61, s55, 8
    s_lshl_b32 s55, s55, 2
    s_add_u32 s55, s55, s47
    s_lshr_b32 s56, s77, 2
    s_mul_i32 s57, s55, 0x1e000
    s_mul_i32 s58, s56, 3072
    s_add_u32 s57, s57, s58
    s_add_u32 s57, s57, 4194304
    s_add_u32 s57, s57, s101
    s_mul_i32 s58, s55, 0xa000
    s_lshl_b32 s59, s56, 10
    s_add_u32 s58, s58, s59
    s_add_u32 s58, s58, 6291456
    s_add_u32 s58, s58, s101
    s_lshl_b32 s56, s56, 2
    s_add_u32 s61, s61, s56
    s_add_u32 s61, s61, 5120
    s_add_u32 s61, s61, s101
    s_and_b32 s55, s77, 7
    s_lshr_b32 s56, s77, 3
    s_mul_i32 s59, s55, 0x19000
    s_mul_i32 s60, s56, 5120
    s_add_u32 s59, s59, s60
    s_add_u32 s59, s59, 7340032
    s_add_u32 s59, s59, s101
    s_lshl_b32 s62, s55, 7
    s_lshl_b32 s56, s56, 2
    s_add_u32 s62, s62, s56
    s_add_u32 s62, s62, 7168
    s_add_u32 s62, s62, s101
    s_waitcnt vmcnt(6)
    s_barrier
    ds_read_b64_tr_b16 v[180:181], v16
    ds_read_b64_tr_b16 v[182:183], v16 offset:4096
    ds_read_b64_tr_b16 v[184:185], v17
    ds_read_b64_tr_b16 v[186:187], v17 offset:4096
    ds_read_b64_tr_b16 v[188:189], v18
    ds_read_b64_tr_b16 v[190:191], v18 offset:4096
    ds_read_b64_tr_b16 v[192:193], v19
    ds_read_b64_tr_b16 v[194:195], v19 offset:4096
    s_waitcnt lgkmcnt(0)
    buffer_store_dwordx4 v[180:183], v1, s[4:7], s57 offen offset:0 sc1
    buffer_store_dwordx4 v[184:187], v1, s[4:7], s57 offen offset:1024 sc1
    buffer_store_dwordx4 v[188:191], v1, s[4:7], s57 offen offset:2048 sc1
    buffer_store_dwordx4 v[192:195], v1, s[4:7], s58 offen sc1
    ds_read_b64_tr_b16 v[196:197], v33
    ds_read_b64_tr_b16 v[198:199], v33 offset:1024
    ds_read_b64_tr_b16 v[200:201], v34
    ds_read_b64_tr_b16 v[202:203], v34 offset:1024
    s_lshl_b32 s56, s47, 10
    s_add_u32 s56, s56, s59
    s_add_u32 s55, s59, 4096
    s_cmp_eq_u32 s47, 0
    s_cselect_b32 s55, s55, 1073741824
    s_waitcnt lgkmcnt(0)
    buffer_store_dwordx4 v[196:199], v1, s[4:7], s56 offen sc1
    buffer_store_dwordx4 v[200:203], v1, s[4:7], s55 offen sc1
    s_waitcnt vmcnt(7)
L_rcommon:
    v_min_u32 v31, 19, v2
    s_mul_i32 s55, s47, 20
    v_add_u32 v31, s55, v31
    v_lshlrev_b32 v31, 9, v31
    v_add_u32 v31, s82, v31
    s_lshl_b32 s55, s50, 7
    s_add_u32 s55, s55, 16384
    s_lshl_b32 s56, s50, 8
    s_add_u32 s56, s56, 20480
    s_lshl_b32 s57, s52, 7
    s_add_u32 s57, s57, 24576
    v_writelane_b32 v31, s55, 20
    v_writelane_b32 v31, s56, 21
    v_writelane_b32 v31, s57, 22
    s_add_u32 s56, s56, 128
    s_add_u32 s57, s57, 4096
    v_writelane_b32 v31, s56, 23
    v_writelane_b32 v31, s57, 24
    v_mov_b32 v26, v31
    v_and_b32 v27, 31, v2
    v_min_u32 v27, 23, v27
    v_lshlrev_b32 v28, 4, v27
    v_add_u32 v29, 1536, v28
    v_subrev_u32 v28, 192, v28
    v_cmp_gt_u32 vcc, 12, v27
    s_nop 1
    v_cndmask_b32 v28, v28, v29, vcc
    v_lshrrev_b32 v29, 5, v0
    v_mul_u32_u24 v29, 3072, v29
    v_add_u32 v28, v28, v29
    s_mul_i32 s55, s52, 98304
    s_mul_i32 s56, s53, 192
    s_add_u32 s55, s55, s56
    s_cmp_lt_u32 s52, 20
    s_cselect_b32 s87, s55, 1073741824
    v_lshlrev_b32 v30, 1, v9
    v_mul_u32_u24 v29, 7680, v9
    v_lshl_add_u32 v29, v8, 4, v29
    s_mul_i32 s92, s48, 25
    s_add_u32 s92, s92, s49
    s_mul_i32 s55, s92, 205
    s_lshr_b32 s55, s55, 10
    s_mul_i32 s56, s55, 5
    s_sub_u32 s56, s92, s56
    s_lshl_b32 s89, s56, 8
    s_mul_i32 s56, s56, 983040
    s_lshl_b32 s55, s55, 7
    s_add_u32 s55, s55, s56
    s_add_u32 s55, s55, 2560
    s_cmp_lt_u32 s49, 25
    s_cselect_b32 s88, s55, 1073741824
    v_and_b32 v11, 15, v2
    v_min_u32 v32, 9, v11
    v_lshrrev_b32 v23, 4, v0
    v_mul_u32_u24 v23, 1280, v23
    v_lshl_add_u32 v23, v32, 4, v23
    s_mul_i32 s55, s52, 40960
    s_mul_i32 s56, s53, 160
    s_add_u32 s55, s55, s56
    s_cmp_lt_u32 s52, 24
    s_cselect_b32 s90, s55, 1073741824
    v_lshrrev_b32 v32, 4, v2
    v_mul_u32_u24 v25, 1280, v11
    v_lshl_add_u32 v24, v32, 5, v25
    v_lshl_add_u32 v25, v32, 3, v25
    s_lshl_b32 s55, s52, 2
    s_add_u32 s55, s55, s47
    s_mul_i32 s55, s55, 20480
    s_add_u32 s97, s55, s56
    s_lshl_b32 s81, s47, 10
    s_add_u32 s81, s81, 65536
    s_mov_b32 s12, s36
    s_mov_b32 s13, s37
    s_mov_b32 s14, 4915200
    s_mov_b32 s15, s96
    s_mov_b32 s64, s34
    s_mov_b32 s65, s35
    s_mov_b32 s66, 1280
    s_mov_b32 s67, s96
    s_mov_b32 s68, s26
    s_mov_b32 s69, s27
    s_mov_b32 s70, 1966080
    s_mov_b32 s71, s96
    s_mov_b32 s72, s32
    s_mov_b32 s73, s33
    s_mov_b32 s74, 983040
    s_mov_b32 s75, s96
    buffer_load_dword v63, v26, s[4:7], 0 offen sc1
    buffer_load_dwordx4 v[204:207], v29, s[12:15], s88 offen nt
    s_add_u32 s88, s88, 245760
    buffer_load_dwordx4 v[208:211], v29, s[12:15], s88 offen nt
    s_add_u32 s88, s88, 245760
    buffer_load_dwordx4 v[212:215], v29, s[12:15], s88 offen nt
    s_add_u32 s88, s88, 245760
    buffer_load_dwordx4 v[216:219], v29, s[12:15], s88 offen nt
    buffer_load_ushort v220, v30, s[64:67], s89 offen offset:0
    buffer_load_ushort v221, v30, s[64:67], s89 offen offset:64
    buffer_load_ushort v222, v30, s[64:67], s89 offen offset:128
    v_mov_b32 v16, 0
    v_mov_b32 v17, 0
    v_mov_b32 v18, 0x3f803f80
    v_dot2c_f32_bf16 v16, v48, v18
    v_dot2c_f32_bf16 v17, v48, v48
    v_dot2c_f32_bf16 v16, v49, v18
    v_dot2c_f32_bf16 v17, v49, v49
    v_dot2c_f32_bf16 v16, v50, v18
    v_dot2c_f32_bf16 v17, v50, v50
    v_dot2c_f32_bf16 v16, v51, v18
    v_dot2c_f32_bf16 v17, v51, v51
    v_dot2c_f32_bf16 v16, v52, v18
    v_dot2c_f32_bf16 v17, v52, v52
    v_dot2c_f32_bf16 v16, v53, v18
    v_dot2c_f32_bf16 v17, v53, v53
    v_dot2c_f32_bf16 v16, v54, v18
    v_dot2c_f32_bf16 v17, v54, v54
    v_dot2c_f32_bf16 v16, v55, v18
    v_dot2c_f32_bf16 v17, v55, v55
    v_dot2c_f32_bf16 v16, v56, v18
    v_dot2c_f32_bf16 v17, v56, v56
    v_dot2c_f32_bf16 v16, v57, v18
    v_dot2c_f32_bf16 v17, v57, v57
    v_dot2c_f32_bf16 v16, v58, v18
    v_dot2c_f32_bf16 v17, v58, v58
    v_dot2c_f32_bf16 v16, v59, v18
    v_dot2c_f32_bf16 v17, v59, v59
    s_nop 1
    v_add_f32_dpp v16, v16, v16 row_ror:8 row_mask:0xf bank_mask:0xf
    v_add_f32_dpp v17, v17, v17 row_ror:8 row_mask:0xf bank_mask:0xf
    s_nop 1
    v_permlane16_swap_b32 v16, v17
    v_add_f32 v16, v16, v17
    v_mov_b32 v17, v16
    s_nop 1
    v_permlane32_swap_b32 v16, v17
    v_add_f32 v16, v16, v17
    v_bfe_u32 v18, v2, 4, 1
    v_lshlrev_b32 v18, 5, v18
    v_lshl_add_u32 v18, v8, 2, v18
    s_lshl_b32 s55, s47, 6
    s_add_u32 s55, s55, 155648
    v_add_u32 v18, s55, v18
    ds_write_b32 v18, v16
    v_mul_u32_u24 v36, 800, v42
    v_mul_u32_u24 v37, 40, v43
    v_add_u32 v36, v36, v37
    v_lshl_add_u32 v36, v41, 1, v36
    v_add_u32 v36, 156672, v36
    v_mov_b32 v39, 160768
    v_cmp_eq_u32 vcc, v42, v44
    s_nop 1
    v_cndmask_b32 v37, v39, v36, vcc
    v_add_u32 v38, 32, v37
    v_cmp_eq_u32 vcc, 0, v41
    s_nop 1
    v_cndmask_b32 v38, v39, v38, vcc
    s_cmp_eq_u32 s47, 0
    s_cselect_b32 s61, s61, 1073741824
    s_cmp_eq_u32 s47, 0
    s_cselect_b32 s62, s62, 1073741824
    v_lshlrev_b32 v96, 16, v48
    v_and_b32 v97, 0xffff0000, v48
    v_lshlrev_b32 v98, 16, v49
    v_and_b32 v99, 0xffff0000, v49
    v_lshlrev_b32 v100, 16, v50
    v_and_b32 v101, 0xffff0000, v50
    v_lshlrev_b32 v102, 16, v51
    v_and_b32 v103, 0xffff0000, v51
    v_lshlrev_b32 v104, 16, v52
    v_and_b32 v105, 0xffff0000, v52
    v_lshlrev_b32 v106, 16, v53
    v_and_b32 v107, 0xffff0000, v53
    v_lshlrev_b32 v108, 16, v54
    v_and_b32 v109, 0xffff0000, v54
    v_lshlrev_b32 v110, 16, v55
    v_and_b32 v111, 0xffff0000, v55
    v_lshlrev_b32 v112, 16, v56
    v_and_b32 v113, 0xffff0000, v56
    v_lshlrev_b32 v114, 16, v57
    v_and_b32 v115, 0xffff0000, v57
    v_lshlrev_b32 v116, 16, v58
    v_and_b32 v117, 0xffff0000, v58
    v_lshlrev_b32 v118, 16, v59
    v_and_b32 v119, 0xffff0000, v59
    buffer_load_ushort v223, v30, s[64:67], s89 offen offset:192
    s_mov_b32 m0, s81
    s_nop 0
    buffer_load_dwordx4 v28, s[68:71], s87 offen nt lds
    s_add_u32 s87, s87, 24576
    s_add_u32 s81, s81, 4096
    s_mov_b32 m0, s81
    s_nop 0
    buffer_load_dwordx4 v28, s[68:71], s87 offen nt lds
    s_waitcnt vmcnt(11)
    s_waitcnt lgkmcnt(0)
    s_barrier
    v_mov_b32 v46, s44
    v_mov_b32 v47, 0
    s_mov_b64 exec, 1
    buffer_store_dword v46, v47, s[4:7], s61 offen sc1
    s_mov_b64 exec, -1
    v_mov_b32 v46, s44
    v_mov_b32 v47, 0
    s_mov_b64 exec, 1
    buffer_store_dword v46, v47, s[4:7], s62 offen sc1
    s_mov_b64 exec, -1
    s_add_u32 s87, s87, 24576
    s_add_u32 s81, s81, 4096
    s_mov_b32 m0, s81
    s_nop 0
    buffer_load_dwordx4 v28, s[68:71], s87 offen nt lds
    s_add_u32 s87, s87, 24576
    s_add_u32 s81, s81, 4096
    s_mov_b32 m0, s81
    s_nop 0
    buffer_load_dwordx4 v28, s[68:71], s87 offen nt lds
    s_add_u32 s81, s81, 4096
    s_mov_b32 m0, s81
    s_nop 0
    buffer_load_dwordx4 v23, s[72:75], s90 offen nt lds
    s_add_u32 s90, s90, 20480
    s_add_u32 s81, s81, 4096
    s_mov_b32 m0, s81
    s_nop 0
    buffer_load_dwordx4 v23, s[72:75], s90 offen nt lds
    buffer_load_dwordx4 a[244:247], v24, s[8:11], s97 offen
    buffer_load_dwordx4 a[248:251], v24, s[8:11], s97 offen offset:16
    buffer_load_dwordx2 a[252:253], v25, s[8:11], s97 offen offset:128
    v_lshlrev_b32 v18, 2, v8
    v_add_u32 v18, 155648, v18
    ds_read2_b32 v[20:21], v18 offset0:0 offset1:8
    ds_read2_b32 v[22:23], v18 offset0:16 offset1:24
    ds_read2_b32 v[24:25], v18 offset0:32 offset1:40
    ds_read2_b32 v[26:27], v18 offset0:48 offset1:56
    ds_read_b64_tr_b16 v[232:233], v37 offset:0
    ds_read_b64_tr_b16 v[234:235], v37 offset:160
    ds_read_b64_tr_b16 v[236:237], v37 offset:320
    ds_read_b64_tr_b16 v[238:239], v37 offset:480
    ds_read_b64_tr_b16 v[240:241], v37 offset:640
    v_mov_b32 v242, 0
    v_mov_b32 v243, 0
    ds_read_b64_tr_b16 v[244:245], v38 offset:0
    ds_read_b64_tr_b16 v[246:247], v38 offset:160
    ds_read_b64_tr_b16 v[248:249], v38 offset:320
    ds_read_b64_tr_b16 v[250:251], v38 offset:480
    ds_read_b64_tr_b16 v[252:253], v38 offset:640
    v_mov_b32 v254, 0
    v_mov_b32 v255, 0
    s_waitcnt lgkmcnt(10)
    v_add_f32 v20, v20, v22
    v_add_f32 v21, v21, v23
    v_add_f32 v24, v24, v26
    v_add_f32 v25, v25, v27
    v_add_f32 v16, v20, v24
    v_add_f32 v17, v21, v25
    s_mov_b32 s57, 0x3acccccd
    v_mul_f32 v16, s57, v16
    v_mul_f32 v4, v16, v16
    v_fma_f32 v17, v17, s57, -v4
    v_max_f32 v17, 0, v17
    v_add_f32 v17, 0x3727c5ac, v17
    v_rsq_f32 v17, v17
    s_nop 0
    v_mul_f32 v16, -v16, v17
    v_fma_f32 v96, v96, v17, v16
    v_fma_f32 v97, v97, v17, v16
    v_fma_f32 v98, v98, v17, v16
    v_fma_f32 v99, v99, v17, v16
    v_fma_f32 v100, v100, v17, v16
    v_fma_f32 v101, v101, v17, v16
    v_fma_f32 v102, v102, v17, v16
    v_fma_f32 v103, v103, v17, v16
    v_fma_f32 v104, v104, v17, v16
    v_fma_f32 v105, v105, v17, v16
    v_fma_f32 v106, v106, v17, v16
    v_fma_f32 v107, v107, v17, v16
    v_fma_f32 v108, v108, v17, v16
    v_fma_f32 v109, v109, v17, v16
    v_fma_f32 v110, v110, v17, v16
    v_fma_f32 v111, v111, v17, v16
    v_fma_f32 v112, v112, v17, v16
    v_fma_f32 v113, v113, v17, v16
    v_fma_f32 v114, v114, v17, v16
    v_fma_f32 v115, v115, v17, v16
    v_fma_f32 v116, v116, v17, v16
    v_fma_f32 v117, v117, v17, v16
    v_fma_f32 v118, v118, v17, v16
    v_fma_f32 v119, v119, v17, v16
    v_cvt_pk_bf16_f32 v64, v96, 0
    v_cvt_pk_bf16_f32 v65, 0, v97
    v_cvt_pk_bf16_f32 v66, v98, 0
    v_cvt_pk_bf16_f32 v67, 0, v99
    v_cvt_pk_bf16_f32 v68, v100, 0
    v_cvt_pk_bf16_f32 v69, 0, v101
    v_cvt_pk_bf16_f32 v70, v102, 0
    v_cvt_pk_bf16_f32 v71, 0, v103
    v_cvt_pk_bf16_f32 v72, v104, 0
    v_cvt_pk_bf16_f32 v73, 0, v105
    v_cvt_pk_bf16_f32 v74, v106, 0
    v_cvt_pk_bf16_f32 v75, 0, v107
    v_cvt_pk_bf16_f32 v76, v108, 0
    v_cvt_pk_bf16_f32 v77, 0, v109
    v_cvt_pk_bf16_f32 v78, v110, 0
    v_cvt_pk_bf16_f32 v79, 0, v111
    v_cvt_pk_bf16_f32 v80, v112, 0
    v_cvt_pk_bf16_f32 v81, 0, v113
    v_cvt_pk_bf16_f32 v82, v114, 0
    v_cvt_pk_bf16_f32 v83, 0, v115
    v_cvt_pk_bf16_f32 v84, v116, 0
    v_cvt_pk_bf16_f32 v85, 0, v117
    v_cvt_pk_bf16_f32 v86, v118, 0
    v_cvt_pk_bf16_f32 v87, 0, v119
    s_mov_b32 s57, 147456
    v_add_u32 v31, 0, v0
    v_min_u32 v31, 439, v31
    v_mul_u32_u24 v32, 2979, v31
    v_lshrrev_b32 v32, 16, v32
    v_mul_u32_u24 v33, 22, v32
    v_sub_u32 v33, v31, v33
    v_mul_u32_u24 v34, 1536, v32
    v_lshl_add_u32 v20, v33, 4, v34
    v_mul_u32_u24 v34, 144, v32
    v_mul_u32_u24 v33, 6, v33
    v_add3_u32 v22, v33, v34, s57
    v_cmp_lt_u32 vcc, 9, v32
    s_nop 1
    v_cndmask_b32 v24, 0, 1.0, vcc
    v_add_u32 v31, 256, v0
    v_min_u32 v31, 439, v31
    v_mul_u32_u24 v32, 2979, v31
    v_lshrrev_b32 v32, 16, v32
    v_mul_u32_u24 v33, 22, v32
    v_sub_u32 v33, v31, v33
    v_mul_u32_u24 v34, 1536, v32
    v_lshl_add_u32 v21, v33, 4, v34
    v_mul_u32_u24 v34, 144, v32
    v_mul_u32_u24 v33, 6, v33
    v_add3_u32 v23, v33, v34, s57
    v_cmp_lt_u32 vcc, 9, v32
    s_nop 1
    v_cndmask_b32 v25, 0, 1.0, vcc
    v_min_u32 v26, 39, v2
    v_lshlrev_b32 v26, 2, v26
    v_and_b32 v27, 31, v2
    v_lshlrev_b32 v27, 2, v27
    v_lshrrev_b32 v13, 3, v9
    v_mul_u32_u24 v13, 144, v13
    v_and_b32 v28, 7, v9
    v_lshl_add_u32 v13, v28, 4, v13
    v_add_u32 v13, 147456, v13
    s_mov_b32 s55, 65536
    s_lshr_b32 s56, s51, 2
    s_lshl_b32 s56, s56, 8
    s_add_u32 s56, s56, 5120
    s_lshl_b32 s57, s48, 7
    s_add_u32 s57, s57, 4096
    s_add_u32 s61, s44, 1
    v_mov_b32 v29, s44
    s_mul_i32 s62, s51, 0x1e000
    s_mul_i32 s63, s47, 3072
    s_add_u32 s62, s62, s63
    s_add_u32 s62, s62, 4194304
    s_lshl_b32 s58, s50, 7
    s_add_u32 s58, s58, 16384
    s_lshl_b32 s59, s51, 2
    s_add_u32 s59, s59, s58
    s_lshl_b32 s60, s47, 4
    s_add_u32 s58, s58, s60
    v_and_b32 v14, 3, v2
    v_lshlrev_b32 v14, 2, v14
    s_cmp_eq_u32 s47, 0
    s_cselect_b32 s59, s59, 1073741824
    v_lshrrev_b32 v40, 4, v2
    v_bfe_u32 v45, v2, 2, 2
    v_lshl_add_u32 v40, v40, 3, v45
    v_and_b32 v45, 3, v2
    v_lshlrev_b32 v37, 9, v40
    v_mul_u32_u24 v38, 48, v45
    s_lshr_b32 s75, s47, 1
    s_and_b32 s76, s47, 1
    s_mul_i32 s77, s75, 192
    s_mul_i32 s74, s76, 24
    s_add_u32 s77, s77, s74
    s_add_u32 s77, s77, 65536
    v_add3_u32 v37, v37, v38, s77
    v_lshlrev_b32 v40, 8, v40
    s_lshl_b32 s74, s47, 3
    s_add_u32 s74, s74, 81920
    v_lshl_add_u32 v38, v45, 5, v40
    v_add_u32 v38, s74, v38
    v_lshl_add_u32 v39, v45, 3, v40
    v_add_u32 v39, 82048, v39
    s_mul_i32 s74, s53, 0x3c000
    s_mul_i32 s77, s75, 0x1e000
    s_add_u32 s74, s74, s77
    s_mul_i32 s77, s52, 6144
    s_add_u32 s74, s74, s77
    s_mul_i32 s77, s76, 3072
    s_add_u32 s74, s74, s77
    s_add_u32 s74, s74, 9437184
    s_cmp_lt_u32 s52, 20
    s_cselect_b32 s91, s74, 1073741824
    s_mul_i32 s92, s92, 384
    s_add_u32 s92, s92, 917504
    s_cmp_lt_u32 s49, 25
    s_cselect_b32 s92, s92, 1073741824
    s_mul_i32 s74, s53, 0x1e000
    s_mul_i32 s77, s52, 5120
    s_add_u32 s74, s74, s77
    s_add_u32 s74, s74, 8388608
    s_cmp_lt_u32 s52, 24
    s_cselect_b32 s74, s74, 1073741824
    s_lshl_b32 s77, s47, 10
    s_add_u32 s93, s74, s77
    s_add_u32 s86, s74, 4096
    s_cmp_eq_u32 s47, 0
    s_cselect_b32 s86, s86, 1073741824
    s_waitcnt vmcnt(0)
    buffer_load_dwordx4 v[96:99], v20, s[4:7], s55 offen offset:0 sc1
    buffer_load_dwordx4 v[100:103], v20, s[4:7], s55 offen offset:384 sc1
    buffer_load_dwordx4 v[104:107], v20, s[4:7], s55 offen offset:768 sc1
    buffer_load_dwordx4 v[108:111], v20, s[4:7], s55 offen offset:1152 sc1
    buffer_load_dwordx4 v[112:115], v21, s[4:7], s55 offen offset:0 sc1
    buffer_load_dwordx4 v[116:119], v21, s[4:7], s55 offen offset:384 sc1
    buffer_load_dwordx4 v[120:123], v21, s[4:7], s55 offen offset:768 sc1
    buffer_load_dwordx4 v[124:127], v21, s[4:7], s55 offen offset:1152 sc1
    buffer_load_dword v31, v27, s[4:7], s57 offen sc1
    v_lshlrev_b32 v220, 16, v220
    v_mul_f32 v167, 0xbfb8aa3b, v220
    v_exp_f32 v167, v167
    s_nop 0
    v_add_f32 v167, 1.0, v167
    v_rcp_f32 v167, v167
    s_nop 0
    v_mul_f32 v167, v220, v167
    v_cvt_pk_bf16_f32 v168, v167, 0
    v_lshlrev_b32 v169, 16, v168
    v_lshlrev_b32 v221, 16, v221
    v_mul_f32 v167, 0xbfb8aa3b, v221
    v_exp_f32 v167, v167
    s_nop 0
    v_add_f32 v167, 1.0, v167
    v_rcp_f32 v167, v167
    s_nop 0
    v_mul_f32 v167, v221, v167
    v_cvt_pk_bf16_f32 v170, v167, 0
    v_lshlrev_b32 v171, 16, v170
    v_lshlrev_b32 v222, 16, v222
    v_mul_f32 v167, 0xbfb8aa3b, v222
    v_exp_f32 v167, v167
    s_nop 0
    v_add_f32 v167, 1.0, v167
    v_rcp_f32 v167, v167
    s_nop 0
    v_mul_f32 v167, v222, v167
    v_cvt_pk_bf16_f32 v172, v167, 0
    v_lshlrev_b32 v173, 16, v172
    v_lshlrev_b32 v223, 16, v223
    v_mul_f32 v167, 0xbfb8aa3b, v223
    v_exp_f32 v167, v167
    s_nop 0
    v_add_f32 v167, 1.0, v167
    v_rcp_f32 v167, v167
    s_nop 0
    v_mul_f32 v167, v223, v167
    v_cvt_pk_bf16_f32 v174, v167, 0
    v_lshlrev_b32 v175, 16, v174
    v_mov_b32 v180, 0
    v_mov_b32 v181, 0
    v_mov_b32 v182, 0
    v_mov_b32 v183, 0
    v_mov_b32 v184, 0
    v_mov_b32 v185, 0
    v_mov_b32 v186, 0
    v_mov_b32 v187, 0
    v_dot2c_f32_bf16 v180, v204, v168
    v_dot2c_f32_bf16 v181, v204, v169
    v_dot2c_f32_bf16 v182, v205, v168
    v_dot2c_f32_bf16 v183, v205, v169
    v_dot2c_f32_bf16 v184, v206, v168
    v_dot2c_f32_bf16 v185, v206, v169
    v_dot2c_f32_bf16 v186, v207, v168
    v_dot2c_f32_bf16 v187, v207, v169
    v_dot2c_f32_bf16 v180, v208, v170
    v_dot2c_f32_bf16 v181, v208, v171
    v_dot2c_f32_bf16 v182, v209, v170
    v_dot2c_f32_bf16 v183, v209, v171
    v_dot2c_f32_bf16 v184, v210, v170
    v_dot2c_f32_bf16 v185, v210, v171
    v_dot2c_f32_bf16 v186, v211, v170
    v_dot2c_f32_bf16 v187, v211, v171
    v_dot2c_f32_bf16 v180, v212, v172
    v_dot2c_f32_bf16 v181, v212, v173
    v_dot2c_f32_bf16 v182, v213, v172
    v_dot2c_f32_bf16 v183, v213, v173
    v_dot2c_f32_bf16 v184, v214, v172
    v_dot2c_f32_bf16 v185, v214, v173
    v_dot2c_f32_bf16 v186, v215, v172
    v_dot2c_f32_bf16 v187, v215, v173
    v_dot2c_f32_bf16 v180, v216, v174
    v_dot2c_f32_bf16 v181, v216, v175
    v_dot2c_f32_bf16 v182, v217, v174
    v_dot2c_f32_bf16 v183, v217, v175
    v_dot2c_f32_bf16 v184, v218, v174
    v_dot2c_f32_bf16 v185, v218, v175
    v_dot2c_f32_bf16 v186, v219, v174
    v_dot2c_f32_bf16 v187, v219, v175
    v_permlane32_swap_b32 v180, v182
    v_permlane32_swap_b32 v181, v183
    v_permlane32_swap_b32 v184, v186
    v_permlane32_swap_b32 v185, v187
    v_add_f32 v180, v180, v182
    v_add_f32 v181, v181, v183
    v_add_f32 v184, v184, v186
    v_add_f32 v185, v185, v187
    v_permlane16_swap_b32 v180, v181
    s_nop 0
    v_permlane16_swap_b32 v184, v185
    v_add_f32 v180, v180, v181
    v_add_f32 v184, v184, v185
    s_nop 0
    v_add_f32_dpp v180, v180, v180 row_ror:8 row_mask:0xf bank_mask:0xf
    v_add_f32_dpp v184, v184, v184 row_ror:8 row_mask:0xf bank_mask:0xf
    v_and_b32 v167, 7, v2
    v_lshrrev_b32 v168, 4, v2
    v_lshl_add_u32 v167, v167, 3, v168
    v_lshlrev_b32 v167, 2, v167
    s_lshl_b32 s60, s47, 8
    s_add_u32 s60, s60, 90112
    v_add_u32 v167, s60, v167
    ds_write_b32 v167, v180
    ds_write_b32 v167, v184 offset:16
    v_min_u32 v167, 21, v2
    v_mul_u32_u24 v168, 12, v167
    v_add_u32 v168, 90112, v168
    s_waitcnt vmcnt(0)
    v_xor_b32 v30, v99, v29
    v_bitop3_b32 v30, v30, v103, v29 bitop3:0xf6
    v_bitop3_b32 v30, v30, v107, v29 bitop3:0xf6
    v_bitop3_b32 v30, v30, v111, v29 bitop3:0xf6
    v_bitop3_b32 v30, v30, v115, v29 bitop3:0xf6
    v_bitop3_b32 v30, v30, v119, v29 bitop3:0xf6
    v_bitop3_b32 v30, v30, v123, v29 bitop3:0xf6
    v_bitop3_b32 v30, v30, v127, v29 bitop3:0xf6
    v_subrev_u32 v32, s61, v31
    v_lshrrev_b32 v32, 4, v32
    v_or_b32 v30, v30, v32
    v_cmp_ne_u32 vcc, 0, v30
    s_nop 0
    s_cmp_eq_u64 vcc, 0
    s_cbranch_scc1 L_mgd_2
L_mg_1:
    s_sleep 6
    buffer_load_dwordx4 v[96:99], v20, s[4:7], s55 offen offset:0 sc1
    buffer_load_dwordx4 v[100:103], v20, s[4:7], s55 offen offset:384 sc1
    buffer_load_dwordx4 v[104:107], v20, s[4:7], s55 offen offset:768 sc1
    buffer_load_dwordx4 v[108:111], v20, s[4:7], s55 offen offset:1152 sc1
    buffer_load_dwordx4 v[112:115], v21, s[4:7], s55 offen offset:0 sc1
    buffer_load_dwordx4 v[116:119], v21, s[4:7], s55 offen offset:384 sc1
    buffer_load_dwordx4 v[120:123], v21, s[4:7], s55 offen offset:768 sc1
    buffer_load_dwordx4 v[124:127], v21, s[4:7], s55 offen offset:1152 sc1
    buffer_load_dword v31, v27, s[4:7], s57 offen sc1
    s_waitcnt vmcnt(0)
    v_xor_b32 v30, v99, v29
    v_bitop3_b32 v30, v30, v103, v29 bitop3:0xf6
    v_bitop3_b32 v30, v30, v107, v29 bitop3:0xf6
    v_bitop3_b32 v30, v30, v111, v29 bitop3:0xf6
    v_bitop3_b32 v30, v30, v115, v29 bitop3:0xf6
    v_bitop3_b32 v30, v30, v119, v29 bitop3:0xf6
    v_bitop3_b32 v30, v30, v123, v29 bitop3:0xf6
    v_bitop3_b32 v30, v30, v127, v29 bitop3:0xf6
    v_subrev_u32 v32, s61, v31
    v_lshrrev_b32 v32, 4, v32
    v_or_b32 v30, v30, v32
    v_cmp_ne_u32 vcc, 0, v30
    s_nop 0
    s_cmp_eq_u64 vcc, 0
    s_cbranch_scc1 L_mgd_2
    s_sub_u32 s100, s100, 1
    s_cbranch_scc0 L_mg_1
    s_mov_b32 s100, 0
L_mgd_2:
    v_add_f32 v96, v96, v100
    v_add_f32 v97, v97, v101
    v_add_f32 v98, v98, v102
    v_add_f32 v96, v96, v104
    v_add_f32 v97, v97, v105
    v_add_f32 v98, v98, v106
    v_add_f32 v96, v96, v108
    v_add_f32 v97, v97, v109
    v_add_f32 v98, v98, v110
    v_cvt_pk_bf16_f32 v100, v96, v97
    v_cvt_pk_bf16_f32 v101, v98, v98
    v_lshlrev_b32 v96, 16, v100
    v_and_b32 v97, 0xffff0000, v100
    v_lshlrev_b32 v98, 16, v101
    v_add_f32 v96, v96, v24
    v_add_f32 v97, v97, v24
    v_add_f32 v98, v98, v24
    v_cvt_pk_bf16_f32 v100, v96, v97
    v_cvt_pk_bf16_f32 v101, v98, v98
    ds_write_b16 v22, v100
    ds_write_b16_d16_hi v22, v100 offset:2
    ds_write_b16 v22, v101 offset:4
    v_add_f32 v112, v112, v116
    v_add_f32 v113, v113, v117
    v_add_f32 v114, v114, v118
    v_add_f32 v112, v112, v120
    v_add_f32 v113, v113, v121
    v_add_f32 v114, v114, v122
    v_add_f32 v112, v112, v124
    v_add_f32 v113, v113, v125
    v_add_f32 v114, v114, v126
    v_cvt_pk_bf16_f32 v116, v112, v113
    v_cvt_pk_bf16_f32 v117, v114, v114
    v_lshlrev_b32 v112, 16, v116
    v_and_b32 v113, 0xffff0000, v116
    v_lshlrev_b32 v114, 16, v117
    v_add_f32 v112, v112, v25
    v_add_f32 v113, v113, v25
    v_add_f32 v114, v114, v25
    v_cvt_pk_bf16_f32 v116, v112, v113
    v_cvt_pk_bf16_f32 v117, v114, v114
    ds_write_b16 v23, v116
    ds_write_b16_d16_hi v23, v116 offset:2
    ds_write_b16 v23, v117 offset:4
    v_cmp_ne_u32 vcc, s24, v31
    s_nop 0
    s_cmp_eq_u64 vcc, 0
    s_cselect_b32 s54, 1, 0
    s_waitcnt lgkmcnt(0)
    s_barrier
    buffer_load_dword v35, v26, s[4:7], s56 offen sc1
    ds_read_b128 v[96:99], v13 offset:0
    ds_read_b128 v[100:103], v13 offset:1440
    ds_read_b128 v[104:107], v13 offset:576
    ds_read_b128 v[108:111], v13 offset:2016
    ds_read_b128 v[112:115], v13 offset:1152
    ds_read_b128 v[116:119], v13 offset:2592
    s_waitcnt lgkmcnt(4)
    v_lshlrev_b32 v140, 16, v96
    v_and_b32 v141, 0xffff0000, v96
    v_lshlrev_b32 v142, 16, v97
    v_and_b32 v143, 0xffff0000, v97
    v_lshlrev_b32 v144, 16, v98
    v_and_b32 v145, 0xffff0000, v98
    v_lshlrev_b32 v146, 16, v99
    v_and_b32 v147, 0xffff0000, v99
    v_dot2c_f32_bf16 v140, v64, v100
    v_dot2c_f32_bf16 v141, v65, v100
    v_dot2c_f32_bf16 v142, v66, v101
    v_dot2c_f32_bf16 v143, v67, v101
    v_dot2c_f32_bf16 v144, v68, v102
    v_dot2c_f32_bf16 v145, v69, v102
    v_dot2c_f32_bf16 v146, v70, v103
    v_dot2c_f32_bf16 v147, v71, v103
    s_waitcnt lgkmcnt(2)
    v_lshlrev_b32 v148, 16, v104
    v_and_b32 v149, 0xffff0000, v104
    v_lshlrev_b32 v150, 16, v105
    v_and_b32 v151, 0xffff0000, v105
    v_lshlrev_b32 v152, 16, v106
    v_and_b32 v153, 0xffff0000, v106
    v_lshlrev_b32 v154, 16, v107
    v_and_b32 v155, 0xffff0000, v107
    v_dot2c_f32_bf16 v148, v72, v108
    v_dot2c_f32_bf16 v149, v73, v108
    v_dot2c_f32_bf16 v150, v74, v109
    v_dot2c_f32_bf16 v151, v75, v109
    v_dot2c_f32_bf16 v152, v76, v110
    v_dot2c_f32_bf16 v153, v77, v110
    v_dot2c_f32_bf16 v154, v78, v111
    v_dot2c_f32_bf16 v155, v79, v111
    s_waitcnt lgkmcnt(0)
    v_lshlrev_b32 v156, 16, v112
    v_and_b32 v157, 0xffff0000, v112
    v_lshlrev_b32 v158, 16, v113
    v_and_b32 v159, 0xffff0000, v113
    v_lshlrev_b32 v160, 16, v114
    v_and_b32 v161, 0xffff0000, v114
    v_lshlrev_b32 v162, 16, v115
    v_and_b32 v163, 0xffff0000, v115
    v_dot2c_f32_bf16 v156, v80, v116
    v_dot2c_f32_bf16 v157, v81, v116
    v_dot2c_f32_bf16 v158, v82, v117
    v_dot2c_f32_bf16 v159, v83, v117
    v_dot2c_f32_bf16 v160, v84, v118
    v_dot2c_f32_bf16 v161, v85, v118
    v_dot2c_f32_bf16 v162, v86, v119
    v_dot2c_f32_bf16 v163, v87, v119
    v_cvt_pk_bf16_f32 v128, v140, v141
    v_cvt_pk_bf16_f32 v129, v142, v143
    v_cvt_pk_bf16_f32 v130, v144, v145
    v_cvt_pk_bf16_f32 v131, v146, v147
    v_cvt_pk_bf16_f32 v132, v148, v149
    v_cvt_pk_bf16_f32 v133, v150, v151
    v_cvt_pk_bf16_f32 v134, v152, v153
    v_cvt_pk_bf16_f32 v135, v154, v155
    v_cvt_pk_bf16_f32 v136, v156, v157
    v_cvt_pk_bf16_f32 v137, v158, v159
    v_cvt_pk_bf16_f32 v138, v160, v161
    v_cvt_pk_bf16_f32 v139, v162, v163
    s_cmp_eq_u32 s54, 0
    s_cbranch_scc1 L_glob_3
    buffer_store_dwordx4 v[128:131], v12, s[4:7], s82 offen
    buffer_store_dwordx4 v[132:135], v12, s[4:7], s83 offen
    buffer_store_dwordx4 v[136:139], v12, s[4:7], s84 offen
L_back_4:
    s_lshl_b32 s61, s50, 2
    s_add_u32 s61, s61, s47
    s_mul_i32 s61, s61, 40960
    s_add_u32 s61, s61, 1048576
    v_add_u32 v5, 0x10000, v1
    v_add_u32 v6, 0x20000, v1
    s_waitcnt vmcnt(3)
    v_cmp_ne_u32 vcc, s44, v35
    s_nop 0
    s_cmp_eq_u64 vcc, 0
    s_cselect_b32 s101, 1, 0
    s_cbranch_scc0 L_w1late
    s_mov_b32 m0, s63
    s_nop 0
    buffer_load_dwordx4 v1, s[4:7], s62 offen offset:0 sc1 lds
    buffer_load_dwordx4 v1, s[4:7], s62 offen offset:1024 sc1 lds
    buffer_load_dwordx4 v1, s[4:7], s62 offen offset:2048 sc1 lds
    s_add_u32 s62, s62, 12288
    s_add_u32 s63, s63, 12288
    s_mov_b32 m0, s63
    s_nop 0
    buffer_load_dwordx4 v1, s[4:7], s62 offen offset:0 sc1 lds
    buffer_load_dwordx4 v1, s[4:7], s62 offen offset:1024 sc1 lds
    buffer_load_dwordx4 v1, s[4:7], s62 offen offset:2048 sc1 lds
    s_add_u32 s62, s62, 12288
    s_add_u32 s63, s63, 12288
    s_mov_b32 m0, s63
    s_nop 0
    buffer_load_dwordx4 v1, s[4:7], s62 offen offset:0 sc1 lds
    buffer_load_dwordx4 v1, s[4:7], s62 offen offset:1024 sc1 lds
    buffer_load_dwordx4 v1, s[4:7], s62 offen offset:2048 sc1 lds
    s_add_u32 s62, s62, 12288
    s_add_u32 s63, s63, 12288
L_w1late:
    s_cmp_eq_u32 s101, 1
    s_cbranch_scc1 L_w1w
    s_waitcnt vmcnt(0)
L_w1w:
    s_waitcnt vmcnt(9)
    s_waitcnt lgkmcnt(0)
    s_barrier
    v_mov_b32 v46, s44
    v_mov_b32 v47, 0
    s_mov_b64 exec, 1
    s_cmp_eq_u32 s54, 0
    s_cbranch_scc1 L_glob_5
    buffer_store_dword v46, v47, s[4:7], s59 offen
L_back_6:
    s_mov_b64 exec, -1
    s_cmp_eq_u32 s101, 1
    s_cbranch_scc1 L_w1ok
L_vp_7:
    buffer_load_dword v35, v26, s[4:7], s56 offen sc1
    s_waitcnt vmcnt(0)
    v_cmp_ne_u32 vcc, s44, v35
    s_nop 0
    s_cmp_eq_u64 vcc, 0
    s_cbranch_scc1 L_vpd_8
    s_sub_u32 s100, s100, 1
    s_cbranch_scc0 L_vp_7
    s_mov_b32 s100, 0
L_vpd_8:
    s_mov_b32 m0, s63
    s_nop 0
    buffer_load_dwordx4 v1, s[4:7], s62 offen offset:0 sc1 lds
    buffer_load_dwordx4 v1, s[4:7], s62 offen offset:1024 sc1 lds
    buffer_load_dwordx4 v1, s[4:7], s62 offen offset:2048 sc1 lds
    s_add_u32 s62, s62, 12288
    s_add_u32 s63, s63, 12288
    s_mov_b32 m0, s63
    s_nop 0
    buffer_load_dwordx4 v1, s[4:7], s62 offen offset:0 sc1 lds
    buffer_load_dwordx4 v1, s[4:7], s62 offen offset:1024 sc1 lds
    buffer_load_dwordx4 v1, s[4:7], s62 offen offset:2048 sc1 lds
    s_add_u32 s62, s62, 12288
    s_add_u32 s63, s63, 12288
    s_mov_b32 m0, s63
    s_nop 0
    buffer_load_dwordx4 v1, s[4:7], s62 offen offset:0 sc1 lds
    buffer_load_dwordx4 v1, s[4:7], s62 offen offset:1024 sc1 lds
    buffer_load_dwordx4 v1, s[4:7], s62 offen offset:2048 sc1 lds
    s_add_u32 s62, s62, 12288
    s_add_u32 s63, s63, 12288
L_w1ok:
    s_mov_b32 m0, s63
    s_nop 0
    buffer_load_dwordx4 v1, s[4:7], s62 offen offset:0 sc1 lds
    buffer_load_dwordx4 v1, s[4:7], s62 offen offset:1024 sc1 lds
    buffer_load_dwordx4 v1, s[4:7], s62 offen offset:2048 sc1 lds
    s_add_u32 s62, s62, 12288
    s_add_u32 s63, s63, 12288
    s_mov_b32 m0, s63
    s_nop 0
    buffer_load_dwordx4 v1, s[4:7], s62 offen offset:0 sc1 lds
    buffer_load_dwordx4 v1, s[4:7], s62 offen offset:1024 sc1 lds
    buffer_load_dwordx4 v1, s[4:7], s62 offen offset:2048 sc1 lds
    s_add_u32 s62, s62, 12288
    s_add_u32 s63, s63, 12288
    ds_read2_b32 v[170:171], v168 offset0:0 offset1:1
    ds_read_b32 v172, v168 offset:8
    ds_read2_b32 v[174:175], v168 offset0:64 offset1:65
    ds_read_b32 v176, v168 offset:264
    ds_read2_b32 v[178:179], v168 offset0:128 offset1:129
    ds_read_b32 v180, v168 offset:520
    ds_read2_b32 v[182:183], v168 offset0:192 offset1:193
    ds_read_b32 v184, v168 offset:776
    s_cmp_eq_u32 s47, 0
    s_cselect_b32 s92, s92, 1073741824
    v_lshlrev_b32 v167, 4, v167
    v_mov_b32 v191, s44
    s_waitcnt lgkmcnt(0)
    v_add_f32 v170, v170, v174
    v_add_f32 v178, v178, v182
    v_add_f32 v171, v171, v175
    v_add_f32 v179, v179, v183
    v_add_f32 v172, v172, v176
    v_add_f32 v180, v180, v184
    v_add_f32 v188, v170, v178
    v_add_f32 v189, v171, v179
    v_add_f32 v190, v172, v180
    v_mov_b32 v168, 1073741824
    v_cmp_lt_u32 vcc, 21, v2
    s_nop 1
    v_cndmask_b32 v167, v167, v168, vcc
    ds_read_b64_tr_b16 v[176:177], v37 offset:0
    ds_read_b64_tr_b16 v[178:179], v37 offset:2048
    ds_read_b64_tr_b16 v[180:181], v37 offset:8
    ds_read_b64_tr_b16 v[182:183], v37 offset:2056
    ds_read_b64_tr_b16 v[184:185], v37 offset:16
    ds_read_b64_tr_b16 v[186:187], v37 offset:2064
    ds_read_b64_tr_b16 v[192:193], v38
    ds_read_b64_tr_b16 v[194:195], v38 offset:1024
    ds_read_b64_tr_b16 v[196:197], v39
    ds_read_b64_tr_b16 v[198:199], v39 offset:1024
L_vp_9:
    buffer_load_dword v63, v14, s[4:7], s58 offen sc1
    s_waitcnt vmcnt(0)
    v_cmp_ne_u32 vcc, s44, v63
    s_nop 0
    s_cmp_eq_u64 vcc, 0
    s_cbranch_scc1 L_vpd_10
    s_sub_u32 s100, s100, 1
    s_cbranch_scc0 L_vp_9
    s_mov_b32 s100, 0
L_vpd_10:
    buffer_load_dwordx4 a[0:3], v1, s[4:7], s61 offen offset:0 sc1
    buffer_load_dwordx4 a[4:7], v1, s[4:7], s61 offen offset:1024 sc1
    buffer_load_dwordx4 a[8:11], v1, s[4:7], s61 offen offset:2048 sc1
    buffer_load_dwordx4 a[12:15], v1, s[4:7], s61 offen offset:3072 sc1
    s_add_u32 s61, s61, 4096
    buffer_load_dwordx4 a[16:19], v1, s[4:7], s61 offen offset:0 sc1
    buffer_load_dwordx4 a[20:23], v1, s[4:7], s61 offen offset:1024 sc1
    buffer_load_dwordx4 a[24:27], v1, s[4:7], s61 offen offset:2048 sc1
    buffer_load_dwordx4 a[28:31], v1, s[4:7], s61 offen offset:3072 sc1
    s_add_u32 s61, s61, 4096
    s_waitcnt lgkmcnt(0)
    s_barrier
    ds_read_b128 v[128:131], v1 offset:0
    ds_read_b128 v[132:135], v1 offset:1024
    ds_read_b128 v[136:139], v1 offset:2048
    ds_read_b128 v[140:143], v1 offset:3072
    ds_read_b128 v[144:147], v1 offset:4096
    ds_read_b128 v[148:151], v1 offset:5120
    s_waitcnt vmcnt(7) lgkmcnt(3)
    v_mfma_f32_32x32x16_bf16 v[64:79], v[128:131], a[0:3], 0
    ds_read_b128 v[152:155], v1 offset:6144
    buffer_load_dwordx4 a[32:35], v1, s[4:7], s61 offen offset:0 sc1
    v_and_b32 v4, 31, v2
    v_mfma_f32_32x32x16_bf16 v[80:95], v[132:135], a[0:3], 0
    ds_read_b128 v[156:159], v1 offset:7168
    v_lshrrev_b32 v12, 5, v2
    v_lshrrev_b32 v13, 4, v2
    v_and_b32 v11, 15, v2
    s_mul_i32 s81, s47, 10240
    v_mfma_f32_32x32x16_bf16 v[96:111], v[136:139], a[0:3], 0
    ds_read_b128 v[160:163], v1 offset:8192
    s_mul_i32 s55, s51, 0xa000
    s_add_u32 s80, s81, s55
    s_add_u32 s80, s80, 6291456
    v_lshlrev_b32 v16, 14, v12
    s_waitcnt vmcnt(7) lgkmcnt(3)
    v_mfma_f32_32x32x16_bf16 v[64:79], v[140:143], a[4:7], v[64:79]
    ds_read_b128 v[128:131], v1 offset:9216
    buffer_load_dwordx4 a[36:39], v1, s[4:7], s61 offen offset:1024 sc1
    v_lshl_add_u32 v16, v4, 7, v16
    v_mfma_f32_32x32x16_bf16 v[80:95], v[144:147], a[4:7], v[80:95]
    ds_read_b128 v[132:135], v1 offset:10240
    s_lshl_b32 s55, s47, 12
    s_add_u32 s55, s55, 40960
    v_add_u32 v16, s55, v16
    v_bfe_u32 v14, v2, 1, 1
    v_mfma_f32_32x32x16_bf16 v[96:111], v[148:151], a[4:7], v[96:111]
    ds_read_b128 v[136:139], v1 offset:11264
    buffer_load_dwordx4 a[40:43], v1, s[4:7], s61 offen offset:2048 sc1
    v_bfe_u32 v15, v2, 2, 1
    s_waitcnt vmcnt(8) lgkmcnt(3)
    v_mfma_f32_32x32x16_bf16 v[64:79], v[152:155], a[8:11], v[64:79]
    ds_read_b128 v[140:143], v1 offset:12288
    buffer_load_dwordx4 a[44:47], v1, s[4:7], s61 offen offset:3072 sc1
    s_add_u32 s61, s61, 4096
    v_lshl_add_u32 v15, v14, 1, v15
    v_mfma_f32_32x32x16_bf16 v[80:95], v[156:159], a[8:11], v[80:95]
    ds_read_b128 v[144:147], v1 offset:13312
    v_and_b32 v21, 1, v2
    v_lshl_add_u32 v15, v15, 1, v21
    v_lshl_add_u32 v16, v15, 4, v16
    v_bfe_u32 v15, v2, 2, 2
    v_mfma_f32_32x32x16_bf16 v[96:111], v[160:163], a[8:11], v[96:111]
    ds_read_b128 v[148:151], v1 offset:14336
    buffer_load_dwordx4 a[48:51], v1, s[4:7], s61 offen offset:0 sc1
    v_lshl_add_u32 v20, v12, 3, v15
    s_waitcnt vmcnt(9) lgkmcnt(3)
    v_mfma_f32_32x32x16_bf16 v[64:79], v[128:131], a[12:15], v[64:79]
    ds_read_b128 v[152:155], v1 offset:15360
    buffer_load_dwordx4 a[52:55], v1, s[4:7], s61 offen offset:1024 sc1
    v_lshlrev_b32 v20, 7, v20
    v_mfma_f32_32x32x16_bf16 v[80:95], v[132:135], a[12:15], v[80:95]
    ds_read_b128 v[156:159], v1 offset:16384
    s_lshr_b32 s55, s47, 1
    s_lshl_b32 s55, s55, 14
    s_add_u32 s55, s55, 40960
    v_add_u32 v20, s55, v20
    v_mfma_f32_32x32x16_bf16 v[96:111], v[136:139], a[12:15], v[96:111]
    ds_read_b128 v[160:163], v1 offset:17408
    buffer_load_dwordx4 a[56:59], v1, s[4:7], s61 offen offset:2048 sc1
    v_lshrrev_b32 v26, 1, v15
    s_waitcnt vmcnt(10) lgkmcnt(3)
    v_mfma_f32_32x32x16_bf16 v[64:79], v[140:143], a[16:19], v[64:79]
    ds_read_b128 v[128:131], v1 offset:18432
    buffer_load_dwordx4 a[60:63], v1, s[4:7], s61 offen offset:3072 sc1
    s_add_u32 s61, s61, 4096
    v_and_b32 v15, 1, v15
    v_mfma_f32_32x32x16_bf16 v[80:95], v[144:147], a[16:19], v[80:95]
    ds_read_b128 v[132:135], v1 offset:19456
    v_lshl_add_u32 v26, v26, 2, v15
    v_bfe_u32 v15, v2, 4, 1
    v_lshl_add_u32 v17, v15, 1, v21
    s_and_b32 s56, s47, 1
    v_mfma_f32_32x32x16_bf16 v[96:111], v[148:151], a[16:19], v[96:111]
    ds_read_b128 v[136:139], v1 offset:20480
    s_lshl_b32 s57, s56, 2
    v_add_u32 v17, s57, v17
    v_xor_b32 v17, v17, v26
    v_lshlrev_b32 v17, 4, v17
    s_waitcnt vmcnt(10) lgkmcnt(3)
    v_mfma_f32_32x32x16_bf16 v[64:79], v[152:155], a[20:23], v[64:79]
    ds_read_b128 v[140:143], v1 offset:21504
    buffer_load_dwordx4 a[64:67], v1, s[4:7], s61 offen offset:0 sc1
    v_lshl_add_u32 v17, v14, 3, v17
    v_mfma_f32_32x32x16_bf16 v[80:95], v[156:159], a[20:23], v[80:95]
    ds_read_b128 v[144:147], v1 offset:22528
    v_xor_b32 v18, 32, v17
    v_add_u32 v17, v17, v20
    s_mov_b32 s57, 512
    v_add3_u32 v18, v18, v20, s57
    v_mfma_f32_32x32x16_bf16 v[96:111], v[160:163], a[20:23], v[96:111]
    ds_read_b128 v[148:151], v1 offset:23552
    buffer_load_dwordx4 a[68:71], v1, s[4:7], s61 offen offset:1024 sc1
    v_lshl_add_u32 v19, v15, 1, v14
    s_waitcnt vmcnt(11) lgkmcnt(3)
    v_mfma_f32_32x32x16_bf16 v[64:79], v[128:131], a[24:27], v[64:79]
    ds_read_b128 v[152:155], v1 offset:24576
    buffer_load_dwordx4 a[72:75], v1, s[4:7], s61 offen offset:2048 sc1
    v_add_u32 v19, 5, v19
    v_mfma_f32_32x32x16_bf16 v[80:95], v[132:135], a[24:27], v[80:95]
    ds_read_b128 v[156:159], v1 offset:25600
    v_min_u32 v19, 7, v19
    v_xor_b32 v19, v19, v26
    v_lshlrev_b32 v19, 4, v19
    v_lshl_add_u32 v19, v21, 3, v19
    v_mfma_f32_32x32x16_bf16 v[96:111], v[136:139], a[24:27], v[96:111]
    ds_read_b128 v[160:163], v1 offset:26624
    buffer_load_dwordx4 a[76:79], v1, s[4:7], s61 offen offset:3072 sc1
    s_add_u32 s61, s61, 4096
    v_xor_b32 v26, 32, v19
    s_waitcnt vmcnt(12) lgkmcnt(3)
    v_mfma_f32_32x32x16_bf16 v[64:79], v[140:143], a[28:31], v[64:79]
    ds_read_b128 v[128:131], v1 offset:27648
    buffer_load_dwordx4 a[80:83], v1, s[4:7], s61 offen offset:0 sc1
    v_add_u32 v19, v19, v20
    v_mfma_f32_32x32x16_bf16 v[80:95], v[144:147], a[28:31], v[80:95]
    ds_read_b128 v[132:135], v1 offset:28672
    v_add3_u32 v20, v26, v20, s57
    s_lshl_b32 s57, s56, 5
    v_and_b32 v15, s57, v2
    v_add_u32 v15, v4, v15
    v_mfma_f32_32x32x16_bf16 v[96:111], v[148:151], a[28:31], v[96:111]
    ds_read_b128 v[136:139], v1 offset:29696
    buffer_load_dwordx4 a[84:87], v1, s[4:7], s61 offen offset:1024 sc1
    v_mov_b32 v26, 1073741824
    s_waitcnt vmcnt(13) lgkmcnt(3)
    v_mfma_f32_32x32x16_bf16 v[64:79], v[152:155], a[32:35], v[64:79]
    s_mov_b32 m0, s63
    ds_read_b128 v[140:143], v1 offset:30720
    buffer_load_dwordx4 v1, s[4:7], s62 offen offset:0 sc1 lds
    v_cmp_lt_u32 vcc, 20, v15
    s_nop 1
    v_cndmask_b32 v21, v1, v26, vcc
    v_mfma_f32_32x32x16_bf16 v[80:95], v[156:159], a[32:35], v[80:95]
    ds_read_b128 v[144:147], v1 offset:31744
    s_lshl_b32 s55, s51, 4
    s_add_u32 s55, s55, s50
    s_mul_i32 s55, s55, 5120
    s_lshr_b32 s57, s47, 1
    v_mfma_f32_32x32x16_bf16 v[96:111], v[160:163], a[32:35], v[96:111]
    ds_read_b128 v[148:151], v1 offset:32768
    s_mul_i32 s57, s57, 2560
    s_add_u32 s55, s55, s57
    s_lshl_b32 s57, s56, 11
    s_add_u32 s55, s55, s57
    s_waitcnt vmcnt(13) lgkmcnt(3)
    v_mfma_f32_32x32x16_bf16 v[64:79], v[128:131], a[36:39], v[64:79]
    ds_read_b128 v[152:155], v1 offset:33792
    buffer_load_dwordx4 v1, s[4:7], s62 offen offset:1024 sc1 lds
    s_add_u32 s87, s55, 11534336
    v_mfma_f32_32x32x16_bf16 v[80:95], v[132:135], a[36:39], v[80:95]
    ds_read_b128 v[156:159], v1 offset:34816
    s_cmp_eq_u32 s56, 0
    s_cselect_b32 s88, s87, 1073741824
    s_lshl_b32 s60, s51, 7
    s_add_u32 s60, s60, 10240
    v_mfma_f32_32x32x16_bf16 v[96:111], v[136:139], a[36:39], v[96:111]
    ds_read_b128 v[160:163], v1 offset:35840
    buffer_load_dwordx4 v1, s[4:7], s62 offen offset:2048 sc1 lds
    s_add_u32 s62, s62, 12288
    s_add_u32 s63, s63, 12288
    s_lshl_b32 s58, s50, 2
    s_waitcnt vmcnt(14) lgkmcnt(3)
    v_mfma_f32_32x32x16_bf16 v[64:79], v[140:143], a[40:43], v[64:79]
    s_mov_b32 m0, s63
    ds_read_b128 v[128:131], v1 offset:36864
    buffer_load_dwordx4 v1, s[4:7], s62 offen offset:0 sc1 lds
    s_add_u32 s59, s60, s58
    v_mfma_f32_32x32x16_bf16 v[80:95], v[144:147], a[40:43], v[80:95]
    ds_read_b128 v[132:135], v1 offset:37888
    s_cmp_eq_u32 s47, 0
    s_cselect_b32 s59, s59, 1073741824
    v_mul_u32_u24 v31, 3121, v0
    v_lshrrev_b32 v31, 16, v31
    v_mfma_f32_32x32x16_bf16 v[96:111], v[148:151], a[40:43], v[96:111]
    ds_read_b128 v[136:139], v1 offset:38912
    buffer_load_dwordx4 v1, s[4:7], s62 offen offset:1024 sc1 lds
    v_mul_u32_u24 v32, 21, v31
    s_waitcnt vmcnt(15) lgkmcnt(3)
    v_mfma_f32_32x32x16_bf16 v[64:79], v[152:155], a[44:47], v[64:79]
    ds_read_b128 v[140:143], v1 offset:39936
    buffer_load_dwordx4 v1, s[4:7], s62 offen offset:2048 sc1 lds
    s_add_u32 s62, s62, 12288
    s_add_u32 s63, s63, 12288
    v_sub_u32 v32, v0, v32
    v_mfma_f32_32x32x16_bf16 v[80:95], v[156:159], a[44:47], v[80:95]
    ds_read_b128 v[144:147], v1 offset:40960
    v_lshlrev_b32 v32, 4, v32
    v_mul_u32_u24 v15, 384, v31
    v_lshl_add_u32 v31, v31, 9, v32
    s_mov_b32 s57, 156672
    v_mfma_f32_32x32x16_bf16 v[96:111], v[160:163], a[44:47], v[96:111]
    s_mov_b32 m0, s63
    ds_read_b128 v[148:151], v1 offset:41984
    buffer_load_dwordx4 v1, s[4:7], s62 offen offset:0 sc1 lds
    v_add3_u32 v32, v15, v32, s57
    s_waitcnt vmcnt(16) lgkmcnt(3)
    v_mfma_f32_32x32x16_bf16 v[64:79], v[128:131], a[48:51], v[64:79]
    ds_read_b128 v[152:155], v1 offset:43008
    buffer_load_dwordx4 v1, s[4:7], s62 offen offset:1024 sc1 lds
    v_mov_b32 v15, 162816
    v_mfma_f32_32x32x16_bf16 v[80:95], v[132:135], a[48:51], v[80:95]
    ds_read_b128 v[156:159], v1 offset:44032
    v_cmp_gt_u32 vcc, 210, v0
    s_nop 1
    v_cndmask_b32 v31, v26, v31, vcc
    v_cndmask_b32 v32, v15, v32, vcc
    v_bfe_u32 v14, v2, 3, 2
    v_mfma_f32_32x32x16_bf16 v[96:111], v[136:139], a[48:51], v[96:111]
    ds_read_b128 v[160:163], v1 offset:45056
    v_and_b32 v15, 3, v2
    v_lshl_add_u32 v14, v14, 2, v15
    v_bfe_u32 v15, v2, 2, 1
    v_mul_u32_u24 v33, 1920, v15
    s_waitcnt vmcnt(16) lgkmcnt(3)
    v_mfma_f32_32x32x16_bf16 v[64:79], v[140:143], a[52:55], v[64:79]
    ds_read_b128 v[128:131], v1 offset:46080
    buffer_load_dwordx4 v1, s[4:7], s62 offen offset:2048 sc1 lds
    s_add_u32 s62, s62, 12288
    s_add_u32 s63, s63, 12288
    v_lshl_add_u32 v33, v14, 4, v33
    v_mfma_f32_32x32x16_bf16 v[80:95], v[144:147], a[52:55], v[80:95]
    ds_read_b128 v[132:135], v1 offset:47104
    v_add_u32 v33, 156672, v33
    v_mov_b32 v26, 160768
    v_cmp_eq_u32 vcc, v15, v12
    s_nop 1
    v_cndmask_b32 v33, v26, v33, vcc
    v_mfma_f32_32x32x16_bf16 v[96:111], v[148:151], a[52:55], v[96:111]
    ds_read_b128 v[136:139], v1 offset:48128
    buffer_load_dwordx4 a[88:91], v1, s[4:7], s61 offen offset:2048 sc1
    v_add_u32 v34, 256, v33
    s_waitcnt vmcnt(17) lgkmcnt(3)
    v_mfma_f32_32x32x16_bf16 v[64:79], v[152:155], a[56:59], v[64:79]
    ds_read_b128 v[140:143], v1 offset:49152
    buffer_load_dwordx4 a[92:95], v1, s[4:7], s61 offen offset:3072 sc1
    s_add_u32 s61, s61, 4096
    v_cmp_ge_u32 vcc, 4, v14
    s_nop 1
    v_cndmask_b32 v34, v26, v34, vcc
    v_mfma_f32_32x32x16_bf16 v[80:95], v[156:159], a[56:59], v[80:95]
    ds_read_b128 v[144:147], v1 offset:50176
    v_bfe_u32 v29, v2, 4, 1
    v_mul_u32_u24 v29, 20480, v29
    v_lshl_add_u32 v29, v11, 4, v29
    v_lshl_add_u32 v30, v12, 3, v29
    v_mfma_f32_32x32x16_bf16 v[96:111], v[160:163], a[56:59], v[96:111]
    ds_read_b128 v[148:151], v1 offset:51200
    buffer_load_dwordx4 a[96:99], v1, s[4:7], s61 offen offset:0 sc1
    v_lshl_add_u32 v29, v12, 9, v29
    s_waitcnt vmcnt(18) lgkmcnt(3)
    v_mfma_f32_32x32x16_bf16 v[64:79], v[128:131], a[60:63], v[64:79]
    ds_read_b128 v[152:155], v1 offset:52224
    buffer_load_dwordx4 a[100:103], v1, s[4:7], s61 offen offset:1024 sc1
    s_and_b32 s55, s50, 1
    v_mfma_f32_32x32x16_bf16 v[80:95], v[132:135], a[60:63], v[80:95]
    ds_read_b128 v[156:159], v1 offset:53248
    s_lshl_b32 s55, s55, 2
    s_add_u32 s55, s55, s47
    s_mul_i32 s55, s55, 40960
    s_mul_i32 s56, s51, 1280
    v_mfma_f32_32x32x16_bf16 v[96:111], v[136:139], a[60:63], v[96:111]
    ds_read_b128 v[160:163], v1 offset:54272
    buffer_load_dwordx4 a[104:107], v1, s[4:7], s61 offen offset:2048 sc1
    s_add_u32 s55, s55, s56
    s_waitcnt vmcnt(19) lgkmcnt(3)
    v_mfma_f32_32x32x16_bf16 v[64:79], v[140:143], a[64:67], v[64:79]
    ds_read_b128 v[128:131], v1 offset:55296
    buffer_load_dwordx4 a[108:111], v1, s[4:7], s61 offen offset:3072 sc1
    s_add_u32 s61, s61, 4096
    s_mul_i32 s56, s48, 393216
    v_mfma_f32_32x32x16_bf16 v[80:95], v[144:147], a[64:67], v[80:95]
    ds_read_b128 v[132:135], v1 offset:56320
    s_add_u32 s55, s55, s56
    s_add_u32 s89, s55, 13631488
    v_xor_b32 v26, v4, v12
    v_lshlrev_b32 v26, 4, v26
    v_mfma_f32_32x32x16_bf16 v[96:111], v[148:151], a[64:67], v[96:111]
    ds_read_b128 v[136:139], v1 offset:57344
    v_lshl_add_u32 v26, v12, 12, v26
    v_min_u32 v41, 19, v2
    v_lshlrev_b32 v41, 2, v41
    s_lshl_b32 s90, s53, 7
    s_waitcnt vmcnt(19) lgkmcnt(3)
    v_mfma_f32_32x32x16_bf16 v[64:79], v[152:155], a[68:71], v[64:79]
    ds_read_b128 v[140:143], v1 offset:58368
    buffer_load_dwordx4 a[112:115], v1, s[4:7], s61 offen offset:0 sc1
    s_add_u32 s90, s90, 7168
    v_mfma_f32_32x32x16_bf16 v[80:95], v[156:159], a[68:71], v[80:95]
    ds_read_b128 v[144:147], v1 offset:59392
    s_lshl_b32 s55, s52, 18
    s_lshl_b32 s56, s53, 9
    s_add_u32 s55, s55, s56
    s_lshl_b32 s56, s47, 16
    v_mfma_f32_32x32x16_bf16 v[96:111], v[160:163], a[68:71], v[96:111]
    ds_read_b128 v[148:151], v1 offset:60416
    buffer_load_dwordx4 a[116:119], v1, s[4:7], s61 offen offset:1024 sc1
    s_add_u32 s82, s55, s56
    s_waitcnt vmcnt(8)
    s_barrier
    s_waitcnt lgkmcnt(3)
    v_mfma_f32_32x32x16_bf16 v[64:79], v[128:131], a[72:75], v[64:79]
    ds_read_b128 v[152:155], v1 offset:61440
    buffer_load_dwordx4 a[120:123], v1, s[4:7], s61 offen offset:2048 sc1
    s_lshl_b32 s56, s47, 13
    v_mfma_f32_32x32x16_bf16 v[80:95], v[132:135], a[72:75], v[80:95]
    ds_read_b128 v[156:159], v1 offset:62464
    s_add_u32 s83, s56, 118784
    s_mov_b32 s12, s28
    s_mov_b32 s13, s29
    s_mov_b32 s14, 8388608
    v_mfma_f32_32x32x16_bf16 v[96:111], v[136:139], a[72:75], v[96:111]
    ds_read_b128 v[160:163], v1 offset:63488
    buffer_load_dwordx4 a[124:127], v1, s[4:7], s61 offen offset:3072 sc1
    s_add_u32 s61, s61, 4096
    s_mov_b32 s15, s96
    s_waitcnt lgkmcnt(3)
    v_mfma_f32_32x32x16_bf16 v[64:79], v[140:143], a[76:79], v[64:79]
    ds_read_b128 v[128:131], v1 offset:64512
    buffer_load_dwordx4 a[128:131], v1, s[4:7], s61 offen offset:0 sc1
    s_mul_i32 s85, s53, 0x19000
    v_mfma_f32_32x32x16_bf16 v[80:95], v[144:147], a[76:79], v[80:95]
    ds_read_b128 v[132:135], v5 offset:0
    s_add_u32 s85, s85, 7340032
    v_lshlrev_b32 v9, 5, v13
    v_lshlrev_b32 v10, 3, v13
    v_add_u32 v10, 128, v10
    v_mfma_f32_32x32x16_bf16 v[96:111], v[148:151], a[76:79], v[96:111]
    ds_read_b128 v[136:139], v5 offset:1024
    buffer_load_dwordx4 a[132:135], v1, s[4:7], s61 offen offset:1024 sc1
    v_mul_u32_u24 v8, 1280, v11
    s_waitcnt lgkmcnt(3)
    v_mfma_f32_32x32x16_bf16 v[64:79], v[152:155], a[80:83], v[64:79]
    s_mov_b32 m0, s63
    ds_read_b128 v[140:143], v5 offset:2048
    buffer_load_dwordx4 v1, s[4:7], s62 offen offset:0 sc1 lds
    v_add_u32 v7, v8, v9
    v_mfma_f32_32x32x16_bf16 v[80:95], v[156:159], a[80:83], v[80:95]
    ds_read_b128 v[144:147], v5 offset:3072
    v_add_u32 v8, v8, v10
    s_and_b32 s55, s53, 3
    s_lshl_b32 s55, s55, 5
    v_add_u32 v9, s55, v9
    v_mfma_f32_32x32x16_bf16 v[96:111], v[160:163], a[80:83], v[96:111]
    ds_read_b128 v[148:151], v5 offset:4096
    v_lshrrev_b32 v15, 7, v9
    v_lshl_add_u32 v9, v15, 4, v9
    v_add_u32 v9, 153600, v9
    s_add_u32 s55, s55, 153616
    s_waitcnt lgkmcnt(3)
    v_mfma_f32_32x32x16_bf16 v[64:79], v[128:131], a[84:87], v[64:79]
    ds_read_b128 v[152:155], v5 offset:5120
    buffer_load_dwordx4 v1, s[4:7], s62 offen offset:1024 sc1 lds
    v_add_u32 v10, s55, v10
    v_mfma_f32_32x32x16_bf16 v[80:95], v[132:135], a[84:87], v[80:95]
    ds_read_b128 v[156:159], v5 offset:6144
    v_lshlrev_b32 v45, 4, v11
    v_lshl_add_u32 v43, v13, 9, v45
    v_lshrrev_b32 v44, 1, v13
    v_lshl_add_u32 v44, v44, 8, v45
    v_mfma_f32_32x32x16_bf16 v[96:111], v[136:139], a[84:87], v[96:111]
    ds_read_b128 v[160:163], v5 offset:7168
    buffer_load_dwordx4 v1, s[4:7], s62 offen offset:2048 sc1 lds
    s_add_u32 s62, s62, 12288
    s_add_u32 s63, s63, 12288
    v_and_b32 v15, 1, v13
    s_waitcnt vmcnt(14) lgkmcnt(3)
    v_mfma_f32_32x32x16_bf16 v[64:79], v[140:143], a[88:91], v[64:79]
    s_mov_b32 m0, s63
    ds_read_b128 v[128:131], v5 offset:8192
    buffer_load_dwordx4 v1, s[4:7], s62 offen offset:0 sc1 lds
    v_lshl_add_u32 v44, v15, 3, v44
    v_mfma_f32_32x32x16_bf16 v[80:95], v[144:147], a[88:91], v[80:95]
    ds_read_b128 v[132:135], v5 offset:9216
    v_lshl_add_u32 v46, v13, 10, v45
    v_min_u32 v14, 175, v0
    v_mul_u32_u24 v15, 2979, v14
    v_lshrrev_b32 v15, 16, v15
    v_mfma_f32_32x32x16_bf16 v[96:111], v[148:151], a[88:91], v[96:111]
    ds_read_b128 v[136:139], v5 offset:10240
    buffer_load_dwordx4 v1, s[4:7], s62 offen offset:1024 sc1 lds
    v_mul_u32_u24 v48, 22, v15
    s_waitcnt vmcnt(15) lgkmcnt(3)
    v_mfma_f32_32x32x16_bf16 v[64:79], v[152:155], a[92:95], v[64:79]
    ds_read_b128 v[140:143], v5 offset:11264
    buffer_load_dwordx4 v1, s[4:7], s62 offen offset:2048 sc1 lds
    s_add_u32 s62, s62, 12288
    s_add_u32 s63, s63, 12288
    v_sub_u32 v48, v14, v48
    v_mfma_f32_32x32x16_bf16 v[80:95], v[156:159], a[92:95], v[80:95]
    ds_read_b128 v[144:147], v5 offset:12288
    v_lshrrev_b32 v14, 1, v15
    v_cmp_eq_u32 vcc, 2, v14
    s_nop 1
    v_cndmask_b32 v49, 0, 1.0, vcc
    v_mul_u32_u24 v14, 10, v14
    v_mfma_f32_32x32x16_bf16 v[96:111], v[160:163], a[92:95], v[96:111]
    ds_read_b128 v[148:151], v5 offset:13312
    buffer_load_dwordx4 a[136:139], v1, s[4:7], s61 offen offset:2048 sc1
    v_and_b32 v47, 1, v15
    s_waitcnt vmcnt(16) lgkmcnt(3)
    v_mfma_f32_32x32x16_bf16 v[64:79], v[128:131], a[96:99], v[64:79]
    ds_read_b128 v[152:155], v5 offset:14336
    buffer_load_dwordx4 a[140:143], v1, s[4:7], s61 offen offset:3072 sc1
    s_add_u32 s61, s61, 4096
    s_mul_i32 s55, s53, 5
    v_mfma_f32_32x32x16_bf16 v[80:95], v[132:135], a[96:99], v[80:95]
    ds_read_b128 v[156:159], v5 offset:15360
    s_lshr_b32 s55, s55, 2
    v_add3_u32 v47, v47, v14, s55
    v_mul_u32_u24 v47, 1920, v47
    v_lshl_add_u32 v47, v48, 4, v47
    v_mfma_f32_32x32x16_bf16 v[96:111], v[136:139], a[96:99], v[96:111]
    ds_read_b128 v[160:163], v5 offset:16384
    v_mul_u32_u24 v15, 144, v15
    v_mul_u32_u24 v48, 6, v48
    s_mov_b32 s55, 153600
    v_add3_u32 v48, v15, v48, s55
    s_waitcnt vmcnt(16) lgkmcnt(3)
    v_mfma_f32_32x32x16_bf16 v[64:79], v[140:143], a[100:103], v[64:79]
    ds_read_b128 v[128:131], v5 offset:17408
    buffer_load_dwordx4 a[144:147], v1, s[4:7], s61 offen offset:0 sc1
    v_and_b32 v14, 31, v2
    v_mfma_f32_32x32x16_bf16 v[80:95], v[144:147], a[100:103], v[80:95]
    ds_read_b128 v[132:135], v5 offset:18432
    v_min_u32 v14, 19, v14
    v_min_u32 v15, 55, v2
    v_cmp_gt_u32 vcc, 32, v2
    s_nop 1
    v_cndmask_b32 v14, v15, v14, vcc
    v_mfma_f32_32x32x16_bf16 v[96:111], v[148:151], a[100:103], v[96:111]
    ds_read_b128 v[136:139], v5 offset:19456
    buffer_load_dwordx4 a[148:151], v1, s[4:7], s61 offen offset:1024 sc1
    v_lshlrev_b32 v14, 2, v14
    s_waitcnt vmcnt(17) lgkmcnt(3)
    v_mfma_f32_32x32x16_bf16 v[64:79], v[152:155], a[104:107], v[64:79]
    ds_read_b128 v[140:143], v5 offset:20480
    buffer_load_dwordx4 a[152:155], v1, s[4:7], s61 offen offset:2048 sc1
    s_lshl_b32 s55, s53, 7
    v_mfma_f32_32x32x16_bf16 v[80:95], v[156:159], a[104:107], v[80:95]
    ds_read_b128 v[144:147], v5 offset:21504
    s_add_u32 s56, s55, 8192
    s_add_u32 s55, s55, 9088
    v_mov_b32 v52, s56
    v_mov_b32 v15, s55
    v_mfma_f32_32x32x16_bf16 v[96:111], v[160:163], a[104:107], v[96:111]
    ds_read_b128 v[148:151], v5 offset:22528
    buffer_load_dwordx4 a[156:159], v1, s[4:7], s61 offen offset:3072 sc1
    s_add_u32 s61, s61, 4096
    v_cndmask_b32 v52, v15, v52, vcc
    s_waitcnt vmcnt(18) lgkmcnt(3)
    v_mfma_f32_32x32x16_bf16 v[64:79], v[128:131], a[108:111], v[64:79]
    ds_read_b128 v[152:155], v5 offset:23552
    buffer_store_dwordx4 v[188:191], v167, s[4:7], s92 offen sc1
    v_add_u32 v52, v52, v14
    v_mfma_f32_32x32x16_bf16 v[80:95], v[132:135], a[108:111], v[80:95]
    ds_read_b128 v[156:159], v5 offset:24576
    v_lshlrev_b32 v53, 2, v11
    v_and_b32 v14, 1, v2
    v_lshlrev_b32 v14, 4, v14
    v_mov_b32 v15, 0x3f80
    v_lshlrev_b32 v14, v14, v15
    v_mfma_f32_32x32x16_bf16 v[96:111], v[136:139], a[108:111], v[96:111]
    ds_read_b128 v[160:163], v5 offset:25600
    buffer_store_dwordx4 v[176:179], v1, s[4:7], s91 offen offset:0 sc1
    v_bfe_u32 v35, v2, 3, 2
    s_waitcnt vmcnt(19) lgkmcnt(3)
    v_mfma_f32_32x32x16_bf16 v[64:79], v[140:143], a[112:115], v[64:79]
    ds_read_b128 v[128:131], v5 offset:26624
    buffer_store_dwordx4 v[180:183], v1, s[4:7], s91 offen offset:1024 sc1
    v_cmp_eq_u32 vcc, v35, v12
    s_nop 1
    v_cndmask_b32 v14, 0, v14, vcc
    v_mfma_f32_32x32x16_bf16 v[80:95], v[144:147], a[112:115], v[80:95]
    ds_read_b128 v[132:135], v5 offset:27648
    v_bfe_u32 v35, v2, 1, 2
    v_cmp_eq_u32 vcc, 0, v35
    s_nop 1
    v_cndmask_b32 v36, 0, v14, vcc
    v_cmp_eq_u32 vcc, 1, v35
    s_nop 1
    v_cndmask_b32 v37, 0, v14, vcc
    v_mfma_f32_32x32x16_bf16 v[96:111], v[148:151], a[112:115], v[96:111]
    ds_read_b128 v[136:139], v5 offset:28672
    v_cmp_eq_u32 vcc, 2, v35
    s_nop 1
    v_cndmask_b32 v38, 0, v14, vcc
    v_cmp_eq_u32 vcc, 3, v35
    s_nop 1
    v_cndmask_b32 v39, 0, v14, vcc
    s_waitcnt vmcnt(19) lgkmcnt(3)
    v_mfma_f32_32x32x16_bf16 v[64:79], v[152:155], a[116:119], v[64:79]
    ds_read_b128 v[140:143], v5 offset:29696
    buffer_store_dwordx4 v[184:187], v1, s[4:7], s91 offen offset:2048 sc1
    v_mfma_f32_32x32x16_bf16 v[80:95], v[156:159], a[116:119], v[80:95]
    ds_read_b128 v[144:147], v5 offset:30720
    v_mfma_f32_32x32x16_bf16 v[96:111], v[160:163], a[116:119], v[96:111]
    ds_read_b128 v[148:151], v5 offset:31744
    buffer_store_dwordx4 v[192:195], v1, s[4:7], s93 offen sc1
    s_waitcnt vmcnt(11)
    s_barrier
    s_waitcnt lgkmcnt(3)
    v_mfma_f32_32x32x16_bf16 v[64:79], v[128:131], a[120:123], v[64:79]
    ds_read_b128 v[152:155], v5 offset:32768
    buffer_store_dwordx4 v[196:199], v1, s[4:7], s86 offen sc1
    v_mfma_f32_32x32x16_bf16 v[80:95], v[132:135], a[120:123], v[80:95]
    ds_read_b128 v[156:159], v5 offset:33792
    v_mfma_f32_32x32x16_bf16 v[96:111], v[136:139], a[120:123], v[96:111]
    ds_read_b128 v[160:163], v5 offset:34816
    buffer_load_dword v42, v41, s[4:7], s90 offen sc1
    s_waitcnt lgkmcnt(3)
    v_mfma_f32_32x32x16_bf16 v[64:79], v[140:143], a[124:127], v[64:79]
    ds_read_b128 v[128:131], v5 offset:35840
    v_mfma_f32_32x32x16_bf16 v[80:95], v[144:147], a[124:127], v[80:95]
    ds_read_b128 v[132:135], v5 offset:36864
    v_mfma_f32_32x32x16_bf16 v[96:111], v[148:151], a[124:127], v[96:111]
    ds_read_b128 v[136:139], v5 offset:37888
    s_waitcnt lgkmcnt(3)
    v_mfma_f32_32x32x16_bf16 v[64:79], v[152:155], a[128:131], v[64:79]
    ds_read_b128 v[140:143], v5 offset:38912
    v_mfma_f32_32x32x16_bf16 v[80:95], v[156:159], a[128:131], v[80:95]
    ds_read_b128 v[144:147], v5 offset:39936
    v_mfma_f32_32x32x16_bf16 v[96:111], v[160:163], a[128:131], v[96:111]
    ds_read_b128 v[148:151], v5 offset:40960
    s_waitcnt lgkmcnt(3)
    v_mfma_f32_32x32x16_bf16 v[64:79], v[128:131], a[132:135], v[64:79]
    ds_read_b128 v[152:155], v5 offset:41984
    v_mfma_f32_32x32x16_bf16 v[80:95], v[132:135], a[132:135], v[80:95]
    ds_read_b128 v[156:159], v5 offset:43008
    v_mfma_f32_32x32x16_bf16 v[96:111], v[136:139], a[132:135], v[96:111]
    ds_read_b128 v[160:163], v5 offset:44032
    s_waitcnt vmcnt(12) lgkmcnt(3)
    v_mfma_f32_32x32x16_bf16 v[64:79], v[140:143], a[136:139], v[64:79]
    ds_read_b128 v[128:131], v5 offset:45056
    v_mfma_f32_32x32x16_bf16 v[80:95], v[144:147], a[136:139], v[80:95]
    ds_read_b128 v[132:135], v5 offset:46080
    v_mfma_f32_32x32x16_bf16 v[96:111], v[148:151], a[136:139], v[96:111]
    ds_read_b128 v[136:139], v5 offset:47104
    s_waitcnt vmcnt(11) lgkmcnt(3)
    v_mfma_f32_32x32x16_bf16 v[64:79], v[152:155], a[140:143], v[64:79]
    ds_read_b128 v[140:143], v5 offset:48128
    v_mfma_f32_32x32x16_bf16 v[80:95], v[156:159], a[140:143], v[80:95]
    ds_read_b128 v[144:147], v5 offset:49152
    v_mfma_f32_32x32x16_bf16 v[96:111], v[160:163], a[140:143], v[96:111]
    ds_read_b128 v[148:151], v5 offset:50176
    s_waitcnt vmcnt(10) lgkmcnt(3)
    v_mfma_f32_32x32x16_bf16 v[64:79], v[128:131], a[144:147], v[64:79]
    ds_read_b128 v[152:155], v5 offset:51200
    v_mfma_f32_32x32x16_bf16 v[80:95], v[132:135], a[144:147], v[80:95]
    ds_read_b128 v[156:159], v5 offset:52224
    v_mfma_f32_32x32x16_bf16 v[96:111], v[136:139], a[144:147], v[96:111]
    ds_read_b128 v[160:163], v5 offset:53248
    s_waitcnt vmcnt(9) lgkmcnt(3)
    v_mfma_f32_32x32x16_bf16 v[64:79], v[140:143], a[148:151], v[64:79]
    ds_read_b128 v[128:131], v5 offset:54272
    v_mfma_f32_32x32x16_bf16 v[80:95], v[144:147], a[148:151], v[80:95]
    ds_read_b128 v[132:135], v5 offset:55296
    v_mfma_f32_32x32x16_bf16 v[96:111], v[148:151], a[148:151], v[96:111]
    ds_read_b128 v[136:139], v5 offset:56320
    s_waitcnt vmcnt(8) lgkmcnt(3)
    v_mfma_f32_32x32x16_bf16 v[64:79], v[152:155], a[152:155], v[64:79]
    v_mfma_f32_32x32x16_bf16 v[80:95], v[156:159], a[152:155], v[80:95]
    v_mfma_f32_32x32x16_bf16 v[96:111], v[160:163], a[152:155], v[96:111]
    s_waitcnt vmcnt(7) lgkmcnt(0)
    v_mfma_f32_32x32x16_bf16 v[64:79], v[128:131], a[156:159], v[64:79]
    v_mfma_f32_32x32x16_bf16 v[80:95], v[132:135], a[156:159], v[80:95]
    v_mfma_f32_32x32x16_bf16 v[96:111], v[136:139], a[156:159], v[96:111]
    s_barrier
    s_waitcnt vmcnt(0)
    v_cmp_ne_u32 vcc, s44, v42
    s_nop 0
    s_cmp_eq_u64 vcc, 0
    s_cbranch_scc1 L_cfd_12
L_cf_11:
    buffer_load_dword v42, v41, s[4:7], s90 offen sc1
    s_waitcnt vmcnt(0)
    v_cmp_ne_u32 vcc, s44, v42
    s_nop 0
    s_cmp_eq_u64 vcc, 0
    s_cbranch_scc1 L_cfd_12
    s_sleep 2
    s_sub_u32 s100, s100, 1
    s_cbranch_scc0 L_cf_11
    s_mov_b32 s100, 0
L_cfd_12:
    v_cvt_pk_bf16_f32 v164, v64, v65
    v_cvt_pk_bf16_f32 v165, v66, v67
    v_cvt_pk_bf16_f32 v166, v68, v69
    v_cvt_pk_bf16_f32 v167, v70, v71
    v_cvt_pk_bf16_f32 v168, v72, v73
    v_cvt_pk_bf16_f32 v169, v74, v75
    v_cvt_pk_bf16_f32 v170, v76, v77
    v_cvt_pk_bf16_f32 v171, v78, v79
    v_cvt_pk_bf16_f32 v172, v80, v81
    v_cvt_pk_bf16_f32 v173, v82, v83
    v_mov_b32 v174, 0
    v_mov_b32 v175, 0
    v_mfma_f32_32x32x16_bf16 v[176:191], v[232:235], v[164:167], 0
    v_cvt_pk_bf16_f32 v152, v84, v85
    v_cvt_pk_bf16_f32 v153, v86, v87
    v_cvt_pk_bf16_f32 v154, v88, v89
    v_cvt_pk_bf16_f32 v155, v90, v91
    v_mfma_f32_32x32x16_bf16 v[192:207], v[244:247], v[164:167], 0
    v_cvt_pk_bf16_f32 v156, v92, v93
    v_cvt_pk_bf16_f32 v157, v94, v95
    v_cvt_pk_bf16_f32 v158, v96, v97
    s_mov_b32 m0, s81
    v_cvt_pk_bf16_f32 v159, v98, v99
    buffer_load_dwordx4 v1, s[4:7], s80 offen offset:0 sc1 lds
    v_mfma_f32_32x32x16_bf16 v[176:191], v[236:239], v[168:171], v[176:191]
    v_cvt_pk_bf16_f32 v160, v100, v101
    v_cvt_pk_bf16_f32 v161, v102, v103
    v_mov_b32 v162, 0x3f80
    v_mov_b32 v163, 0
    v_mfma_f32_32x32x16_bf16 v[192:207], v[248:251], v[168:171], v[192:207]
    v_xor_b32 v55, 16, v16
    v_xor_b32 v56, 32, v16
    v_xor_b32 v57, 48, v16
    v_xor_b32 v58, 64, v16
    buffer_load_dwordx4 v1, s[4:7], s80 offen offset:1024 sc1 lds
    v_mfma_f32_32x32x16_bf16 v[176:191], v[240:243], v[172:175], v[176:191]
    v_xor_b32 v59, 80, v16
    v_xor_b32 v60, 96, v16
    v_xor_b32 v61, 112, v16
    v_mfma_f32_32x32x16_bf16 v[192:207], v[252:255], v[172:175], v[192:207]
    buffer_load_dwordx4 v1, s[4:7], s80 offen offset:2048 sc1 lds
    s_mov_b32 s24, 0x3fb8aa3b
    s_mov_b32 s25, s24
    s_nop 8
    v_max3_f32 v196, v176, v177, v178
    v_min3_f32 v198, v176, v177, v178
    v_max3_f32 v196, v196, v179, v180
    v_min3_f32 v198, v198, v179, v180
    buffer_load_dwordx4 v1, s[4:7], s80 offen offset:3072 sc1 lds
    v_max3_f32 v196, v196, v181, v182
    v_min3_f32 v198, v198, v181, v182
    v_max3_f32 v196, v196, v183, v184
    v_min3_f32 v198, v198, v183, v184
    v_max3_f32 v196, v196, v185, v186
    s_add_u32 s80, s80, 4096
    s_add_u32 s81, s81, 4096
    s_mov_b32 m0, s81
    v_min3_f32 v198, v198, v185, v186
    buffer_load_dwordx4 v1, s[4:7], s80 offen offset:0 sc1 lds
    v_max3_f32 v196, v196, v187, v188
    v_min3_f32 v198, v198, v187, v188
    v_max3_f32 v196, v196, v189, v190
    v_min3_f32 v198, v198, v189, v190
    v_max3_f32 v196, v196, v191, v192
    v_min3_f32 v198, v198, v191, v192
    buffer_load_dwordx4 v1, s[4:7], s80 offen offset:1024 sc1 lds
    v_max3_f32 v196, v196, v193, v194
    v_min3_f32 v198, v198, v193, v194
    v_max_f32 v196, v196, v195
    v_min_f32 v198, v198, v195
    v_mul_f32 v196, 0xbfb8aa3b, v196
    v_mul_f32 v198, 0x3fb8aa3b, v198
    v_pk_fma_f32 v[128:129], v[176:177], s[24:25], v[196:197] op_sel_hi:[1,1,0]
    v_pk_fma_f32 v[176:177], v[176:177], s[24:25], v[198:199] op_sel_hi:[1,1,0] neg_lo:[1,0,0] neg_hi:[1,0,0]
    buffer_load_dwordx4 v1, s[4:7], s80 offen offset:2048 sc1 lds
    v_pk_fma_f32 v[130:131], v[178:179], s[24:25], v[196:197] op_sel_hi:[1,1,0]
    v_pk_fma_f32 v[178:179], v[178:179], s[24:25], v[198:199] op_sel_hi:[1,1,0] neg_lo:[1,0,0] neg_hi:[1,0,0]
    v_pk_fma_f32 v[132:133], v[180:181], s[24:25], v[196:197] op_sel_hi:[1,1,0]
    v_pk_fma_f32 v[180:181], v[180:181], s[24:25], v[198:199] op_sel_hi:[1,1,0] neg_lo:[1,0,0] neg_hi:[1,0,0]
    v_pk_fma_f32 v[134:135], v[182:183], s[24:25], v[196:197] op_sel_hi:[1,1,0]
    v_pk_fma_f32 v[182:183], v[182:183], s[24:25], v[198:199] op_sel_hi:[1,1,0] neg_lo:[1,0,0] neg_hi:[1,0,0]
    v_pk_fma_f32 v[136:137], v[184:185], s[24:25], v[196:197] op_sel_hi:[1,1,0]
    v_pk_fma_f32 v[184:185], v[184:185], s[24:25], v[198:199] op_sel_hi:[1,1,0] neg_lo:[1,0,0] neg_hi:[1,0,0]
    buffer_load_dwordx4 v1, s[4:7], s80 offen offset:3072 sc1 lds
    v_pk_fma_f32 v[138:139], v[186:187], s[24:25], v[196:197] op_sel_hi:[1,1,0]
    v_pk_fma_f32 v[186:187], v[186:187], s[24:25], v[198:199] op_sel_hi:[1,1,0] neg_lo:[1,0,0] neg_hi:[1,0,0]
    v_pk_fma_f32 v[140:141], v[188:189], s[24:25], v[196:197] op_sel_hi:[1,1,0]
    v_pk_fma_f32 v[188:189], v[188:189], s[24:25], v[198:199] op_sel_hi:[1,1,0] neg_lo:[1,0,0] neg_hi:[1,0,0]
    v_pk_fma_f32 v[142:143], v[190:191], s[24:25], v[196:197] op_sel_hi:[1,1,0]
    v_pk_fma_f32 v[190:191], v[190:191], s[24:25], v[198:199] op_sel_hi:[1,1,0] neg_lo:[1,0,0] neg_hi:[1,0,0]
    v_pk_fma_f32 v[144:145], v[192:193], s[24:25], v[196:197] op_sel_hi:[1,1,0]
    s_add_u32 s80, s80, 4096
    s_add_u32 s81, s81, 4096
    s_mov_b32 m0, s81
    v_pk_fma_f32 v[192:193], v[192:193], s[24:25], v[198:199] op_sel_hi:[1,1,0] neg_lo:[1,0,0] neg_hi:[1,0,0]
    buffer_load_dwordx4 v1, s[4:7], s80 offen offset:0 sc1 lds
    v_pk_fma_f32 v[146:147], v[194:195], s[24:25], v[196:197] op_sel_hi:[1,1,0]
    v_pk_fma_f32 v[194:195], v[194:195], s[24:25], v[198:199] op_sel_hi:[1,1,0] neg_lo:[1,0,0] neg_hi:[1,0,0]
    v_exp_f32 v128, v128
    v_exp_f32 v176, v176
    buffer_load_dwordx4 v1, s[4:7], s80 offen offset:1024 sc1 lds
    v_exp_f32 v129, v129
    v_exp_f32 v177, v177
    v_exp_f32 v130, v130
    v_exp_f32 v178, v178
    v_exp_f32 v131, v131
    s_mul_i32 s81, s47, 11264
    s_add_u32 s80, s81, s85
    s_add_u32 s80, s80, 0
    s_add_u32 s81, s81, 73728
    s_mov_b32 m0, s81
    v_exp_f32 v179, v179
    buffer_load_dwordx4 v1, s[4:7], s80 offen offset:0 sc1 lds
    v_exp_f32 v132, v132
    v_exp_f32 v180, v180
    v_exp_f32 v133, v133
    v_exp_f32 v181, v181
    v_exp_f32 v134, v134
    v_exp_f32 v182, v182
    buffer_load_dwordx4 v1, s[4:7], s80 offen offset:1024 sc1 lds
    v_exp_f32 v135, v135
    v_exp_f32 v183, v183
    v_exp_f32 v136, v136
    v_exp_f32 v184, v184
    v_exp_f32 v137, v137
    v_exp_f32 v185, v185
    buffer_load_dwordx4 v1, s[4:7], s80 offen offset:2048 sc1 lds
    v_exp_f32 v138, v138
    v_exp_f32 v186, v186
    v_exp_f32 v139, v139
    v_exp_f32 v187, v187
    v_exp_f32 v140, v140
    v_exp_f32 v188, v188
    buffer_load_dwordx4 v1, s[4:7], s80 offen offset:3072 sc1 lds
    v_exp_f32 v141, v141
    v_exp_f32 v189, v189
    v_exp_f32 v142, v142
    v_exp_f32 v190, v190
    v_exp_f32 v143, v143
    s_add_u32 s80, s80, 4096
    s_add_u32 s81, s81, 4096
    s_mov_b32 m0, s81
    v_exp_f32 v191, v191
    buffer_load_dwordx4 v1, s[4:7], s80 offen offset:0 sc1 lds
    v_exp_f32 v144, v144
    v_exp_f32 v192, v192
    v_exp_f32 v145, v145
    v_exp_f32 v193, v193
    v_exp_f32 v146, v146
    v_exp_f32 v194, v194
    buffer_load_dwordx4 v1, s[4:7], s80 offen offset:1024 sc1 lds
    v_exp_f32 v147, v147
    v_exp_f32 v195, v195
    v_pk_add_f32 v[200:201], v[128:129], v[130:131]
    v_pk_add_f32 v[202:203], v[176:177], v[178:179]
    v_pk_add_f32 v[200:201], v[200:201], v[132:133]
    v_pk_add_f32 v[202:203], v[202:203], v[180:181]
    v_pk_add_f32 v[200:201], v[200:201], v[134:135]
    v_pk_add_f32 v[202:203], v[202:203], v[182:183]
    v_pk_add_f32 v[200:201], v[200:201], v[136:137]
    v_pk_add_f32 v[202:203], v[202:203], v[184:185]
    v_pk_add_f32 v[200:201], v[200:201], v[138:139]
    v_pk_add_f32 v[202:203], v[202:203], v[186:187]
    v_pk_add_f32 v[200:201], v[200:201], v[140:141]
    v_pk_add_f32 v[202:203], v[202:203], v[188:189]
    v_pk_add_f32 v[200:201], v[200:201], v[142:143]
    v_pk_add_f32 v[202:203], v[202:203], v[190:191]
    v_pk_add_f32 v[200:201], v[200:201], v[144:145]
    v_pk_add_f32 v[202:203], v[202:203], v[192:193]
    v_pk_add_f32 v[200:201], v[200:201], v[146:147]
    v_pk_add_f32 v[202:203], v[202:203], v[194:195]
    v_add_f32 v200, v200, v201
    v_add_f32 v202, v202, v203
    v_rcp_f32 v200, v200
    v_rcp_f32 v202, v202
    buffer_load_dwordx4 v1, s[4:7], s80 offen offset:2048 sc1 lds
    v_pk_mul_f32 v[128:129], v[128:129], v[200:201] op_sel_hi:[1,0]
    v_pk_mul_f32 v[176:177], v[176:177], v[202:203] op_sel_hi:[1,0]
    v_pk_mul_f32 v[130:131], v[130:131], v[200:201] op_sel_hi:[1,0]
    v_pk_mul_f32 v[178:179], v[178:179], v[202:203] op_sel_hi:[1,0]
    v_pk_mul_f32 v[132:133], v[132:133], v[200:201] op_sel_hi:[1,0]
    v_pk_mul_f32 v[180:181], v[180:181], v[202:203] op_sel_hi:[1,0]
    v_pk_mul_f32 v[134:135], v[134:135], v[200:201] op_sel_hi:[1,0]
    v_pk_mul_f32 v[182:183], v[182:183], v[202:203] op_sel_hi:[1,0]
    v_pk_mul_f32 v[136:137], v[136:137], v[200:201] op_sel_hi:[1,0]
    v_pk_mul_f32 v[184:185], v[184:185], v[202:203] op_sel_hi:[1,0]
    v_pk_mul_f32 v[138:139], v[138:139], v[200:201] op_sel_hi:[1,0]
    v_pk_mul_f32 v[186:187], v[186:187], v[202:203] op_sel_hi:[1,0]
    v_pk_mul_f32 v[140:141], v[140:141], v[200:201] op_sel_hi:[1,0]
    v_pk_mul_f32 v[188:189], v[188:189], v[202:203] op_sel_hi:[1,0]
    v_pk_mul_f32 v[142:143], v[142:143], v[200:201] op_sel_hi:[1,0]
    v_pk_mul_f32 v[190:191], v[190:191], v[202:203] op_sel_hi:[1,0]
    v_pk_mul_f32 v[144:145], v[144:145], v[200:201] op_sel_hi:[1,0]
    v_pk_mul_f32 v[192:193], v[192:193], v[202:203] op_sel_hi:[1,0]
    v_pk_mul_f32 v[146:147], v[146:147], v[200:201] op_sel_hi:[1,0]
    v_pk_mul_f32 v[194:195], v[194:195], v[202:203] op_sel_hi:[1,0]
    v_cvt_pk_bf16_f32 v208, v128, v129
    v_cvt_pk_bf16_f32 v218, v176, v177
    v_cvt_pk_bf16_f32 v209, v130, v131
    v_cvt_pk_bf16_f32 v219, v178, v179
    v_cvt_pk_bf16_f32 v210, v132, v133
    v_cvt_pk_bf16_f32 v220, v180, v181
    v_cvt_pk_bf16_f32 v211, v134, v135
    v_cvt_pk_bf16_f32 v221, v182, v183
    v_cvt_pk_bf16_f32 v212, v136, v137
    v_cvt_pk_bf16_f32 v222, v184, v185
    v_cvt_pk_bf16_f32 v213, v138, v139
    v_cvt_pk_bf16_f32 v223, v186, v187
    v_cvt_pk_bf16_f32 v214, v140, v141
    v_cvt_pk_bf16_f32 v224, v188, v189
    v_cvt_pk_bf16_f32 v215, v142, v143
    v_cvt_pk_bf16_f32 v225, v190, v191
    v_cvt_pk_bf16_f32 v216, v144, v145
    v_cvt_pk_bf16_f32 v226, v192, v193
    v_cvt_pk_bf16_f32 v217, v146, v147
    v_cvt_pk_bf16_f32 v227, v194, v195
    buffer_load_dwordx4 v1, s[4:7], s80 offen offset:3072 sc1 lds
    s_add_u32 s80, s80, 4096
    s_add_u32 s81, s81, 4096
    s_mov_b32 m0, s81
    s_nop 0
    buffer_load_dwordx4 v1, s[4:7], s80 offen offset:0 sc1 lds
    buffer_load_dwordx4 v1, s[4:7], s80 offen offset:1024 sc1 lds
    buffer_load_dwordx4 v1, s[4:7], s80 offen offset:2048 sc1 lds
    ds_write_b128 v59, v[152:155]
    ds_write_b128 v60, v[156:159]
    ds_write_b128 v61, v[160:163]
    ds_write_b128 v16, v[208:211]
    ds_write_b128 v55, v[212:215]
    ds_write_b128 v56, v[216:219]
    ds_write_b128 v57, v[220:223]
    ds_write_b128 v58, v[224:227]
    s_waitcnt vmcnt(11)
    s_waitcnt lgkmcnt(0)
    s_barrier
    ds_read_b64_tr_b16 v[128:129], v17 offset:0
    ds_read_b64_tr_b16 v[130:131], v18 offset:0
    ds_read_b64_tr_b16 v[132:133], v19 offset:0
    ds_read_b64_tr_b16 v[134:135], v20 offset:0
    ds_read_b64_tr_b16 v[136:137], v17 offset:2048
    ds_read_b64_tr_b16 v[138:139], v18 offset:2048
    ds_read_b64_tr_b16 v[140:141], v19 offset:2048
    ds_read_b64_tr_b16 v[142:143], v20 offset:2048
    ds_read_b64_tr_b16 v[144:145], v17 offset:4096
    ds_read_b64_tr_b16 v[146:147], v18 offset:4096
    ds_read_b64_tr_b16 v[148:149], v19 offset:4096
    ds_read_b64_tr_b16 v[150:151], v20 offset:4096
    ds_read_b64_tr_b16 v[152:153], v17 offset:6144
    ds_read_b64_tr_b16 v[154:155], v18 offset:6144
    ds_read_b64_tr_b16 v[156:157], v19 offset:6144
    ds_read_b64_tr_b16 v[158:159], v20 offset:6144
    s_waitcnt lgkmcnt(12)
    v_mfma_f32_32x32x16_bf16 v[176:191], v[128:131], v[132:135], 0
    ds_read_b64_tr_b16 v[128:129], v17 offset:8192
    ds_read_b64_tr_b16 v[130:131], v18 offset:8192
    ds_read_b64_tr_b16 v[132:133], v19 offset:8192
    ds_read_b64_tr_b16 v[134:135], v20 offset:8192
    s_waitcnt lgkmcnt(12)
    v_mfma_f32_32x32x16_bf16 v[176:191], v[136:139], v[140:143], v[176:191]
    ds_read_b64_tr_b16 v[136:137], v17 offset:10240
    ds_read_b64_tr_b16 v[138:139], v18 offset:10240
    ds_read_b64_tr_b16 v[140:141], v19 offset:10240
    ds_read_b64_tr_b16 v[142:143], v20 offset:10240
    s_waitcnt lgkmcnt(12)
    v_mfma_f32_32x32x16_bf16 v[176:191], v[144:147], v[148:151], v[176:191]
    ds_read_b64_tr_b16 v[144:145], v17 offset:12288
    ds_read_b64_tr_b16 v[146:147], v18 offset:12288
    ds_read_b64_tr_b16 v[148:149], v19 offset:12288
    ds_read_b64_tr_b16 v[150:151], v20 offset:12288
    s_waitcnt lgkmcnt(12)
    v_mfma_f32_32x32x16_bf16 v[176:191], v[152:155], v[156:159], v[176:191]
    ds_read_b64_tr_b16 v[152:153], v17 offset:14336
    ds_read_b64_tr_b16 v[154:155], v18 offset:14336
    ds_read_b64_tr_b16 v[156:157], v19 offset:14336
    ds_read_b64_tr_b16 v[158:159], v20 offset:14336
    s_waitcnt lgkmcnt(12)
    v_mfma_f32_32x32x16_bf16 v[176:191], v[128:131], v[132:135], v[176:191]
    s_waitcnt lgkmcnt(8)
    v_mfma_f32_32x32x16_bf16 v[176:191], v[136:139], v[140:143], v[176:191]
    s_waitcnt lgkmcnt(4)
    v_mfma_f32_32x32x16_bf16 v[176:191], v[144:147], v[148:151], v[176:191]
    s_waitcnt lgkmcnt(0)
    v_mfma_f32_32x32x16_bf16 v[176:191], v[152:155], v[156:159], v[176:191]
    s_nop 11
    v_cvt_pk_bf16_f32 v164, v176, v177
    v_cvt_pk_bf16_f32 v165, v178, v179
    v_cvt_pk_bf16_f32 v166, v180, v181
    v_cvt_pk_bf16_f32 v167, v182, v183
    v_cvt_pk_bf16_f32 v168, v184, v185
    v_cvt_pk_bf16_f32 v169, v186, v187
    v_cvt_pk_bf16_f32 v170, v188, v189
    v_cvt_pk_bf16_f32 v171, v190, v191
    buffer_store_dwordx4 v[164:167], v21, s[4:7], s87 offen sc1
    buffer_store_dwordx4 v[168:171], v21, s[4:7], s88 offen offset:1024 sc1
    s_mov_b32 m0, s83
    s_nop 0
    buffer_load_dwordx4 v26, s[12:15], s82 offen nt lds
    s_add_u32 s82, s82, 8192
    s_add_u32 s83, s83, 1024
    s_mov_b32 m0, s83
    v_xor_b32 v28, 32, v26
    buffer_load_dwordx4 v28, s[12:15], s82 offen nt lds
    s_add_u32 s82, s82, 8192
    s_add_u32 s83, s83, 1024
    s_mov_b32 m0, s83
    v_xor_b32 v27, 64, v26
    buffer_load_dwordx4 v27, s[12:15], s82 offen nt lds
    s_add_u32 s82, s82, 8192
    s_add_u32 s83, s83, 1024
    s_mov_b32 m0, s83
    v_xor_b32 v28, 96, v26
    buffer_load_dwordx4 v28, s[12:15], s82 offen nt lds
    s_add_u32 s82, s82, 8192
    s_add_u32 s83, s83, 1024
    s_mov_b32 m0, s83
    v_xor_b32 v27, 128, v26
    buffer_load_dwordx4 v27, s[12:15], s82 offen nt lds
    s_add_u32 s82, s82, 8192
    s_add_u32 s83, s83, 1024
    s_mov_b32 m0, s83
    v_xor_b32 v28, 160, v26
    buffer_load_dwordx4 v28, s[12:15], s82 offen nt lds
    s_add_u32 s82, s82, 8192
    s_add_u32 s83, s83, 1024
    s_mov_b32 m0, s83
    v_xor_b32 v27, 192, v26
    buffer_load_dwordx4 v27, s[12:15], s82 offen nt lds
    s_add_u32 s82, s82, 8192
    s_add_u32 s83, s83, 1024
    s_mov_b32 m0, s83
    v_xor_b32 v28, 224, v26
    buffer_load_dwordx4 v28, s[12:15], s82 offen nt lds
    s_lshl_b32 s82, s52, 18
    s_lshl_b32 s56, s53, 14
    s_add_u32 s82, s82, s56
    s_lshl_b32 s56, s47, 12
    s_add_u32 s82, s82, s56
    s_add_u32 s82, s82, 26214400
    s_add_u32 s83, s82, 0x20000
    s_lshl_b32 s55, s52, 2
    s_add_u32 s55, s55, s47
    s_mul_i32 s61, s55, 20480
    s_mul_i32 s56, s53, 2560
    s_add_u32 s87, s61, s56
    s_add_u32 s87, s87, 1048576
    s_lshl_b32 s56, s48, 16
    s_add_u32 s61, s61, s56
    s_add_u32 s61, s61, 13631488
    s_lshl_b32 s62, s52, 13
    s_lshl_b32 s56, s47, 8
    s_add_u32 s62, s62, s56
    s_add_u32 s62, s62, 131072
    s_lshl_b32 s56, s53, 10
    s_add_u32 s88, s62, s56
    s_add_u32 s84, s88, 262144
    s_mul_i32 s63, s51, 81920
    s_add_u32 s63, s63, 11534336
    v_cmp_lt_u32 vcc, 9, v2
    s_nop 1
    v_cndmask_b32 v27, 0, 1, vcc
    v_mul_u32_u24 v27, 19200, v27
    v_lshl_add_u32 v27, v2, 7, v27
    v_add_u32 v27, s89, v27
    v_subrev_u32 v28, 20, v2
    v_lshlrev_b32 v28, 7, v28
    v_add_u32 v28, s87, v28
    v_cmp_lt_u32 vcc, 19, v2
    s_nop 1
    v_cndmask_b32 v27, v27, v28, vcc
    v_and_b32 v28, 1, v2
    v_lshlrev_b32 v28, 7, v28
    v_add_u32 v15, s88, v28
    v_cmp_lt_u32 vcc, 39, v2
    s_nop 1
    v_cndmask_b32 v27, v27, v15, vcc
    v_add_u32 v15, s84, v28
    v_cmp_lt_u32 vcc, 41, v2
    s_nop 1
    v_cndmask_b32 v27, v27, v15, vcc
    ds_read_b128 v[128:131], v1 offset:0
    ds_read_b128 v[132:135], v1 offset:1024
    ds_read_b128 v[136:139], v1 offset:2048
    ds_read_b128 v[140:143], v1 offset:3072
    s_waitcnt lgkmcnt(3)
    v_mfma_f32_32x32x16_bf16 v[112:127], v[128:131], a[0:3], 0
    ds_read_b128 v[128:131], v1 offset:4096
    s_waitcnt lgkmcnt(3)
    v_mfma_f32_32x32x16_bf16 v[112:127], v[132:135], a[4:7], v[112:127]
    ds_read_b128 v[132:135], v1 offset:5120
    s_waitcnt lgkmcnt(3)
    v_mfma_f32_32x32x16_bf16 v[112:127], v[136:139], a[8:11], v[112:127]
    ds_read_b128 v[136:139], v1 offset:6144
    s_waitcnt lgkmcnt(3)
    v_mfma_f32_32x32x16_bf16 v[112:127], v[140:143], a[12:15], v[112:127]
    ds_read_b128 v[140:143], v1 offset:7168
    s_waitcnt lgkmcnt(3)
    v_mfma_f32_32x32x16_bf16 v[112:127], v[128:131], a[16:19], v[112:127]
    ds_read_b128 v[128:131], v1 offset:8192
    s_waitcnt lgkmcnt(3)
    v_mfma_f32_32x32x16_bf16 v[112:127], v[132:135], a[20:23], v[112:127]
    ds_read_b128 v[132:135], v1 offset:9216
    s_waitcnt lgkmcnt(3)
    v_mfma_f32_32x32x16_bf16 v[112:127], v[136:139], a[24:27], v[112:127]
    ds_read_b128 v[136:139], v1 offset:10240
    s_waitcnt lgkmcnt(3)
    v_mfma_f32_32x32x16_bf16 v[112:127], v[140:143], a[28:31], v[112:127]
    ds_read_b128 v[140:143], v1 offset:11264
    s_waitcnt lgkmcnt(3)
    v_mfma_f32_32x32x16_bf16 v[112:127], v[128:131], a[32:35], v[112:127]
    ds_read_b128 v[128:131], v1 offset:12288
    s_waitcnt lgkmcnt(3)
    v_mfma_f32_32x32x16_bf16 v[112:127], v[132:135], a[36:39], v[112:127]
    ds_read_b128 v[132:135], v1 offset:13312
    s_waitcnt lgkmcnt(3)
    v_mfma_f32_32x32x16_bf16 v[112:127], v[136:139], a[40:43], v[112:127]
    ds_read_b128 v[136:139], v1 offset:14336
    s_waitcnt lgkmcnt(3)
    v_mfma_f32_32x32x16_bf16 v[112:127], v[140:143], a[44:47], v[112:127]
    ds_read_b128 v[140:143], v1 offset:15360
    s_waitcnt lgkmcnt(3)
    v_mfma_f32_32x32x16_bf16 v[112:127], v[128:131], a[48:51], v[112:127]
    ds_read_b128 v[128:131], v1 offset:16384
    s_waitcnt lgkmcnt(3)
    v_mfma_f32_32x32x16_bf16 v[112:127], v[132:135], a[52:55], v[112:127]
    s_waitcnt vmcnt(8)
    s_barrier
    v_mov_b32 v50, s44
    v_mov_b32 v51, 0
    s_mov_b64 exec, 1
    buffer_store_dword v50, v51, s[4:7], s59 offen sc1
    s_mov_b64 exec, -1
    s_lshl_b32 s55, s53, 7
    s_lshl_b32 s56, s52, 2
    s_add_u32 s55, s55, s56
    s_add_u32 s55, s55, 8192
    s_cmp_lt_u32 s52, 20
    s_cselect_b32 s55, s55, 1073741824
    s_cmp_eq_u32 s47, 0
    s_cselect_b32 s55, s55, 1073741824
    v_mov_b32 v50, s44
    v_mov_b32 v51, 0
    s_mov_b64 exec, 1
    buffer_store_dword v50, v51, s[4:7], s55 offen sc1
    s_mov_b64 exec, -1
    s_lshl_b32 s55, s53, 7
    s_lshl_b32 s56, s52, 2
    s_add_u32 s55, s55, s56
    s_add_u32 s55, s55, 9216
    s_cmp_lt_u32 s52, 24
    s_cselect_b32 s55, s55, 1073741824
    s_cmp_eq_u32 s47, 0
    s_cselect_b32 s55, s55, 1073741824
    v_mov_b32 v50, s44
    v_mov_b32 v51, 0
    s_mov_b64 exec, 1
    buffer_store_dword v50, v51, s[4:7], s55 offen sc1
    s_mov_b64 exec, -1
    ds_read_b128 v[132:135], v1 offset:17408
    s_waitcnt lgkmcnt(3)
    v_mfma_f32_32x32x16_bf16 v[112:127], v[136:139], a[56:59], v[112:127]
    ds_read_b128 v[136:139], v1 offset:18432
    buffer_load_dword v15, v27, s[4:7], 0 offen sc1
    s_waitcnt lgkmcnt(3)
    v_mfma_f32_32x32x16_bf16 v[112:127], v[140:143], a[60:63], v[112:127]
    ds_read_b128 v[140:143], v1 offset:19456
    s_waitcnt lgkmcnt(3)
    v_mfma_f32_32x32x16_bf16 v[112:127], v[128:131], a[64:67], v[112:127]
    ds_read_b128 v[128:131], v1 offset:20480
    s_waitcnt lgkmcnt(3)
    v_mfma_f32_32x32x16_bf16 v[112:127], v[132:135], a[68:71], v[112:127]
    s_mul_i32 s81, s47, 8192
    s_add_u32 s80, s81, s85
    s_add_u32 s80, s80, 45056
    s_add_u32 s81, s81, 40960
    s_mov_b32 m0, s81
    ds_read_b128 v[132:135], v1 offset:21504
    buffer_load_dwordx4 v1, s[4:7], s80 offen offset:0 sc1 lds
    s_waitcnt lgkmcnt(3)
    v_mfma_f32_32x32x16_bf16 v[112:127], v[136:139], a[72:75], v[112:127]
    ds_read_b128 v[136:139], v1 offset:22528
    s_waitcnt lgkmcnt(3)
    v_mfma_f32_32x32x16_bf16 v[112:127], v[140:143], a[76:79], v[112:127]
    ds_read_b128 v[140:143], v1 offset:23552
    s_waitcnt lgkmcnt(3)
    v_mfma_f32_32x32x16_bf16 v[112:127], v[128:131], a[80:83], v[112:127]
    ds_read_b128 v[128:131], v1 offset:24576
    buffer_load_dwordx4 v1, s[4:7], s80 offen offset:1024 sc1 lds
    s_waitcnt lgkmcnt(3)
    v_mfma_f32_32x32x16_bf16 v[112:127], v[132:135], a[84:87], v[112:127]
    ds_read_b128 v[132:135], v1 offset:25600
    s_waitcnt lgkmcnt(3)
    v_mfma_f32_32x32x16_bf16 v[112:127], v[136:139], a[88:91], v[112:127]
    ds_read_b128 v[136:139], v1 offset:26624
    s_waitcnt lgkmcnt(3)
    v_mfma_f32_32x32x16_bf16 v[112:127], v[140:143], a[92:95], v[112:127]
    ds_read_b128 v[140:143], v1 offset:27648
    buffer_load_dwordx4 v1, s[4:7], s80 offen offset:2048 sc1 lds
    s_waitcnt lgkmcnt(3)
    v_mfma_f32_32x32x16_bf16 v[112:127], v[128:131], a[96:99], v[112:127]
    ds_read_b128 v[128:131], v1 offset:28672
    s_waitcnt lgkmcnt(3)
    v_mfma_f32_32x32x16_bf16 v[112:127], v[132:135], a[100:103], v[112:127]
    ds_read_b128 v[132:135], v1 offset:29696
    s_waitcnt lgkmcnt(3)
    v_mfma_f32_32x32x16_bf16 v[112:127], v[136:139], a[104:107], v[112:127]
    ds_read_b128 v[136:139], v1 offset:30720
    buffer_load_dwordx4 v1, s[4:7], s80 offen offset:3072 sc1 lds
    s_waitcnt lgkmcnt(3)
    v_mfma_f32_32x32x16_bf16 v[112:127], v[140:143], a[108:111], v[112:127]
    ds_read_b128 v[140:143], v1 offset:31744
    s_waitcnt lgkmcnt(3)
    v_mfma_f32_32x32x16_bf16 v[112:127], v[128:131], a[112:115], v[112:127]
    ds_read_b128 v[128:131], v1 offset:32768
    s_waitcnt lgkmcnt(3)
    v_mfma_f32_32x32x16_bf16 v[112:127], v[132:135], a[116:119], v[112:127]
    s_add_u32 s80, s80, 4096
    s_add_u32 s81, s81, 4096
    s_mov_b32 m0, s81
    ds_read_b128 v[132:135], v1 offset:33792
    buffer_load_dwordx4 v1, s[4:7], s80 offen offset:0 sc1 lds
    s_waitcnt lgkmcnt(3)
    v_mfma_f32_32x32x16_bf16 v[112:127], v[136:139], a[120:123], v[112:127]
    ds_read_b128 v[136:139], v1 offset:34816
    s_waitcnt lgkmcnt(3)
    v_mfma_f32_32x32x16_bf16 v[112:127], v[140:143], a[124:127], v[112:127]
    ds_read_b128 v[140:143], v1 offset:35840
    s_waitcnt lgkmcnt(3)
    v_mfma_f32_32x32x16_bf16 v[112:127], v[128:131], a[128:131], v[112:127]
    ds_read_b128 v[128:131], v1 offset:36864
    buffer_load_dwordx4 v1, s[4:7], s80 offen offset:1024 sc1 lds
    s_waitcnt lgkmcnt(3)
    v_mfma_f32_32x32x16_bf16 v[112:127], v[132:135], a[132:135], v[112:127]
    ds_read_b128 v[132:135], v1 offset:37888
    s_waitcnt lgkmcnt(3)
    v_mfma_f32_32x32x16_bf16 v[112:127], v[136:139], a[136:139], v[112:127]
    ds_read_b128 v[136:139], v1 offset:38912
    s_waitcnt lgkmcnt(3)
    v_mfma_f32_32x32x16_bf16 v[112:127], v[140:143], a[140:143], v[112:127]
    ds_read_b128 v[140:143], v1 offset:39936
    buffer_load_dwordx4 v1, s[4:7], s80 offen offset:2048 sc1 lds
    s_waitcnt lgkmcnt(3)
    v_mfma_f32_32x32x16_bf16 v[112:127], v[128:131], a[144:147], v[112:127]
    s_waitcnt lgkmcnt(2)
    v_mfma_f32_32x32x16_bf16 v[112:127], v[132:135], a[148:151], v[112:127]
    s_waitcnt lgkmcnt(1)
    v_mfma_f32_32x32x16_bf16 v[112:127], v[136:139], a[152:155], v[112:127]
    buffer_load_dwordx4 v1, s[4:7], s80 offen offset:3072 sc1 lds
    s_waitcnt lgkmcnt(0)
    v_mfma_f32_32x32x16_bf16 v[112:127], v[140:143], a[156:159], v[112:127]
    s_add_u32 s98, s42, s60
    s_addc_u32 s99, s43, 0
    s_cmp_lg_u32 s47, 0
    s_cbranch_scc1 L_spi_13
    s_load_dwordx16 s[64:79], s[98:99], 0 glc
L_spi_13:
    v_cvt_pk_bf16_f32 v164, v104, v105
    v_cvt_pk_bf16_f32 v165, v106, v107
    v_cvt_pk_bf16_f32 v166, v108, v109
    v_cvt_pk_bf16_f32 v167, v110, v111
    s_nop 2
    v_cvt_pk_bf16_f32 v168, v112, v113
    v_cvt_pk_bf16_f32 v169, v114, v115
    v_cvt_pk_bf16_f32 v170, v116, v117
    v_cvt_pk_bf16_f32 v171, v118, v119
    v_cvt_pk_bf16_f32 v172, v120, v121
    v_cvt_pk_bf16_f32 v173, v122, v123
    v_mov_b32 v174, 0
    v_mov_b32 v175, 0
    v_mfma_f32_32x32x16_bf16 v[176:191], v[232:235], v[164:167], 0
    v_mfma_f32_32x32x16_bf16 v[192:207], v[244:247], v[164:167], 0
    v_mfma_f32_32x32x16_bf16 v[176:191], v[236:239], v[168:171], v[176:191]
    v_mfma_f32_32x32x16_bf16 v[192:207], v[248:251], v[168:171], v[192:207]
    v_mfma_f32_32x32x16_bf16 v[176:191], v[240:243], v[172:175], v[176:191]
    v_mfma_f32_32x32x16_bf16 v[192:207], v[252:255], v[172:175], v[192:207]
    s_mov_b32 s24, 0x3fb8aa3b
    s_mov_b32 s25, s24
    s_nop 9
    v_max3_f32 v196, v176, v177, v178
    v_min3_f32 v198, v176, v177, v178
    v_max3_f32 v196, v196, v179, v180
    v_min3_f32 v198, v198, v179, v180
    v_max3_f32 v196, v196, v181, v182
    v_min3_f32 v198, v198, v181, v182
    v_max3_f32 v196, v196, v183, v184
    v_min3_f32 v198, v198, v183, v184
    v_max3_f32 v196, v196, v185, v186
    v_min3_f32 v198, v198, v185, v186
    v_max3_f32 v196, v196, v187, v188
    v_min3_f32 v198, v198, v187, v188
    v_max3_f32 v196, v196, v189, v190
    v_min3_f32 v198, v198, v189, v190
    v_max3_f32 v196, v196, v191, v192
    v_min3_f32 v198, v198, v191, v192
    v_max3_f32 v196, v196, v193, v194
    v_min3_f32 v198, v198, v193, v194
    v_max_f32 v196, v196, v195
    v_min_f32 v198, v198, v195
    v_mul_f32 v196, 0xbfb8aa3b, v196
    v_mul_f32 v198, 0x3fb8aa3b, v198
    v_pk_fma_f32 v[128:129], v[176:177], s[24:25], v[196:197] op_sel_hi:[1,1,0]
    v_pk_fma_f32 v[176:177], v[176:177], s[24:25], v[198:199] op_sel_hi:[1,1,0] neg_lo:[1,0,0] neg_hi:[1,0,0]
    v_pk_fma_f32 v[130:131], v[178:179], s[24:25], v[196:197] op_sel_hi:[1,1,0]
    v_pk_fma_f32 v[178:179], v[178:179], s[24:25], v[198:199] op_sel_hi:[1,1,0] neg_lo:[1,0,0] neg_hi:[1,0,0]
    v_pk_fma_f32 v[132:133], v[180:181], s[24:25], v[196:197] op_sel_hi:[1,1,0]
    v_pk_fma_f32 v[180:181], v[180:181], s[24:25], v[198:199] op_sel_hi:[1,1,0] neg_lo:[1,0,0] neg_hi:[1,0,0]
    v_pk_fma_f32 v[134:135], v[182:183], s[24:25], v[196:197] op_sel_hi:[1,1,0]
    v_pk_fma_f32 v[182:183], v[182:183], s[24:25], v[198:199] op_sel_hi:[1,1,0] neg_lo:[1,0,0] neg_hi:[1,0,0]
    v_pk_fma_f32 v[136:137], v[184:185], s[24:25], v[196:197] op_sel_hi:[1,1,0]
    v_pk_fma_f32 v[184:185], v[184:185], s[24:25], v[198:199] op_sel_hi:[1,1,0] neg_lo:[1,0,0] neg_hi:[1,0,0]
    v_pk_fma_f32 v[138:139], v[186:187], s[24:25], v[196:197] op_sel_hi:[1,1,0]
    v_pk_fma_f32 v[186:187], v[186:187], s[24:25], v[198:199] op_sel_hi:[1,1,0] neg_lo:[1,0,0] neg_hi:[1,0,0]
    v_pk_fma_f32 v[140:141], v[188:189], s[24:25], v[196:197] op_sel_hi:[1,1,0]
    v_pk_fma_f32 v[188:189], v[188:189], s[24:25], v[198:199] op_sel_hi:[1,1,0] neg_lo:[1,0,0] neg_hi:[1,0,0]
    v_pk_fma_f32 v[142:143], v[190:191], s[24:25], v[196:197] op_sel_hi:[1,1,0]
    v_pk_fma_f32 v[190:191], v[190:191], s[24:25], v[198:199] op_sel_hi:[1,1,0] neg_lo:[1,0,0] neg_hi:[1,0,0]
    v_pk_fma_f32 v[144:145], v[192:193], s[24:25], v[196:197] op_sel_hi:[1,1,0]
    v_pk_fma_f32 v[192:193], v[192:193], s[24:25], v[198:199] op_sel_hi:[1,1,0] neg_lo:[1,0,0] neg_hi:[1,0,0]
    v_pk_fma_f32 v[146:147], v[194:195], s[24:25], v[196:197] op_sel_hi:[1,1,0]
    v_pk_fma_f32 v[194:195], v[194:195], s[24:25], v[198:199] op_sel_hi:[1,1,0] neg_lo:[1,0,0] neg_hi:[1,0,0]
    v_exp_f32 v128, v128
    v_exp_f32 v176, v176
    v_exp_f32 v129, v129
    v_exp_f32 v177, v177
    v_exp_f32 v130, v130
    v_exp_f32 v178, v178
    v_exp_f32 v131, v131
    v_exp_f32 v179, v179
    v_exp_f32 v132, v132
    v_exp_f32 v180, v180
    v_exp_f32 v133, v133
    v_exp_f32 v181, v181
    v_exp_f32 v134, v134
    v_exp_f32 v182, v182
    v_exp_f32 v135, v135
    v_exp_f32 v183, v183
    v_exp_f32 v136, v136
    v_exp_f32 v184, v184
    v_exp_f32 v137, v137
    v_exp_f32 v185, v185
    v_exp_f32 v138, v138
    v_exp_f32 v186, v186
    v_exp_f32 v139, v139
    v_exp_f32 v187, v187
    v_exp_f32 v140, v140
    v_exp_f32 v188, v188
    v_exp_f32 v141, v141
    v_exp_f32 v189, v189
    v_exp_f32 v142, v142
    v_exp_f32 v190, v190
    v_exp_f32 v143, v143
    v_exp_f32 v191, v191
    v_exp_f32 v144, v144
    v_exp_f32 v192, v192
    v_exp_f32 v145, v145
    v_exp_f32 v193, v193
    v_exp_f32 v146, v146
    v_exp_f32 v194, v194
    v_exp_f32 v147, v147
    v_exp_f32 v195, v195
    v_pk_add_f32 v[200:201], v[128:129], v[130:131]
    v_pk_add_f32 v[202:203], v[176:177], v[178:179]
    v_pk_add_f32 v[200:201], v[200:201], v[132:133]
    v_pk_add_f32 v[202:203], v[202:203], v[180:181]
    v_pk_add_f32 v[200:201], v[200:201], v[134:135]
    v_pk_add_f32 v[202:203], v[202:203], v[182:183]
    v_pk_add_f32 v[200:201], v[200:201], v[136:137]
    v_pk_add_f32 v[202:203], v[202:203], v[184:185]
    v_pk_add_f32 v[200:201], v[200:201], v[138:139]
    v_pk_add_f32 v[202:203], v[202:203], v[186:187]
    v_pk_add_f32 v[200:201], v[200:201], v[140:141]
    v_pk_add_f32 v[202:203], v[202:203], v[188:189]
    v_pk_add_f32 v[200:201], v[200:201], v[142:143]
    v_pk_add_f32 v[202:203], v[202:203], v[190:191]
    v_pk_add_f32 v[200:201], v[200:201], v[144:145]
    v_pk_add_f32 v[202:203], v[202:203], v[192:193]
    v_pk_add_f32 v[200:201], v[200:201], v[146:147]
    v_pk_add_f32 v[202:203], v[202:203], v[194:195]
    v_add_f32 v200, v200, v201
    v_add_f32 v202, v202, v203
    v_rcp_f32 v200, v200
    v_rcp_f32 v202, v202
    v_pk_mul_f32 v[128:129], v[128:129], v[200:201] op_sel_hi:[1,0]
    v_pk_mul_f32 v[176:177], v[176:177], v[202:203] op_sel_hi:[1,0]
    v_pk_mul_f32 v[130:131], v[130:131], v[200:201] op_sel_hi:[1,0]
    v_pk_mul_f32 v[178:179], v[178:179], v[202:203] op_sel_hi:[1,0]
    v_pk_mul_f32 v[132:133], v[132:133], v[200:201] op_sel_hi:[1,0]
    v_pk_mul_f32 v[180:181], v[180:181], v[202:203] op_sel_hi:[1,0]
    v_pk_mul_f32 v[134:135], v[134:135], v[200:201] op_sel_hi:[1,0]
    v_pk_mul_f32 v[182:183], v[182:183], v[202:203] op_sel_hi:[1,0]
    v_pk_mul_f32 v[136:137], v[136:137], v[200:201] op_sel_hi:[1,0]
    v_pk_mul_f32 v[184:185], v[184:185], v[202:203] op_sel_hi:[1,0]
    v_pk_mul_f32 v[138:139], v[138:139], v[200:201] op_sel_hi:[1,0]
    v_pk_mul_f32 v[186:187], v[186:187], v[202:203] op_sel_hi:[1,0]
    v_pk_mul_f32 v[140:141], v[140:141], v[200:201] op_sel_hi:[1,0]
    v_pk_mul_f32 v[188:189], v[188:189], v[202:203] op_sel_hi:[1,0]
    v_pk_mul_f32 v[142:143], v[142:143], v[200:201] op_sel_hi:[1,0]
    v_pk_mul_f32 v[190:191], v[190:191], v[202:203] op_sel_hi:[1,0]
    v_pk_mul_f32 v[144:145], v[144:145], v[200:201] op_sel_hi:[1,0]
    v_pk_mul_f32 v[192:193], v[192:193], v[202:203] op_sel_hi:[1,0]
    v_pk_mul_f32 v[146:147], v[146:147], v[200:201] op_sel_hi:[1,0]
    v_pk_mul_f32 v[194:195], v[194:195], v[202:203] op_sel_hi:[1,0]
    v_cvt_pk_bf16_f32 v208, v128, v129
    v_cvt_pk_bf16_f32 v218, v176, v177
    v_cvt_pk_bf16_f32 v209, v130, v131
    v_cvt_pk_bf16_f32 v219, v178, v179
    v_cvt_pk_bf16_f32 v210, v132, v133
    v_cvt_pk_bf16_f32 v220, v180, v181
    v_cvt_pk_bf16_f32 v211, v134, v135
    v_cvt_pk_bf16_f32 v221, v182, v183
    v_cvt_pk_bf16_f32 v212, v136, v137
    v_cvt_pk_bf16_f32 v222, v184, v185
    v_cvt_pk_bf16_f32 v213, v138, v139
    v_cvt_pk_bf16_f32 v223, v186, v187
    v_cvt_pk_bf16_f32 v214, v140, v141
    v_cvt_pk_bf16_f32 v224, v188, v189
    v_cvt_pk_bf16_f32 v215, v142, v143
    v_cvt_pk_bf16_f32 v225, v190, v191
    v_cvt_pk_bf16_f32 v216, v144, v145
    v_cvt_pk_bf16_f32 v226, v192, v193
    v_cvt_pk_bf16_f32 v217, v146, v147
    v_cvt_pk_bf16_f32 v227, v194, v195
    s_waitcnt vmcnt(12)
    s_waitcnt lgkmcnt(0)
    s_cmp_lg_u32 s47, 0
    s_cbranch_scc1 L_spd_16
    s_xor_b64 s[64:65], s[64:65], s[44:45]
    s_xor_b64 s[66:67], s[66:67], s[44:45]
    s_or_b64 s[64:65], s[64:65], s[66:67]
    s_xor_b64 s[68:69], s[68:69], s[44:45]
    s_or_b64 s[64:65], s[64:65], s[68:69]
    s_xor_b64 s[70:71], s[70:71], s[44:45]
    s_or_b64 s[64:65], s[64:65], s[70:71]
    s_xor_b64 s[72:73], s[72:73], s[44:45]
    s_or_b64 s[64:65], s[64:65], s[72:73]
    s_xor_b64 s[74:75], s[74:75], s[44:45]
    s_or_b64 s[64:65], s[64:65], s[74:75]
    s_xor_b64 s[76:77], s[76:77], s[44:45]
    s_or_b64 s[64:65], s[64:65], s[76:77]
    s_xor_b64 s[78:79], s[78:79], s[44:45]
    s_or_b64 s[64:65], s[64:65], s[78:79]
    s_cmp_eq_u64 s[64:65], 0
    s_cbranch_scc1 L_spd_16
L_sp_14:
    s_sleep 4
    s_load_dwordx16 s[64:79], s[98:99], 0 glc
    s_waitcnt lgkmcnt(0)
    s_xor_b64 s[64:65], s[64:65], s[44:45]
    s_xor_b64 s[66:67], s[66:67], s[44:45]
    s_or_b64 s[64:65], s[64:65], s[66:67]
    s_xor_b64 s[68:69], s[68:69], s[44:45]
    s_or_b64 s[64:65], s[64:65], s[68:69]
    s_xor_b64 s[70:71], s[70:71], s[44:45]
    s_or_b64 s[64:65], s[64:65], s[70:71]
    s_xor_b64 s[72:73], s[72:73], s[44:45]
    s_or_b64 s[64:65], s[64:65], s[72:73]
    s_xor_b64 s[74:75], s[74:75], s[44:45]
    s_or_b64 s[64:65], s[64:65], s[74:75]
    s_xor_b64 s[76:77], s[76:77], s[44:45]
    s_or_b64 s[64:65], s[64:65], s[76:77]
    s_xor_b64 s[78:79], s[78:79], s[44:45]
    s_or_b64 s[64:65], s[64:65], s[78:79]
    s_cmp_eq_u64 s[64:65], 0
    s_cbranch_scc1 L_spd_16
    s_sub_u32 s100, s100, 1
    s_cbranch_scc0 L_sp_14
    s_mov_b32 s100, 0
L_spd_16:
    s_barrier
    buffer_load_dwordx4 v[64:67], v31, s[4:7], s63 offen sc1
    s_add_u32 s63, s63, 5120
    buffer_load_dwordx4 v[68:71], v31, s[4:7], s63 offen sc1
    s_add_u32 s63, s63, 5120
    buffer_load_dwordx4 v[72:75], v31, s[4:7], s63 offen sc1
    s_add_u32 s63, s63, 5120
    buffer_load_dwordx4 v[76:79], v31, s[4:7], s63 offen sc1
    s_add_u32 s63, s63, 5120
    buffer_load_dwordx4 v[80:83], v31, s[4:7], s63 offen sc1
    s_add_u32 s63, s63, 5120
    buffer_load_dwordx4 v[84:87], v31, s[4:7], s63 offen sc1
    s_add_u32 s63, s63, 5120
    buffer_load_dwordx4 v[88:91], v31, s[4:7], s63 offen sc1
    s_add_u32 s63, s63, 5120
    buffer_load_dwordx4 v[92:95], v31, s[4:7], s63 offen sc1
    s_add_u32 s63, s63, 5120
    v_and_b32 v16, 31, v2
    v_lshrrev_b32 v17, 5, v2
    s_lshl_b32 s57, s47, 3
    v_add_u32 v17, s57, v17
    v_xor_b32 v17, v17, v11
    v_lshlrev_b32 v17, 4, v17
    v_lshl_add_u32 v17, v16, 9, v17
    v_add_u32 v17, 118784, v17
    ds_read_b128 a[212:215], v17 offset:0
    ds_read_b128 a[216:219], v17 offset:16384
    v_xor_b32 v18, 32, v17
    ds_read_b128 a[220:223], v18 offset:0
    ds_read_b128 a[224:227], v18 offset:16384
    v_xor_b32 v19, 64, v17
    ds_read_b128 a[228:231], v19 offset:0
    ds_read_b128 a[232:235], v19 offset:16384
    v_xor_b32 v20, 96, v17
    ds_read_b128 a[236:239], v20 offset:0
    ds_read_b128 a[240:243], v20 offset:16384
    s_waitcnt vmcnt(7)
    v_mfma_f32_32x32x16_bf16 v[128:143], v[36:39], v[64:67], 0
    buffer_load_dwordx4 v[96:99], v31, s[4:7], s63 offen sc1
    s_add_u32 s63, s63, 5120
    s_waitcnt vmcnt(7)
    v_mfma_f32_32x32x16_bf16 v[128:143], v[36:39], v[68:71], v[128:143]
    buffer_load_dwordx4 v[100:103], v31, s[4:7], s63 offen sc1
    s_add_u32 s63, s63, 5120
    s_waitcnt vmcnt(7)
    v_mfma_f32_32x32x16_bf16 v[128:143], v[36:39], v[72:75], v[128:143]
    buffer_load_dwordx4 v[104:107], v31, s[4:7], s63 offen sc1
    s_add_u32 s63, s63, 5120
    s_waitcnt vmcnt(7)
    v_mfma_f32_32x32x16_bf16 v[128:143], v[36:39], v[76:79], v[128:143]
    buffer_load_dwordx4 v[108:111], v31, s[4:7], s63 offen sc1
    s_add_u32 s63, s63, 5120
    s_waitcnt vmcnt(7)
    v_mfma_f32_32x32x16_bf16 v[128:143], v[36:39], v[80:83], v[128:143]
    buffer_load_dwordx4 v[112:115], v31, s[4:7], s63 offen sc1
    s_add_u32 s63, s63, 5120
    s_waitcnt vmcnt(7)
    v_mfma_f32_32x32x16_bf16 v[128:143], v[36:39], v[84:87], v[128:143]
    buffer_load_dwordx4 v[116:119], v31, s[4:7], s63 offen sc1
    s_add_u32 s63, s63, 5120
    s_waitcnt vmcnt(7)
    v_mfma_f32_32x32x16_bf16 v[128:143], v[36:39], v[88:91], v[128:143]
    buffer_load_dwordx4 v[120:123], v31, s[4:7], s63 offen sc1
    s_add_u32 s63, s63, 5120
    s_waitcnt vmcnt(7)
    v_mfma_f32_32x32x16_bf16 v[128:143], v[36:39], v[92:95], v[128:143]
    buffer_load_dwordx4 v[124:127], v31, s[4:7], s63 offen sc1
    s_waitcnt vmcnt(7)
    v_mfma_f32_32x32x16_bf16 v[128:143], v[36:39], v[96:99], v[128:143]
    s_waitcnt lgkmcnt(0)
    buffer_store_dwordx4 a[212:215], v1, s[4:7], s82 offen offset:0 sc1
    s_waitcnt vmcnt(7)
    v_mfma_f32_32x32x16_bf16 v[128:143], v[36:39], v[100:103], v[128:143]
    buffer_store_dwordx4 a[216:219], v1, s[4:7], s83 offen offset:0 sc1
    s_waitcnt vmcnt(7)
    v_mfma_f32_32x32x16_bf16 v[128:143], v[36:39], v[104:107], v[128:143]
    buffer_store_dwordx4 a[220:223], v1, s[4:7], s82 offen offset:1024 sc1
    s_waitcnt vmcnt(7)
    v_mfma_f32_32x32x16_bf16 v[128:143], v[36:39], v[108:111], v[128:143]
    buffer_store_dwordx4 a[224:227], v1, s[4:7], s83 offen offset:1024 sc1
    s_waitcnt vmcnt(7)
    v_mfma_f32_32x32x16_bf16 v[128:143], v[36:39], v[112:115], v[128:143]
    buffer_store_dwordx4 a[228:231], v1, s[4:7], s82 offen offset:2048 sc1
    s_waitcnt vmcnt(7)
    v_mfma_f32_32x32x16_bf16 v[128:143], v[36:39], v[116:119], v[128:143]
    buffer_store_dwordx4 a[232:235], v1, s[4:7], s83 offen offset:2048 sc1
    s_waitcnt vmcnt(7)
    v_mfma_f32_32x32x16_bf16 v[128:143], v[36:39], v[120:123], v[128:143]
    buffer_store_dwordx4 a[236:239], v1, s[4:7], s82 offen offset:3072 sc1
    s_waitcnt vmcnt(7)
    v_mfma_f32_32x32x16_bf16 v[128:143], v[36:39], v[124:127], v[128:143]
    buffer_store_dwordx4 a[240:243], v1, s[4:7], s83 offen offset:3072 sc1
    s_nop 10
    v_cvt_pk_bf16_f32 v156, v128, v129
    v_cvt_pk_bf16_f32 v157, v130, v131
    v_cvt_pk_bf16_f32 v158, v132, v133
    v_cvt_pk_bf16_f32 v159, v134, v135
    s_nop 0
    v_permlane32_swap_b32 v156, v158
    v_permlane32_swap_b32 v157, v159
    ds_write_b128 v32, v[156:159]
    s_mov_b32 s63, 917504
    buffer_load_dwordx4 v[164:167], v47, s[4:7], s63 offen offset:0 sc1
    buffer_load_dwordx4 v[168:171], v47, s[4:7], s63 offen offset:384 sc1
    buffer_load_dwordx4 v[172:175], v47, s[4:7], s63 offen offset:768 sc1
    buffer_load_dwordx4 v[176:179], v47, s[4:7], s63 offen offset:1152 sc1
    buffer_load_dwordx4 v[180:183], v47, s[4:7], s63 offen offset:1536 sc1
    buffer_load_dword v42, v52, s[4:7], 0 offen sc1
    s_waitcnt lgkmcnt(0)
    s_barrier
    ds_read_b128 v[64:67], v33 offset:0
    ds_read_b128 v[68:71], v34 offset:0
    ds_read_b128 v[72:75], v33 offset:384
    ds_read_b128 v[76:79], v34 offset:384
    ds_read_b128 v[80:83], v33 offset:768
    ds_read_b128 v[84:87], v34 offset:768
    ds_read_b128 v[88:91], v33 offset:1152
    ds_read_b128 v[92:95], v34 offset:1152
    ds_read_b128 v[96:99], v33 offset:1536
    ds_read_b128 v[100:103], v34 offset:1536
    s_lshl_b32 s59, s50, 8
    s_add_u32 s59, s59, 20480
    s_and_b32 s56, s52, 1
    s_lshl_b32 s56, s56, 1
    s_lshr_b32 s57, s47, 1
    s_add_u32 s56, s56, s57
    s_lshl_b32 s56, s56, 6
    s_add_u32 s60, s59, s56
    s_lshl_b32 s56, s47, 6
    s_add_u32 s59, s59, s56
    s_lshl_b32 s56, s51, 2
    s_add_u32 s59, s59, s56
    s_waitcnt lgkmcnt(8)
    v_mfma_f32_32x32x16_bf16 v[128:143], v[64:67], v[208:211], 0
    v_mfma_f32_32x32x16_bf16 v[144:159], v[68:71], v[208:211], 0
    s_waitcnt lgkmcnt(6)
    v_mfma_f32_32x32x16_bf16 v[128:143], v[72:75], v[212:215], v[128:143]
    v_mfma_f32_32x32x16_bf16 v[144:159], v[76:79], v[212:215], v[144:159]
    s_waitcnt lgkmcnt(4)
    v_mfma_f32_32x32x16_bf16 v[128:143], v[80:83], v[216:219], v[128:143]
    v_mfma_f32_32x32x16_bf16 v[144:159], v[84:87], v[216:219], v[144:159]
    s_waitcnt lgkmcnt(2)
    v_mfma_f32_32x32x16_bf16 v[128:143], v[88:91], v[220:223], v[128:143]
    v_mfma_f32_32x32x16_bf16 v[144:159], v[92:95], v[220:223], v[144:159]
    s_waitcnt lgkmcnt(0)
    v_mfma_f32_32x32x16_bf16 v[128:143], v[96:99], v[224:227], v[128:143]
    v_mfma_f32_32x32x16_bf16 v[144:159], v[100:103], v[224:227], v[144:159]
    s_nop 11
    v_add_f32 v148, 0x358637bd, v148
    v_rcp_f32 v148, v148
    s_nop 0
    v_pk_mul_f32 v[128:129], v[128:129], v[148:149] op_sel_hi:[1,0]
    v_pk_mul_f32 v[130:131], v[130:131], v[148:149] op_sel_hi:[1,0]
    v_pk_mul_f32 v[132:133], v[132:133], v[148:149] op_sel_hi:[1,0]
    v_pk_mul_f32 v[134:135], v[134:135], v[148:149] op_sel_hi:[1,0]
    v_pk_mul_f32 v[136:137], v[136:137], v[148:149] op_sel_hi:[1,0]
    v_pk_mul_f32 v[138:139], v[138:139], v[148:149] op_sel_hi:[1,0]
    v_pk_mul_f32 v[140:141], v[140:141], v[148:149] op_sel_hi:[1,0]
    v_pk_mul_f32 v[142:143], v[142:143], v[148:149] op_sel_hi:[1,0]
    v_pk_mul_f32 v[144:145], v[144:145], v[148:149] op_sel_hi:[1,0]
    v_pk_mul_f32 v[146:147], v[146:147], v[148:149] op_sel_hi:[1,0]
    v_cvt_pk_bf16_f32 v152, v128, v129
    v_cvt_pk_bf16_f32 v153, v130, v131
    v_cvt_pk_bf16_f32 v154, v132, v133
    v_cvt_pk_bf16_f32 v155, v134, v135
    v_cvt_pk_bf16_f32 v156, v136, v137
    v_cvt_pk_bf16_f32 v157, v138, v139
    v_cvt_pk_bf16_f32 v158, v140, v141
    v_cvt_pk_bf16_f32 v159, v142, v143
    v_cvt_pk_bf16_f32 v160, v144, v145
    v_cvt_pk_bf16_f32 v161, v146, v147
    s_cmp_eq_u32 s54, 0
    s_cbranch_scc1 L_glob_17
    buffer_store_dwordx4 v[152:155], v29, s[4:7], s89 offen
    buffer_store_dwordx4 v[156:159], v29, s[4:7], s89 offen offset:256
    buffer_store_dwordx2 v[160:161], v30, s[4:7], s89 offen offset:1024
L_back_18:
    s_mul_i32 s81, s47, 6144
    s_add_u32 s80, s81, s85
    s_add_u32 s80, s80, 77824
    s_add_u32 s81, s81, 118784
    s_mov_b32 m0, s81
    s_nop 0
    buffer_load_dwordx4 v1, s[4:7], s80 offen offset:0 sc1 lds
    buffer_load_dwordx4 v1, s[4:7], s80 offen offset:1024 sc1 lds
    buffer_load_dwordx4 v1, s[4:7], s80 offen offset:2048 sc1 lds
    buffer_load_dwordx4 v1, s[4:7], s80 offen offset:3072 sc1 lds
    s_add_u32 s80, s80, 4096
    s_add_u32 s81, s81, 4096
    s_mov_b32 m0, s81
    s_nop 0
    buffer_load_dwordx4 v1, s[4:7], s80 offen offset:0 sc1 lds
    buffer_load_dwordx4 v1, s[4:7], s80 offen offset:1024 sc1 lds
    v_accvgpr_read_b32 v54, a244
    v_accvgpr_read_b32 v55, a245
    v_accvgpr_read_b32 v56, a246
    v_accvgpr_read_b32 v57, a247
    v_accvgpr_read_b32 v58, a248
    v_accvgpr_read_b32 v59, a249
    v_accvgpr_read_b32 v60, a250
    v_accvgpr_read_b32 v61, a251
    v_accvgpr_read_b32 v62, a252
    v_accvgpr_read_b32 v63, a253
    s_waitcnt vmcnt(6)
    v_mov_b32 v50, s44
    v_mov_b32 v51, 0
    s_mov_b64 exec, 1
    s_cmp_eq_u32 s54, 0
    s_cbranch_scc1 L_glob_19
    buffer_store_dword v50, v51, s[4:7], s59 offen
L_back_20:
    s_mov_b64 exec, -1
    v_mov_b32 v51, s44
    v_xor_b32 v50, v167, v51
    v_bitop3_b32 v50, v50, v171, v51 bitop3:0xf6
    v_bitop3_b32 v50, v50, v175, v51 bitop3:0xf6
    v_bitop3_b32 v50, v50, v179, v51 bitop3:0xf6
    v_bitop3_b32 v50, v50, v183, v51 bitop3:0xf6
    v_cmp_ne_u32 vcc, 0, v50
    s_nop 0
    s_cmp_eq_u64 vcc, 0
    s_cbranch_scc1 L_m2d_22
L_m2_21:
    buffer_load_dwordx4 v[164:167], v47, s[4:7], s63 offen offset:0 sc1
    buffer_load_dwordx4 v[168:171], v47, s[4:7], s63 offen offset:384 sc1
    buffer_load_dwordx4 v[172:175], v47, s[4:7], s63 offen offset:768 sc1
    buffer_load_dwordx4 v[176:179], v47, s[4:7], s63 offen offset:1152 sc1
    buffer_load_dwordx4 v[180:183], v47, s[4:7], s63 offen offset:1536 sc1
    s_waitcnt vmcnt(0)
    v_xor_b32 v50, v167, v51
    v_bitop3_b32 v50, v50, v171, v51 bitop3:0xf6
    v_bitop3_b32 v50, v50, v175, v51 bitop3:0xf6
    v_bitop3_b32 v50, v50, v179, v51 bitop3:0xf6
    v_bitop3_b32 v50, v50, v183, v51 bitop3:0xf6
    v_cmp_ne_u32 vcc, 0, v50
    s_nop 0
    s_cmp_eq_u64 vcc, 0
    s_cbranch_scc1 L_m2d_22
    s_sleep 2
    s_sub_u32 s100, s100, 1
    s_cbranch_scc0 L_m2_21
    s_mov_b32 s100, 0
L_m2d_22:
    v_add_f32 v164, v164, v168
    v_add_f32 v165, v165, v169
    v_add_f32 v166, v166, v170
    v_add_f32 v164, v164, v172
    v_add_f32 v165, v165, v173
    v_add_f32 v166, v166, v174
    v_add_f32 v164, v164, v176
    v_add_f32 v165, v165, v177
    v_add_f32 v166, v166, v178
    v_add_f32 v164, v164, v180
    v_add_f32 v165, v165, v181
    v_add_f32 v166, v166, v182
    v_cvt_pk_bf16_f32 v168, v164, v165
    v_cvt_pk_bf16_f32 v169, v166, v166
    v_lshlrev_b32 v164, 16, v168
    v_and_b32 v165, 0xffff0000, v168
    v_lshlrev_b32 v166, 16, v169
    v_add_f32 v164, v164, v49
    v_add_f32 v165, v165, v49
    v_add_f32 v166, v166, v49
    v_cvt_pk_bf16_f32 v168, v164, v165
    v_cvt_pk_bf16_f32 v169, v166, v166
    ds_write_b16 v48, v168
    ds_write_b16_d16_hi v48, v168 offset:2
    ds_write_b16 v48, v169 offset:4
    v_lshlrev_b32 v232, 16, v54
    v_and_b32 v233, 0xffff0000, v54
    v_lshlrev_b32 v234, 16, v55
    v_and_b32 v235, 0xffff0000, v55
    v_lshlrev_b32 v236, 16, v56
    v_and_b32 v237, 0xffff0000, v56
    v_lshlrev_b32 v238, 16, v57
    v_and_b32 v239, 0xffff0000, v57
    v_lshlrev_b32 v240, 16, v58
    v_and_b32 v241, 0xffff0000, v58
    v_lshlrev_b32 v242, 16, v59
    v_and_b32 v243, 0xffff0000, v59
    v_lshlrev_b32 v244, 16, v60
    v_and_b32 v245, 0xffff0000, v60
    v_lshlrev_b32 v246, 16, v61
    v_and_b32 v247, 0xffff0000, v61
    v_lshlrev_b32 v248, 16, v62
    v_and_b32 v249, 0xffff0000, v62
    v_lshlrev_b32 v250, 16, v63
    v_and_b32 v251, 0xffff0000, v63
    s_mul_i32 s24, s53, 0x3c000
    s_add_u32 s24, s24, 9437184
    s_and_b32 s90, s52, 27
    s_lshl_b32 s90, s90, 5
    s_and_b32 s56, s48, 1
    s_lshl_b32 s56, s56, 4
    s_add_u32 s90, s90, s56
    s_add_u32 s90, s90, 14336
    v_bfe_u32 v41, v2, 2, 1
    v_and_b32 v40, 3, v2
    v_lshl_add_u32 v41, v41, 5, v40
    v_lshlrev_b32 v41, 2, v41
    s_waitcnt lgkmcnt(0)
    s_barrier
    v_cmp_ne_u32 vcc, s44, v42
    s_nop 0
    s_cmp_eq_u64 vcc, 0
    s_cbranch_scc1 L_cfd_24
L_cf_23:
    buffer_load_dword v42, v52, s[4:7], 0 offen sc1
    s_waitcnt vmcnt(0)
    v_cmp_ne_u32 vcc, s44, v42
    s_nop 0
    s_cmp_eq_u64 vcc, 0
    s_cbranch_scc1 L_cfd_24
    s_sleep 2
    s_sub_u32 s100, s100, 1
    s_cbranch_scc0 L_cf_23
    s_mov_b32 s100, 0
L_cfd_24:
    s_lshl_b32 s55, s46, 2
    s_add_u32 s55, s55, 14336
    s_cmp_eq_u32 s47, 0
    s_cselect_b32 s55, s55, 1073741824
    v_mov_b32 v50, s44
    v_mov_b32 v51, 0
    s_mov_b64 exec, 1
    buffer_store_dword v50, v51, s[4:7], s55 offen sc1
    s_mov_b64 exec, -1
    s_mul_i32 s81, s47, 9216
    s_add_u32 s80, s81, s24
    s_add_u32 s80, s80, 0
    s_add_u32 s81, s81, 0
    s_mov_b32 m0, s81
    s_nop 0
    buffer_load_dwordx4 v1, s[4:7], s80 offen offset:0 sc1 lds
    buffer_load_dwordx4 v1, s[4:7], s80 offen offset:1024 sc1 lds
    buffer_load_dwordx4 v1, s[4:7], s80 offen offset:2048 sc1 lds
    ds_read_b128 v[54:57], v9 offset:0
    ds_read_b128 v[58:61], v9 offset:16
    ds_read_b64 v[62:63], v10 offset:0
    s_waitcnt lgkmcnt(0)
    v_lshlrev_b32 v16, 16, v54
    v_and_b32 v17, 0xffff0000, v54
    v_lshlrev_b32 v18, 16, v55
    v_and_b32 v19, 0xffff0000, v55
    v_lshlrev_b32 v20, 16, v56
    v_and_b32 v21, 0xffff0000, v56
    v_lshlrev_b32 v22, 16, v57
    v_and_b32 v23, 0xffff0000, v57
    v_lshlrev_b32 v24, 16, v58
    v_and_b32 v25, 0xffff0000, v58
    v_lshlrev_b32 v26, 16, v59
    v_and_b32 v27, 0xffff0000, v59
    v_lshlrev_b32 v28, 16, v60
    v_and_b32 v29, 0xffff0000, v60
    v_lshlrev_b32 v30, 16, v61
    v_and_b32 v31, 0xffff0000, v61
    v_lshlrev_b32 v32, 16, v62
    v_and_b32 v33, 0xffff0000, v62
    v_lshlrev_b32 v34, 16, v63
    v_and_b32 v35, 0xffff0000, v63
L_vp_25:
    buffer_load_dword v15, v53, s[4:7], s60 offen sc1
    s_waitcnt vmcnt(0)
    v_cmp_ne_u32 vcc, s44, v15
    s_nop 0
    s_cmp_eq_u64 vcc, 0
    s_cbranch_scc1 L_vpd_26
    s_sub_u32 s100, s100, 1
    s_cbranch_scc0 L_vp_25
    s_mov_b32 s100, 0
L_vpd_26:
    buffer_load_dwordx4 v[64:67], v1, s[4:7], s61 offen offset:0 sc1
    buffer_load_dwordx4 v[68:71], v1, s[4:7], s61 offen offset:1024 sc1
    buffer_load_dwordx4 v[72:75], v1, s[4:7], s61 offen offset:2048 sc1
    buffer_load_dwordx4 v[76:79], v1, s[4:7], s61 offen offset:3072 sc1
    s_add_u32 s61, s61, 4096
    buffer_load_dwordx4 v[80:83], v1, s[4:7], s61 offen offset:0 sc1
    buffer_load_dwordx4 v[84:87], v1, s[4:7], s61 offen offset:1024 sc1
    buffer_load_dwordx4 v[88:91], v1, s[4:7], s61 offen offset:2048 sc1
    buffer_load_dwordx4 v[92:95], v1, s[4:7], s61 offen offset:3072 sc1
    s_add_u32 s61, s61, 4096
    s_waitcnt lgkmcnt(0)
    s_barrier
    ds_read_b128 v[144:147], v5 offset:8192
    ds_read_b128 v[148:151], v5 offset:9216
    ds_read_b128 v[152:155], v5 offset:10240
    ds_read_b128 v[156:159], v5 offset:11264
    ds_read_b128 v[160:163], v5 offset:12288
    ds_read_b128 v[164:167], v5 offset:13312
    ds_read_b128 v[168:171], v5 offset:14336
    ds_read_b128 v[172:175], v5 offset:15360
    ds_read_b128 v[176:179], v5 offset:16384
    ds_read_b128 v[180:183], v5 offset:17408
    s_waitcnt vmcnt(7) lgkmcnt(5)
    v_mfma_f32_16x16x32_bf16 v[204:207], v[144:147], v[64:67], 0
    ds_read_b128 v[184:187], v5 offset:18432
    buffer_load_dwordx4 v[96:99], v1, s[4:7], s61 offen offset:0 sc1
    v_mfma_f32_16x16x32_bf16 v[208:211], v[148:151], v[64:67], 0
    ds_read_b128 v[188:191], v5 offset:19456
    v_mfma_f32_16x16x32_bf16 v[212:215], v[152:155], v[64:67], 0
    ds_read_b128 v[192:195], v5 offset:20480
    v_mfma_f32_16x16x32_bf16 v[216:219], v[156:159], v[64:67], 0
    ds_read_b128 v[196:199], v5 offset:21504
    buffer_load_dwordx4 v[100:103], v1, s[4:7], s61 offen offset:1024 sc1
    v_mfma_f32_16x16x32_bf16 v[220:223], v[160:163], v[64:67], 0
    ds_read_b128 v[200:203], v5 offset:22528
    s_waitcnt vmcnt(8) lgkmcnt(5)
    v_mfma_f32_16x16x32_bf16 v[204:207], v[164:167], v[68:71], v[204:207]
    ds_read_b128 v[144:147], v5 offset:23552
    buffer_load_dwordx4 v[104:107], v1, s[4:7], s61 offen offset:2048 sc1
    v_mfma_f32_16x16x32_bf16 v[208:211], v[168:171], v[68:71], v[208:211]
    ds_read_b128 v[148:151], v5 offset:24576
    v_mfma_f32_16x16x32_bf16 v[212:215], v[172:175], v[68:71], v[212:215]
    ds_read_b128 v[152:155], v5 offset:25600
    v_mfma_f32_16x16x32_bf16 v[216:219], v[176:179], v[68:71], v[216:219]
    ds_read_b128 v[156:159], v5 offset:26624
    v_mfma_f32_16x16x32_bf16 v[220:223], v[180:183], v[68:71], v[220:223]
    ds_read_b128 v[160:163], v5 offset:27648
    s_waitcnt vmcnt(8) lgkmcnt(5)
    v_mfma_f32_16x16x32_bf16 v[204:207], v[184:187], v[72:75], v[204:207]
    ds_read_b128 v[164:167], v5 offset:28672
    buffer_load_dwordx4 v[108:111], v1, s[4:7], s61 offen offset:3072 sc1
    s_add_u32 s61, s61, 4096
    v_mfma_f32_16x16x32_bf16 v[208:211], v[188:191], v[72:75], v[208:211]
    ds_read_b128 v[168:171], v5 offset:29696
    v_mfma_f32_16x16x32_bf16 v[212:215], v[192:195], v[72:75], v[212:215]
    ds_read_b128 v[172:175], v5 offset:30720
    v_mfma_f32_16x16x32_bf16 v[216:219], v[196:199], v[72:75], v[216:219]
    ds_read_b128 v[176:179], v5 offset:31744
    buffer_load_dwordx4 v[112:115], v1, s[4:7], s61 offen offset:0 sc1
    v_mfma_f32_16x16x32_bf16 v[220:223], v[200:203], v[72:75], v[220:223]
    ds_read_b128 v[180:183], v5 offset:32768
    s_waitcnt vmcnt(9) lgkmcnt(5)
    v_mfma_f32_16x16x32_bf16 v[204:207], v[144:147], v[76:79], v[204:207]
    ds_read_b128 v[184:187], v5 offset:33792
    buffer_load_dwordx4 v[116:119], v1, s[4:7], s61 offen offset:1024 sc1
    v_mfma_f32_16x16x32_bf16 v[208:211], v[148:151], v[76:79], v[208:211]
    ds_read_b128 v[188:191], v5 offset:34816
    v_mfma_f32_16x16x32_bf16 v[212:215], v[152:155], v[76:79], v[212:215]
    ds_read_b128 v[192:195], v5 offset:35840
    v_mfma_f32_16x16x32_bf16 v[216:219], v[156:159], v[76:79], v[216:219]
    ds_read_b128 v[196:199], v5 offset:36864
    v_mfma_f32_16x16x32_bf16 v[220:223], v[160:163], v[76:79], v[220:223]
    ds_read_b128 v[200:203], v5 offset:37888
    s_waitcnt vmcnt(9) lgkmcnt(5)
    v_mfma_f32_16x16x32_bf16 v[204:207], v[164:167], v[80:83], v[204:207]
    ds_read_b128 v[144:147], v5 offset:38912
    buffer_load_dwordx4 v[120:123], v1, s[4:7], s61 offen offset:2048 sc1
    v_mfma_f32_16x16x32_bf16 v[208:211], v[168:171], v[80:83], v[208:211]
    ds_read_b128 v[148:151], v5 offset:39936
    v_mfma_f32_16x16x32_bf16 v[212:215], v[172:175], v[80:83], v[212:215]
    ds_read_b128 v[152:155], v5 offset:40960
    v_mfma_f32_16x16x32_bf16 v[216:219], v[176:179], v[80:83], v[216:219]
    ds_read_b128 v[156:159], v5 offset:41984
    buffer_load_dwordx4 v[124:127], v1, s[4:7], s61 offen offset:3072 sc1
    s_add_u32 s61, s61, 4096
    v_mfma_f32_16x16x32_bf16 v[220:223], v[180:183], v[80:83], v[220:223]
    ds_read_b128 v[160:163], v5 offset:43008
    s_waitcnt vmcnt(10) lgkmcnt(5)
    v_mfma_f32_16x16x32_bf16 v[204:207], v[184:187], v[84:87], v[204:207]
    ds_read_b128 v[164:167], v5 offset:44032
    buffer_load_dwordx4 v[128:131], v1, s[4:7], s61 offen offset:0 sc1
    v_mfma_f32_16x16x32_bf16 v[208:211], v[188:191], v[84:87], v[208:211]
    ds_read_b128 v[168:171], v5 offset:45056
    v_mfma_f32_16x16x32_bf16 v[212:215], v[192:195], v[84:87], v[212:215]
    ds_read_b128 v[172:175], v5 offset:46080
    v_mfma_f32_16x16x32_bf16 v[216:219], v[196:199], v[84:87], v[216:219]
    ds_read_b128 v[176:179], v5 offset:47104
    v_mfma_f32_16x16x32_bf16 v[220:223], v[200:203], v[84:87], v[220:223]
    ds_read_b128 v[180:183], v5 offset:48128
    s_waitcnt vmcnt(10) lgkmcnt(5)
    v_mfma_f32_16x16x32_bf16 v[204:207], v[144:147], v[88:91], v[204:207]
    ds_read_b128 v[184:187], v5 offset:49152
    buffer_load_dwordx4 v[132:135], v1, s[4:7], s61 offen offset:1024 sc1
    v_mfma_f32_16x16x32_bf16 v[208:211], v[148:151], v[88:91], v[208:211]
    ds_read_b128 v[188:191], v5 offset:50176
    v_mfma_f32_16x16x32_bf16 v[212:215], v[152:155], v[88:91], v[212:215]
    ds_read_b128 v[192:195], v5 offset:51200
    v_mfma_f32_16x16x32_bf16 v[216:219], v[156:159], v[88:91], v[216:219]
    ds_read_b128 v[196:199], v5 offset:52224
    buffer_load_dwordx4 v[136:139], v1, s[4:7], s61 offen offset:2048 sc1
    v_mfma_f32_16x16x32_bf16 v[220:223], v[160:163], v[88:91], v[220:223]
    ds_read_b128 v[200:203], v1 offset:40960
    s_waitcnt vmcnt(11) lgkmcnt(5)
    v_mfma_f32_16x16x32_bf16 v[204:207], v[164:167], v[92:95], v[204:207]
    ds_read_b128 v[144:147], v1 offset:41984
    buffer_load_dwordx4 v[140:143], v1, s[4:7], s61 offen offset:3072 sc1
    v_mfma_f32_16x16x32_bf16 v[208:211], v[168:171], v[92:95], v[208:211]
    ds_read_b128 v[148:151], v1 offset:43008
    v_mfma_f32_16x16x32_bf16 v[212:215], v[172:175], v[92:95], v[212:215]
    ds_read_b128 v[152:155], v1 offset:44032
    v_mfma_f32_16x16x32_bf16 v[216:219], v[176:179], v[92:95], v[216:219]
    ds_read_b128 v[156:159], v1 offset:45056
    v_mfma_f32_16x16x32_bf16 v[220:223], v[180:183], v[92:95], v[220:223]
    ds_read_b128 v[160:163], v1 offset:46080
    buffer_load_dword v40, v41, s[4:7], s90 offen sc1
    s_waitcnt vmcnt(12) lgkmcnt(5)
    v_mfma_f32_16x16x32_bf16 v[204:207], v[184:187], v[96:99], v[204:207]
    ds_read_b128 v[164:167], v1 offset:47104
    buffer_load_dwordx4 v1, s[4:7], s80 offen offset:3072 sc1 lds
    v_mfma_f32_16x16x32_bf16 v[208:211], v[188:191], v[96:99], v[208:211]
    ds_read_b128 v[168:171], v1 offset:48128
    v_mfma_f32_16x16x32_bf16 v[212:215], v[192:195], v[96:99], v[212:215]
    ds_read_b128 v[172:175], v1 offset:49152
    v_mfma_f32_16x16x32_bf16 v[216:219], v[196:199], v[96:99], v[216:219]
    ds_read_b128 v[176:179], v1 offset:50176
    v_mfma_f32_16x16x32_bf16 v[220:223], v[200:203], v[96:99], v[220:223]
    ds_read_b128 v[180:183], v1 offset:51200
    s_waitcnt vmcnt(12) lgkmcnt(5)
    v_mfma_f32_16x16x32_bf16 v[204:207], v[144:147], v[100:103], v[204:207]
    s_add_u32 s80, s80, 4096
    s_add_u32 s81, s81, 4096
    s_mov_b32 m0, s81
    ds_read_b128 v[184:187], v1 offset:52224
    buffer_load_dwordx4 v1, s[4:7], s80 offen offset:0 sc1 lds
    v_mfma_f32_16x16x32_bf16 v[208:211], v[148:151], v[100:103], v[208:211]
    ds_read_b128 v[188:191], v1 offset:53248
    v_mfma_f32_16x16x32_bf16 v[212:215], v[152:155], v[100:103], v[212:215]
    ds_read_b128 v[192:195], v1 offset:54272
    v_mfma_f32_16x16x32_bf16 v[216:219], v[156:159], v[100:103], v[216:219]
    ds_read_b128 v[196:199], v1 offset:55296
    v_mfma_f32_16x16x32_bf16 v[220:223], v[160:163], v[100:103], v[220:223]
    ds_read_b128 v[200:203], v1 offset:56320
    s_waitcnt vmcnt(12) lgkmcnt(5)
    v_mfma_f32_16x16x32_bf16 v[204:207], v[164:167], v[104:107], v[204:207]
    ds_read_b128 v[144:147], v1 offset:57344
    buffer_load_dwordx4 v1, s[4:7], s80 offen offset:1024 sc1 lds
    v_mfma_f32_16x16x32_bf16 v[208:211], v[168:171], v[104:107], v[208:211]
    ds_read_b128 v[148:151], v1 offset:58368
    v_mfma_f32_16x16x32_bf16 v[212:215], v[172:175], v[104:107], v[212:215]
    ds_read_b128 v[152:155], v1 offset:59392
    v_mfma_f32_16x16x32_bf16 v[216:219], v[176:179], v[104:107], v[216:219]
    ds_read_b128 v[156:159], v1 offset:60416
    v_mfma_f32_16x16x32_bf16 v[220:223], v[180:183], v[104:107], v[220:223]
    ds_read_b128 v[160:163], v1 offset:61440
    s_waitcnt vmcnt(12) lgkmcnt(5)
    v_mfma_f32_16x16x32_bf16 v[204:207], v[184:187], v[108:111], v[204:207]
    ds_read_b128 v[164:167], v1 offset:62464
    buffer_load_dwordx4 v1, s[4:7], s80 offen offset:2048 sc1 lds
    v_mfma_f32_16x16x32_bf16 v[208:211], v[188:191], v[108:111], v[208:211]
    ds_read_b128 v[168:171], v1 offset:63488
    v_mfma_f32_16x16x32_bf16 v[212:215], v[192:195], v[108:111], v[212:215]
    ds_read_b128 v[172:175], v1 offset:64512
    v_mfma_f32_16x16x32_bf16 v[216:219], v[196:199], v[108:111], v[216:219]
    ds_read_b128 v[176:179], v5 offset:0
    v_mfma_f32_16x16x32_bf16 v[220:223], v[200:203], v[108:111], v[220:223]
    ds_read_b128 v[180:183], v5 offset:1024
    s_waitcnt vmcnt(12) lgkmcnt(5)
    v_mfma_f32_16x16x32_bf16 v[204:207], v[144:147], v[112:115], v[204:207]
    ds_read_b128 v[184:187], v5 offset:2048
    buffer_load_dwordx4 v1, s[4:7], s80 offen offset:3072 sc1 lds
    v_mfma_f32_16x16x32_bf16 v[208:211], v[148:151], v[112:115], v[208:211]
    ds_read_b128 v[188:191], v5 offset:3072
    v_mfma_f32_16x16x32_bf16 v[212:215], v[152:155], v[112:115], v[212:215]
    ds_read_b128 v[192:195], v5 offset:4096
    v_mfma_f32_16x16x32_bf16 v[216:219], v[156:159], v[112:115], v[216:219]
    ds_read_b128 v[196:199], v5 offset:5120
    v_mfma_f32_16x16x32_bf16 v[220:223], v[160:163], v[112:115], v[220:223]
    ds_read_b128 v[200:203], v5 offset:6144
    s_waitcnt vmcnt(5)
    v_cmp_ne_u32 vcc, s44, v40
    s_nop 0
    s_cmp_eq_u64 vcc, 0
    s_cbranch_scc1 L_cfd_28
L_cf_27:
    buffer_load_dword v40, v41, s[4:7], s90 offen sc1
    s_waitcnt vmcnt(0)
    v_cmp_ne_u32 vcc, s44, v40
    s_nop 0
    s_cmp_eq_u64 vcc, 0
    s_cbranch_scc1 L_cfd_28
    s_sleep 2
    s_sub_u32 s100, s100, 1
    s_cbranch_scc0 L_cf_27
    s_mov_b32 s100, 0
L_cfd_28:
    s_waitcnt lgkmcnt(5)
    v_mfma_f32_16x16x32_bf16 v[204:207], v[164:167], v[116:119], v[204:207]
    s_add_u32 s80, s80, 4096
    s_add_u32 s81, s81, 4096
    s_mov_b32 m0, s81
    ds_read_b128 v[144:147], v5 offset:7168
    buffer_load_dwordx4 v1, s[4:7], s80 offen offset:0 sc1 lds
    v_mfma_f32_16x16x32_bf16 v[208:211], v[168:171], v[116:119], v[208:211]
    ds_read_b128 v[148:151], v5 offset:53248
    v_mfma_f32_16x16x32_bf16 v[212:215], v[172:175], v[116:119], v[212:215]
    ds_read_b128 v[152:155], v5 offset:54272
    v_mfma_f32_16x16x32_bf16 v[216:219], v[176:179], v[116:119], v[216:219]
    ds_read_b128 v[156:159], v5 offset:55296
    v_mfma_f32_16x16x32_bf16 v[220:223], v[180:183], v[116:119], v[220:223]
    ds_read_b128 v[160:163], v5 offset:56320
    s_waitcnt lgkmcnt(5)
    v_mfma_f32_16x16x32_bf16 v[204:207], v[184:187], v[120:123], v[204:207]
    ds_read_b128 v[164:167], v5 offset:57344
    s_and_b32 s3, s48, 1
    s_lshl_b32 s101, s52, 1
    s_lshr_b32 s93, s47, 1
    s_add_u32 s101, s101, s93
    s_lshl_b32 s101, s101, 1
    s_add_u32 s101, s101, s3
    s_lshl_b32 s101, s101, 16
    s_and_b32 s3, s47, 1
    s_lshl_b32 s3, s3, 8
    s_add_u32 s101, s101, s3
    s_xor_b32 s18, s101, 0x100000
    s_add_u32 s17, s101, 26214400
    s_add_u32 s18, s18, 26214400
    s_mul_i32 s16, s53, 0
    v_lshrrev_b32 v254, 4, v2
    v_lshlrev_b32 v254, 9, v254
    v_lshl_add_u32 v254, v11, 4, v254
    s_add_u32 s101, s17, s16
    s_add_u32 s93, s18, s16
    buffer_load_dwordx4 a[0:3], v254, s[4:7], s101 offen offset:0 sc1
    v_mfma_f32_16x16x32_bf16 v[208:211], v[188:191], v[120:123], v[208:211]
    ds_read_b128 v[168:171], v5 offset:58368
    v_mfma_f32_16x16x32_bf16 v[212:215], v[192:195], v[120:123], v[212:215]
    ds_read_b128 v[172:175], v5 offset:59392
    v_mfma_f32_16x16x32_bf16 v[216:219], v[196:199], v[120:123], v[216:219]
    ds_read_b128 v[176:179], v5 offset:60416
    v_mfma_f32_16x16x32_bf16 v[220:223], v[200:203], v[120:123], v[220:223]
    ds_read_b128 v[180:183], v5 offset:61440
    s_waitcnt lgkmcnt(5)
    v_mfma_f32_16x16x32_bf16 v[204:207], v[144:147], v[124:127], v[204:207]
    ds_read_b128 v[184:187], v5 offset:62464
    buffer_load_dwordx4 a[4:7], v254, s[4:7], s93 offen offset:0 sc1
    v_mfma_f32_16x16x32_bf16 v[208:211], v[148:151], v[124:127], v[208:211]
    ds_read_b128 v[188:191], v5 offset:63488
    v_mfma_f32_16x16x32_bf16 v[212:215], v[152:155], v[124:127], v[212:215]
    ds_read_b128 v[192:195], v5 offset:64512
    v_mfma_f32_16x16x32_bf16 v[216:219], v[156:159], v[124:127], v[216:219]
    ds_read_b128 v[196:199], v6 offset:0
    v_mfma_f32_16x16x32_bf16 v[220:223], v[160:163], v[124:127], v[220:223]
    ds_read_b128 v[200:203], v6 offset:1024
    s_waitcnt lgkmcnt(5)
    v_mfma_f32_16x16x32_bf16 v[204:207], v[164:167], v[128:131], v[204:207]
    ds_read_b128 v[144:147], v6 offset:2048
    buffer_load_dwordx4 a[8:11], v254, s[4:7], s101 offen offset:2048 sc1
    v_mfma_f32_16x16x32_bf16 v[208:211], v[168:171], v[128:131], v[208:211]
    ds_read_b128 v[148:151], v6 offset:3072
    v_mfma_f32_16x16x32_bf16 v[212:215], v[172:175], v[128:131], v[212:215]
    ds_read_b128 v[152:155], v6 offset:4096
    v_mfma_f32_16x16x32_bf16 v[216:219], v[176:179], v[128:131], v[216:219]
    ds_read_b128 v[156:159], v6 offset:5120
    v_mfma_f32_16x16x32_bf16 v[220:223], v[180:183], v[128:131], v[220:223]
    ds_read_b128 v[160:163], v6 offset:6144
    s_waitcnt lgkmcnt(5)
    v_mfma_f32_16x16x32_bf16 v[204:207], v[184:187], v[132:135], v[204:207]
    ds_read_b128 v[164:167], v6 offset:7168
    buffer_load_dwordx4 a[12:15], v254, s[4:7], s93 offen offset:2048 sc1
    v_mfma_f32_16x16x32_bf16 v[208:211], v[188:191], v[132:135], v[208:211]
    ds_read_b128 v[168:171], v6 offset:8192
    v_mfma_f32_16x16x32_bf16 v[212:215], v[192:195], v[132:135], v[212:215]
    ds_read_b128 v[172:175], v6 offset:9216
    v_mfma_f32_16x16x32_bf16 v[216:219], v[196:199], v[132:135], v[216:219]
    ds_read_b128 v[176:179], v6 offset:10240
    v_mfma_f32_16x16x32_bf16 v[220:223], v[200:203], v[132:135], v[220:223]
    ds_read_b128 v[180:183], v6 offset:11264
    s_waitcnt lgkmcnt(5)
    v_mfma_f32_16x16x32_bf16 v[204:207], v[144:147], v[136:139], v[204:207]
    s_add_u32 s101, s101, 4096
    s_add_u32 s93, s93, 4096
    buffer_load_dwordx4 a[16:19], v254, s[4:7], s101 offen offset:0 sc1
    v_mfma_f32_16x16x32_bf16 v[208:211], v[148:151], v[136:139], v[208:211]
    v_mfma_f32_16x16x32_bf16 v[212:215], v[152:155], v[136:139], v[212:215]
    v_mfma_f32_16x16x32_bf16 v[216:219], v[156:159], v[136:139], v[216:219]
    v_mfma_f32_16x16x32_bf16 v[220:223], v[160:163], v[136:139], v[220:223]
    s_waitcnt lgkmcnt(0)
    v_mfma_f32_16x16x32_bf16 v[204:207], v[164:167], v[140:143], v[204:207]
    buffer_load_dwordx4 a[20:23], v254, s[4:7], s93 offen offset:0 sc1
    v_mfma_f32_16x16x32_bf16 v[208:211], v[168:171], v[140:143], v[208:211]
    v_mfma_f32_16x16x32_bf16 v[212:215], v[172:175], v[140:143], v[212:215]
    v_mfma_f32_16x16x32_bf16 v[216:219], v[176:179], v[140:143], v[216:219]
    v_mfma_f32_16x16x32_bf16 v[220:223], v[180:183], v[140:143], v[220:223]
    ds_read_b128 v[54:57], v9 offset:576
    ds_read_b128 v[58:61], v9 offset:592
    ds_read_b64 v[62:63], v10 offset:576
    ds_read_b128 v[64:67], v9 offset:288
    ds_read_b128 v[68:71], v9 offset:304
    ds_read_b64 v[72:73], v10 offset:288
    s_barrier
    s_mul_i32 s81, s47, 3072
    s_add_u32 s80, s81, s24
    s_add_u32 s80, s80, 36864
    s_add_u32 s81, s81, 40960
    s_mov_b32 m0, s81
    s_nop 0
    buffer_load_dwordx4 v1, s[4:7], s80 offen offset:0 sc1 lds
    buffer_load_dwordx4 v1, s[4:7], s80 offen offset:1024 sc1 lds
    buffer_load_dwordx4 v1, s[4:7], s80 offen offset:2048 sc1 lds
    v_pk_fma_f32 v[232:233], v[16:17], v[204:205], v[232:233]
    v_pk_fma_f32 v[234:235], v[18:19], v[206:207], v[234:235]
    v_pk_fma_f32 v[236:237], v[20:21], v[208:209], v[236:237]
    v_pk_fma_f32 v[238:239], v[22:23], v[210:211], v[238:239]
    v_pk_fma_f32 v[240:241], v[24:25], v[212:213], v[240:241]
    v_pk_fma_f32 v[242:243], v[26:27], v[214:215], v[242:243]
    v_pk_fma_f32 v[244:245], v[28:29], v[216:217], v[244:245]
    v_pk_fma_f32 v[246:247], v[30:31], v[218:219], v[246:247]
    v_pk_fma_f32 v[248:249], v[32:33], v[220:221], v[248:249]
    v_pk_fma_f32 v[250:251], v[34:35], v[222:223], v[250:251]
    v_pk_add_f32 v[36:37], v[232:233], v[234:235]
    v_pk_mul_f32 v[38:39], v[232:233], v[232:233]
    v_pk_fma_f32 v[38:39], v[234:235], v[234:235], v[38:39]
    v_pk_add_f32 v[36:37], v[36:37], v[236:237]
    v_pk_fma_f32 v[38:39], v[236:237], v[236:237], v[38:39]
    v_pk_add_f32 v[36:37], v[36:37], v[238:239]
    v_pk_fma_f32 v[38:39], v[238:239], v[238:239], v[38:39]
    v_pk_add_f32 v[36:37], v[36:37], v[240:241]
    v_pk_fma_f32 v[38:39], v[240:241], v[240:241], v[38:39]
    v_pk_add_f32 v[36:37], v[36:37], v[242:243]
    v_pk_fma_f32 v[38:39], v[242:243], v[242:243], v[38:39]
    v_pk_add_f32 v[36:37], v[36:37], v[244:245]
    v_pk_fma_f32 v[38:39], v[244:245], v[244:245], v[38:39]
    v_pk_add_f32 v[36:37], v[36:37], v[246:247]
    v_pk_fma_f32 v[38:39], v[246:247], v[246:247], v[38:39]
    v_pk_add_f32 v[36:37], v[36:37], v[248:249]
    v_pk_fma_f32 v[38:39], v[248:249], v[248:249], v[38:39]
    v_pk_add_f32 v[36:37], v[36:37], v[250:251]
    v_pk_fma_f32 v[38:39], v[250:251], v[250:251], v[38:39]
    v_add_f32 v36, v36, v37
    v_add_f32 v38, v38, v39
    s_nop 1
    v_permlane16_swap_b32 v36, v38
    v_add_f32 v36, v36, v38
    v_mov_b32 v38, v36
    s_nop 1
    v_permlane32_swap_b32 v36, v38
    v_add_f32 v36, v36, v38
    v_mov_b32 v37, v36
    s_nop 1
    v_permlane16_swap_b32 v36, v37
    v_mov_b32 v38, s44
    v_mov_b32 v39, 0
    s_mov_b64 exec, 0xffff
    s_cmp_eq_u32 s54, 0
    s_cbranch_scc1 L_glob_29
    buffer_store_dwordx4 v[36:39], v45, s[4:7], s88 offen
L_back_30:
    s_mov_b64 exec, -1
    s_add_u32 s56, s62, 4096
    s_waitcnt lgkmcnt(0)
    v_lshlrev_b32 v76, 16, v54
    v_and_b32 v77, 0xffff0000, v54
    v_lshlrev_b32 v78, 16, v55
    v_and_b32 v79, 0xffff0000, v55
    v_lshlrev_b32 v80, 16, v56
    v_and_b32 v81, 0xffff0000, v56
    v_lshlrev_b32 v82, 16, v57
    v_and_b32 v83, 0xffff0000, v57
    v_lshlrev_b32 v84, 16, v58
    v_and_b32 v85, 0xffff0000, v58
    v_lshlrev_b32 v86, 16, v59
    v_and_b32 v87, 0xffff0000, v59
    v_lshlrev_b32 v88, 16, v60
    v_and_b32 v89, 0xffff0000, v60
    v_lshlrev_b32 v90, 16, v61
    v_and_b32 v91, 0xffff0000, v61
    v_lshlrev_b32 v92, 16, v62
    v_and_b32 v93, 0xffff0000, v62
    v_lshlrev_b32 v94, 16, v63
    v_and_b32 v95, 0xffff0000, v63
    v_lshlrev_b32 v96, 16, v64
    v_and_b32 v97, 0xffff0000, v64
    v_lshlrev_b32 v98, 16, v65
    v_and_b32 v99, 0xffff0000, v65
    v_lshlrev_b32 v100, 16, v66
    v_and_b32 v101, 0xffff0000, v66
    v_lshlrev_b32 v102, 16, v67
    v_and_b32 v103, 0xffff0000, v67
    v_lshlrev_b32 v104, 16, v68
    v_and_b32 v105, 0xffff0000, v68
    v_lshlrev_b32 v106, 16, v69
    v_and_b32 v107, 0xffff0000, v69
    v_lshlrev_b32 v108, 16, v70
    v_and_b32 v109, 0xffff0000, v70
    v_lshlrev_b32 v110, 16, v71
    v_and_b32 v111, 0xffff0000, v71
    v_lshlrev_b32 v112, 16, v72
    v_and_b32 v113, 0xffff0000, v72
    v_lshlrev_b32 v114, 16, v73
    v_and_b32 v115, 0xffff0000, v73
L_st_31:
    buffer_load_dwordx4 v[120:123], v46, s[4:7], s62 offen offset:0 sc1
    buffer_load_dwordx4 v[124:127], v46, s[4:7], s56 offen offset:0 sc1
    s_waitcnt vmcnt(0)
    v_cmp_ne_u32 vcc, s44, v122
    v_cmp_ne_u32 s[98:99], s44, v126
    s_nop 0
    s_or_b64 vcc, vcc, s[98:99]
    s_cmp_eq_u64 vcc, 0
    s_cbranch_scc1 L_std_32
    s_sub_u32 s100, s100, 1
    s_cbranch_scc0 L_st_31
    s_mov_b32 s100, 0
L_std_32:
    v_add_f32 v36, v120, v124
    v_add_f32 v40, v121, v125
    s_nop 1
    v_permlane16_swap_b32 v36, v40
    v_add_f32 v36, v36, v40
    v_mov_b32 v40, v36
    s_nop 1
    v_permlane32_swap_b32 v36, v40
    v_add_f32 v36, v36, v40
    v_mov_b32 v38, v36
    s_nop 1
    v_permlane16_swap_b32 v36, v38
    s_mov_b32 s57, 0x3acccccd
    v_mul_f32 v36, s57, v36
    v_mul_f32 v4, v36, v36
    v_fma_f32 v38, v38, s57, -v4
    v_max_f32 v38, 0, v38
    v_add_f32 v38, 0x3727c5ac, v38
    v_rsq_f32 v38, v38
    s_nop 0
    v_mul_f32 v36, -v36, v38
    v_pk_fma_f32 v[204:205], v[232:233], v[38:39], v[36:37] op_sel_hi:[1,0,0]
    v_pk_fma_f32 v[206:207], v[234:235], v[38:39], v[36:37] op_sel_hi:[1,0,0]
    v_pk_fma_f32 v[208:209], v[236:237], v[38:39], v[36:37] op_sel_hi:[1,0,0]
    v_pk_fma_f32 v[210:211], v[238:239], v[38:39], v[36:37] op_sel_hi:[1,0,0]
    v_pk_fma_f32 v[212:213], v[240:241], v[38:39], v[36:37] op_sel_hi:[1,0,0]
    v_pk_fma_f32 v[214:215], v[242:243], v[38:39], v[36:37] op_sel_hi:[1,0,0]
    v_pk_fma_f32 v[216:217], v[244:245], v[38:39], v[36:37] op_sel_hi:[1,0,0]
    v_pk_fma_f32 v[218:219], v[246:247], v[38:39], v[36:37] op_sel_hi:[1,0,0]
    v_pk_fma_f32 v[220:221], v[248:249], v[38:39], v[36:37] op_sel_hi:[1,0,0]
    v_pk_fma_f32 v[222:223], v[250:251], v[38:39], v[36:37] op_sel_hi:[1,0,0]
    v_pk_fma_f32 v[204:205], v[204:205], v[76:77], v[96:97]
    v_pk_fma_f32 v[206:207], v[206:207], v[78:79], v[98:99]
    v_pk_fma_f32 v[208:209], v[208:209], v[80:81], v[100:101]
    v_pk_fma_f32 v[210:211], v[210:211], v[82:83], v[102:103]
    v_pk_fma_f32 v[212:213], v[212:213], v[84:85], v[104:105]
    v_pk_fma_f32 v[214:215], v[214:215], v[86:87], v[106:107]
    v_pk_fma_f32 v[216:217], v[216:217], v[88:89], v[108:109]
    v_pk_fma_f32 v[218:219], v[218:219], v[90:91], v[110:111]
    v_pk_fma_f32 v[220:221], v[220:221], v[92:93], v[112:113]
    v_pk_fma_f32 v[222:223], v[222:223], v[94:95], v[114:115]
    v_cvt_pk_bf16_f32 v64, v204, v205
    v_cvt_pk_bf16_f32 v65, v206, v207
    v_cvt_pk_bf16_f32 v66, v208, v209
    v_cvt_pk_bf16_f32 v67, v210, v211
    v_cvt_pk_bf16_f32 v68, v212, v213
    v_cvt_pk_bf16_f32 v69, v214, v215
    v_cvt_pk_bf16_f32 v70, v216, v217
    v_cvt_pk_bf16_f32 v71, v218, v219
    v_cvt_pk_bf16_f32 v72, v220, v221
    v_cvt_pk_bf16_f32 v73, v222, v223
    s_cmp_eq_u32 s54, 0
    s_cbranch_scc1 L_glob_33
    buffer_store_dwordx4 v[64:67], v43, s[4:7], s87 offen
    buffer_store_dwordx4 v[68:71], v43, s[4:7], s87 offen offset:256
    buffer_store_dwordx2 v[72:73], v44, s[4:7], s87 offen offset:2048
L_back_34:
    s_lshl_b32 s61, s52, 7
    s_lshl_b32 s56, s47, 5
    s_add_u32 s61, s61, s56
    s_add_u32 s61, s61, 24576
    s_lshl_b32 s56, s53, 2
    s_add_u32 s55, s61, s56
    s_waitcnt vmcnt(0)
    v_mov_b32 v60, s44
    v_mov_b32 v61, 0
    s_mov_b64 exec, 1
    s_cmp_eq_u32 s54, 0
    s_cbranch_scc1 L_glob_35
    buffer_store_dword v60, v61, s[4:7], s55 offen
L_back_36:
    s_mov_b64 exec, -1
    s_mul_i32 s81, s47, 12288
    s_add_u32 s80, s81, s24
    s_add_u32 s80, s80, 49152
    s_add_u32 s81, s81, 53248
    s_mov_b32 m0, s81
    s_nop 0
    buffer_load_dwordx4 v1, s[4:7], s80 offen offset:0 sc1 lds
    buffer_load_dwordx4 v1, s[4:7], s80 offen offset:1024 sc1 lds
    buffer_load_dwordx4 v1, s[4:7], s80 offen offset:2048 sc1 lds
    buffer_load_dwordx4 v1, s[4:7], s80 offen offset:3072 sc1 lds
    s_add_u32 s80, s80, 4096
    s_add_u32 s81, s81, 4096
    s_mov_b32 m0, s81
    s_nop 0
    buffer_load_dwordx4 v1, s[4:7], s80 offen offset:0 sc1 lds
    buffer_load_dwordx4 v1, s[4:7], s80 offen offset:1024 sc1 lds
    buffer_load_dwordx4 v1, s[4:7], s80 offen offset:2048 sc1 lds
    buffer_load_dwordx4 v1, s[4:7], s80 offen offset:3072 sc1 lds
    s_add_u32 s80, s80, 4096
    s_add_u32 s81, s81, 4096
    s_mov_b32 m0, s81
    s_nop 0
    buffer_load_dwordx4 v1, s[4:7], s80 offen offset:0 sc1 lds
    buffer_load_dwordx4 v1, s[4:7], s80 offen offset:1024 sc1 lds
    buffer_load_dwordx4 v1, s[4:7], s80 offen offset:2048 sc1 lds
    buffer_load_dwordx4 v1, s[4:7], s80 offen offset:3072 sc1 lds
    v_and_b32 v15, 7, v2
    v_lshlrev_b32 v4, 2, v15
    s_lshl_b32 s60, s52, 2
    s_add_u32 s60, s60, s47
    s_mul_i32 s59, s60, 3072
    s_mul_i32 s60, s60, 20480
    s_add_u32 s60, s60, 1048576
    v_lshrrev_b32 v12, 4, v2
    v_lshlrev_b32 v12, 6, v12
    v_and_b32 v13, 3, v2
    v_lshl_add_u32 v13, v13, 4, v12
    v_bfe_u32 v14, v2, 3, 1
    v_lshl_add_u32 v14, v14, 4, v12
    v_lshl_add_u32 v14, v15, 10, v14
    s_add_u32 s58, s62, 262144
    s_add_u32 s25, s24, 0x1e000
    s_mul_i32 s87, s53, 393216
    s_add_u32 s87, s87, 19922944
    s_add_u32 s59, s59, s87
    s_lshl_b32 s88, s53, 7
    s_add_u32 s88, s88, 12288
    s_lshl_b32 s56, s52, 2
    s_add_u32 s89, s88, s56
    s_cmp_eq_u32 s47, 0
    s_cselect_b32 s89, s89, 1073741824
L_vp_37:
    buffer_load_dword v63, v4, s[4:7], s61 offen sc1
    s_waitcnt vmcnt(0)
    v_cmp_ne_u32 vcc, s44, v63
    s_nop 0
    s_cmp_eq_u64 vcc, 0
    s_cbranch_scc1 L_vpd_38
    s_sub_u32 s100, s100, 1
    s_cbranch_scc0 L_vp_37
    s_mov_b32 s100, 0
L_vpd_38:
    buffer_load_dwordx4 v[64:67], v1, s[4:7], s60 offen offset:0 sc1
    buffer_load_dwordx4 v[68:71], v1, s[4:7], s60 offen offset:1024 sc1
    buffer_load_dwordx4 v[72:75], v1, s[4:7], s60 offen offset:2048 sc1
    buffer_load_dwordx4 v[76:79], v1, s[4:7], s60 offen offset:3072 sc1
    s_add_u32 s60, s60, 4096
    buffer_load_dwordx4 v[80:83], v1, s[4:7], s60 offen offset:0 sc1
    buffer_load_dwordx4 v[84:87], v1, s[4:7], s60 offen offset:1024 sc1
    buffer_load_dwordx4 v[88:91], v1, s[4:7], s60 offen offset:2048 sc1
    buffer_load_dwordx4 v[92:95], v1, s[4:7], s60 offen offset:3072 sc1
    s_add_u32 s60, s60, 4096
    s_waitcnt lgkmcnt(0)
    s_barrier
    ds_read_b128 v[144:147], v1 offset:0
    ds_read_b128 v[148:151], v1 offset:1024
    ds_read_b128 v[152:155], v1 offset:2048
    ds_read_b128 v[156:159], v1 offset:3072
    ds_read_b128 v[160:163], v1 offset:4096
    ds_read_b128 v[164:167], v1 offset:5120
    ds_read_b128 v[168:171], v1 offset:6144
    ds_read_b128 v[172:175], v1 offset:7168
    ds_read_b128 v[176:179], v1 offset:8192
    ds_read_b128 v[180:183], v1 offset:9216
    ds_read_b128 v[184:187], v1 offset:10240
    ds_read_b128 v[188:191], v1 offset:11264
    s_waitcnt vmcnt(7) lgkmcnt(6)
    v_mfma_f32_16x16x32_bf16 v[16:19], v[64:67], v[144:147], 0
    ds_read_b128 v[192:195], v1 offset:12288
    buffer_load_dwordx4 v[96:99], v1, s[4:7], s60 offen offset:0 sc1
    v_mfma_f32_16x16x32_bf16 v[20:23], v[64:67], v[148:151], 0
    ds_read_b128 v[196:199], v1 offset:13312
    v_mfma_f32_16x16x32_bf16 v[24:27], v[64:67], v[152:155], 0
    ds_read_b128 v[200:203], v1 offset:14336
    v_mfma_f32_16x16x32_bf16 v[28:31], v[64:67], v[156:159], 0
    ds_read_b128 v[204:207], v1 offset:15360
    buffer_load_dwordx4 v[100:103], v1, s[4:7], s60 offen offset:1024 sc1
    v_mfma_f32_16x16x32_bf16 v[32:35], v[64:67], v[160:163], 0
    ds_read_b128 v[208:211], v1 offset:16384
    v_mfma_f32_16x16x32_bf16 v[36:39], v[64:67], v[164:167], 0
    ds_read_b128 v[212:215], v1 offset:17408
    s_waitcnt vmcnt(8) lgkmcnt(6)
    v_mfma_f32_16x16x32_bf16 v[16:19], v[68:71], v[168:171], v[16:19]
    ds_read_b128 v[144:147], v1 offset:18432
    buffer_load_dwordx4 v[104:107], v1, s[4:7], s60 offen offset:2048 sc1
    v_mfma_f32_16x16x32_bf16 v[20:23], v[68:71], v[172:175], v[20:23]
    ds_read_b128 v[148:151], v1 offset:19456
    v_mfma_f32_16x16x32_bf16 v[24:27], v[68:71], v[176:179], v[24:27]
    ds_read_b128 v[152:155], v1 offset:20480
    v_mfma_f32_16x16x32_bf16 v[28:31], v[68:71], v[180:183], v[28:31]
    ds_read_b128 v[156:159], v1 offset:21504
    v_mfma_f32_16x16x32_bf16 v[32:35], v[68:71], v[184:187], v[32:35]
    ds_read_b128 v[160:163], v1 offset:22528
    v_mfma_f32_16x16x32_bf16 v[36:39], v[68:71], v[188:191], v[36:39]
    ds_read_b128 v[164:167], v1 offset:23552
    s_waitcnt vmcnt(8) lgkmcnt(6)
    v_mfma_f32_16x16x32_bf16 v[16:19], v[72:75], v[192:195], v[16:19]
    ds_read_b128 v[168:171], v1 offset:24576
    buffer_load_dwordx4 v[108:111], v1, s[4:7], s60 offen offset:3072 sc1
    s_add_u32 s60, s60, 4096
    v_mfma_f32_16x16x32_bf16 v[20:23], v[72:75], v[196:199], v[20:23]
    ds_read_b128 v[172:175], v1 offset:25600
    v_mfma_f32_16x16x32_bf16 v[24:27], v[72:75], v[200:203], v[24:27]
    ds_read_b128 v[176:179], v1 offset:26624
    v_mfma_f32_16x16x32_bf16 v[28:31], v[72:75], v[204:207], v[28:31]
    ds_read_b128 v[180:183], v1 offset:27648
    buffer_load_dwordx4 v[112:115], v1, s[4:7], s60 offen offset:0 sc1
    v_mfma_f32_16x16x32_bf16 v[32:35], v[72:75], v[208:211], v[32:35]
    ds_read_b128 v[184:187], v1 offset:28672
    v_mfma_f32_16x16x32_bf16 v[36:39], v[72:75], v[212:215], v[36:39]
    ds_read_b128 v[188:191], v1 offset:29696
    s_waitcnt vmcnt(9) lgkmcnt(6)
    v_mfma_f32_16x16x32_bf16 v[16:19], v[76:79], v[144:147], v[16:19]
    ds_read_b128 v[192:195], v1 offset:30720
    buffer_load_dwordx4 v[116:119], v1, s[4:7], s60 offen offset:1024 sc1
    v_mfma_f32_16x16x32_bf16 v[20:23], v[76:79], v[148:151], v[20:23]
    ds_read_b128 v[196:199], v1 offset:31744
    v_mfma_f32_16x16x32_bf16 v[24:27], v[76:79], v[152:155], v[24:27]
    ds_read_b128 v[200:203], v1 offset:32768
    v_mfma_f32_16x16x32_bf16 v[28:31], v[76:79], v[156:159], v[28:31]
    ds_read_b128 v[204:207], v1 offset:33792
    v_mfma_f32_16x16x32_bf16 v[32:35], v[76:79], v[160:163], v[32:35]
    ds_read_b128 v[208:211], v1 offset:34816
    v_mfma_f32_16x16x32_bf16 v[36:39], v[76:79], v[164:167], v[36:39]
    ds_read_b128 v[212:215], v1 offset:35840
    s_waitcnt vmcnt(9) lgkmcnt(6)
    v_mfma_f32_16x16x32_bf16 v[16:19], v[80:83], v[168:171], v[16:19]
    ds_read_b128 v[144:147], v1 offset:40960
    buffer_load_dwordx4 v[120:123], v1, s[4:7], s60 offen offset:2048 sc1
    v_mfma_f32_16x16x32_bf16 v[20:23], v[80:83], v[172:175], v[20:23]
    ds_read_b128 v[148:151], v1 offset:41984
    v_mfma_f32_16x16x32_bf16 v[24:27], v[80:83], v[176:179], v[24:27]
    ds_read_b128 v[152:155], v1 offset:43008
    v_mfma_f32_16x16x32_bf16 v[28:31], v[80:83], v[180:183], v[28:31]
    ds_read_b128 v[156:159], v1 offset:44032
    buffer_load_dwordx4 v[124:127], v1, s[4:7], s60 offen offset:3072 sc1
    s_add_u32 s60, s60, 4096
    v_mfma_f32_16x16x32_bf16 v[32:35], v[80:83], v[184:187], v[32:35]
    ds_read_b128 v[160:163], v1 offset:45056
    v_mfma_f32_16x16x32_bf16 v[36:39], v[80:83], v[188:191], v[36:39]
    ds_read_b128 v[164:167], v1 offset:46080
    s_waitcnt vmcnt(10) lgkmcnt(6)
    v_mfma_f32_16x16x32_bf16 v[16:19], v[84:87], v[192:195], v[16:19]
    ds_read_b128 v[168:171], v1 offset:47104
    buffer_load_dwordx4 v[128:131], v1, s[4:7], s60 offen offset:0 sc1
    v_mfma_f32_16x16x32_bf16 v[20:23], v[84:87], v[196:199], v[20:23]
    ds_read_b128 v[172:175], v1 offset:48128
    v_mfma_f32_16x16x32_bf16 v[24:27], v[84:87], v[200:203], v[24:27]
    ds_read_b128 v[176:179], v1 offset:49152
    v_mfma_f32_16x16x32_bf16 v[28:31], v[84:87], v[204:207], v[28:31]
    ds_read_b128 v[180:183], v1 offset:50176
    v_mfma_f32_16x16x32_bf16 v[32:35], v[84:87], v[208:211], v[32:35]
    ds_read_b128 v[184:187], v1 offset:51200
    v_mfma_f32_16x16x32_bf16 v[36:39], v[84:87], v[212:215], v[36:39]
    ds_read_b128 v[188:191], v1 offset:52224
    s_waitcnt vmcnt(10) lgkmcnt(6)
    v_mfma_f32_16x16x32_bf16 v[16:19], v[88:91], v[144:147], v[16:19]
    ds_read_b128 v[192:195], v1 offset:53248
    buffer_load_dwordx4 v[132:135], v1, s[4:7], s60 offen offset:1024 sc1
    v_mfma_f32_16x16x32_bf16 v[20:23], v[88:91], v[148:151], v[20:23]
    ds_read_b128 v[196:199], v1 offset:54272
    v_mfma_f32_16x16x32_bf16 v[24:27], v[88:91], v[152:155], v[24:27]
    ds_read_b128 v[200:203], v1 offset:55296
    v_mfma_f32_16x16x32_bf16 v[28:31], v[88:91], v[156:159], v[28:31]
    ds_read_b128 v[204:207], v1 offset:56320
    buffer_load_dwordx4 v[136:139], v1, s[4:7], s60 offen offset:2048 sc1
    v_mfma_f32_16x16x32_bf16 v[32:35], v[88:91], v[160:163], v[32:35]
    ds_read_b128 v[208:211], v1 offset:57344
    v_mfma_f32_16x16x32_bf16 v[36:39], v[88:91], v[164:167], v[36:39]
    ds_read_b128 v[212:215], v1 offset:58368
    s_waitcnt vmcnt(11) lgkmcnt(6)
    v_mfma_f32_16x16x32_bf16 v[16:19], v[92:95], v[168:171], v[16:19]
    ds_read_b128 v[144:147], v1 offset:59392
    buffer_load_dwordx4 v[140:143], v1, s[4:7], s60 offen offset:3072 sc1
    v_mfma_f32_16x16x32_bf16 v[20:23], v[92:95], v[172:175], v[20:23]
    ds_read_b128 v[148:151], v1 offset:60416
    v_mfma_f32_16x16x32_bf16 v[24:27], v[92:95], v[176:179], v[24:27]
    ds_read_b128 v[152:155], v1 offset:61440
    v_mfma_f32_16x16x32_bf16 v[28:31], v[92:95], v[180:183], v[28:31]
    s_mul_i32 s81, s47, 6144
    s_add_u32 s80, s81, s24
    s_add_u32 s80, s80, 98304
    s_add_u32 s81, s81, 102400
    s_mov_b32 m0, s81
    ds_read_b128 v[156:159], v1 offset:62464
    buffer_load_dwordx4 v1, s[4:7], s80 offen offset:0 sc1 lds
    v_mfma_f32_16x16x32_bf16 v[32:35], v[92:95], v[184:187], v[32:35]
    ds_read_b128 v[160:163], v1 offset:63488
    v_mfma_f32_16x16x32_bf16 v[36:39], v[92:95], v[188:191], v[36:39]
    ds_read_b128 v[164:167], v1 offset:64512
    s_waitcnt vmcnt(12) lgkmcnt(6)
    v_mfma_f32_16x16x32_bf16 v[16:19], v[96:99], v[192:195], v[16:19]
    ds_read_b128 v[168:171], v5 offset:0
    buffer_load_dwordx4 v1, s[4:7], s80 offen offset:1024 sc1 lds
    v_mfma_f32_16x16x32_bf16 v[20:23], v[96:99], v[196:199], v[20:23]
    ds_read_b128 v[172:175], v5 offset:1024
    v_mfma_f32_16x16x32_bf16 v[24:27], v[96:99], v[200:203], v[24:27]
    ds_read_b128 v[176:179], v5 offset:2048
    v_mfma_f32_16x16x32_bf16 v[28:31], v[96:99], v[204:207], v[28:31]
    ds_read_b128 v[180:183], v5 offset:3072
    buffer_load_dwordx4 v1, s[4:7], s80 offen offset:2048 sc1 lds
    v_mfma_f32_16x16x32_bf16 v[32:35], v[96:99], v[208:211], v[32:35]
    ds_read_b128 v[184:187], v5 offset:4096
    v_mfma_f32_16x16x32_bf16 v[36:39], v[96:99], v[212:215], v[36:39]
    ds_read_b128 v[188:191], v5 offset:5120
    s_waitcnt vmcnt(13) lgkmcnt(6)
    v_mfma_f32_16x16x32_bf16 v[16:19], v[100:103], v[144:147], v[16:19]
    ds_read_b128 v[192:195], v5 offset:6144
    buffer_load_dwordx4 v1, s[4:7], s80 offen offset:3072 sc1 lds
    v_mfma_f32_16x16x32_bf16 v[20:23], v[100:103], v[148:151], v[20:23]
    ds_read_b128 v[196:199], v5 offset:7168
    v_mfma_f32_16x16x32_bf16 v[24:27], v[100:103], v[152:155], v[24:27]
    ds_read_b128 v[200:203], v5 offset:8192
    v_mfma_f32_16x16x32_bf16 v[28:31], v[100:103], v[156:159], v[28:31]
    ds_read_b128 v[204:207], v5 offset:9216
    v_mfma_f32_16x16x32_bf16 v[32:35], v[100:103], v[160:163], v[32:35]
    ds_read_b128 v[208:211], v5 offset:10240
    v_mfma_f32_16x16x32_bf16 v[36:39], v[100:103], v[164:167], v[36:39]
    ds_read_b128 v[212:215], v5 offset:11264
    s_waitcnt vmcnt(13) lgkmcnt(6)
    v_mfma_f32_16x16x32_bf16 v[16:19], v[104:107], v[168:171], v[16:19]
    s_add_u32 s80, s80, 4096
    s_add_u32 s81, s81, 4096
    s_mov_b32 m0, s81
    ds_read_b128 v[144:147], v5 offset:12288
    buffer_load_dwordx4 v1, s[4:7], s80 offen offset:0 sc1 lds
    v_mfma_f32_16x16x32_bf16 v[20:23], v[104:107], v[172:175], v[20:23]
    ds_read_b128 v[148:151], v5 offset:13312
    v_mfma_f32_16x16x32_bf16 v[24:27], v[104:107], v[176:179], v[24:27]
    ds_read_b128 v[152:155], v5 offset:14336
    v_mfma_f32_16x16x32_bf16 v[28:31], v[104:107], v[180:183], v[28:31]
    ds_read_b128 v[156:159], v5 offset:15360
    buffer_load_dwordx4 v1, s[4:7], s80 offen offset:1024 sc1 lds
    v_mfma_f32_16x16x32_bf16 v[32:35], v[104:107], v[184:187], v[32:35]
    ds_read_b128 v[160:163], v5 offset:16384
    v_mfma_f32_16x16x32_bf16 v[36:39], v[104:107], v[188:191], v[36:39]
    ds_read_b128 v[164:167], v5 offset:17408
    s_waitcnt vmcnt(14) lgkmcnt(6)
    v_mfma_f32_16x16x32_bf16 v[16:19], v[108:111], v[192:195], v[16:19]
    s_mul_i32 s81, s47, 6144
    s_add_u32 s80, s81, s25
    s_add_u32 s80, s80, 0
    s_add_u32 s81, s81, 126976
    s_mov_b32 m0, s81
    ds_read_b128 v[168:171], v5 offset:18432
    buffer_load_dwordx4 v1, s[4:7], s80 offen offset:0 sc1 lds
    v_mfma_f32_16x16x32_bf16 v[20:23], v[108:111], v[196:199], v[20:23]
    ds_read_b128 v[172:175], v5 offset:19456
    v_mfma_f32_16x16x32_bf16 v[24:27], v[108:111], v[200:203], v[24:27]
    ds_read_b128 v[176:179], v5 offset:20480
    v_mfma_f32_16x16x32_bf16 v[28:31], v[108:111], v[204:207], v[28:31]
    ds_read_b128 v[180:183], v5 offset:21504
    buffer_load_dwordx4 v1, s[4:7], s80 offen offset:1024 sc1 lds
    v_mfma_f32_16x16x32_bf16 v[32:35], v[108:111], v[208:211], v[32:35]
    ds_read_b128 v[184:187], v5 offset:22528
    v_mfma_f32_16x16x32_bf16 v[36:39], v[108:111], v[212:215], v[36:39]
    ds_read_b128 v[188:191], v5 offset:23552
    s_waitcnt vmcnt(15) lgkmcnt(6)
    v_mfma_f32_16x16x32_bf16 v[16:19], v[112:115], v[144:147], v[16:19]
    ds_read_b128 v[192:195], v5 offset:24576
    buffer_load_dwordx4 v1, s[4:7], s80 offen offset:2048 sc1 lds
    v_mfma_f32_16x16x32_bf16 v[20:23], v[112:115], v[148:151], v[20:23]
    ds_read_b128 v[196:199], v5 offset:25600
    v_mfma_f32_16x16x32_bf16 v[24:27], v[112:115], v[152:155], v[24:27]
    ds_read_b128 v[200:203], v5 offset:26624
    v_mfma_f32_16x16x32_bf16 v[28:31], v[112:115], v[156:159], v[28:31]
    ds_read_b128 v[204:207], v5 offset:27648
    v_mfma_f32_16x16x32_bf16 v[32:35], v[112:115], v[160:163], v[32:35]
    ds_read_b128 v[208:211], v5 offset:28672
    v_mfma_f32_16x16x32_bf16 v[36:39], v[112:115], v[164:167], v[36:39]
    ds_read_b128 v[212:215], v5 offset:29696
    s_waitcnt vmcnt(15) lgkmcnt(6)
    v_mfma_f32_16x16x32_bf16 v[16:19], v[116:119], v[168:171], v[16:19]
    ds_read_b128 v[144:147], v5 offset:30720
    buffer_load_dwordx4 v1, s[4:7], s80 offen offset:3072 sc1 lds
    v_mfma_f32_16x16x32_bf16 v[20:23], v[116:119], v[172:175], v[20:23]
    ds_read_b128 v[148:151], v5 offset:31744
    v_mfma_f32_16x16x32_bf16 v[24:27], v[116:119], v[176:179], v[24:27]
    ds_read_b128 v[152:155], v5 offset:32768
    v_mfma_f32_16x16x32_bf16 v[28:31], v[116:119], v[180:183], v[28:31]
    s_add_u32 s80, s80, 4096
    s_add_u32 s81, s81, 4096
    s_mov_b32 m0, s81
    ds_read_b128 v[156:159], v5 offset:33792
    buffer_load_dwordx4 v1, s[4:7], s80 offen offset:0 sc1 lds
    v_mfma_f32_16x16x32_bf16 v[32:35], v[116:119], v[184:187], v[32:35]
    ds_read_b128 v[160:163], v5 offset:34816
    v_mfma_f32_16x16x32_bf16 v[36:39], v[116:119], v[188:191], v[36:39]
    ds_read_b128 v[164:167], v5 offset:35840
    s_waitcnt vmcnt(5)
    s_barrier
    s_waitcnt lgkmcnt(6)
    v_mfma_f32_16x16x32_bf16 v[16:19], v[120:123], v[192:195], v[16:19]
    ds_read_b128 v[168:171], v5 offset:36864
    buffer_load_dwordx4 v1, s[4:7], s80 offen offset:1024 sc1 lds
    v_mfma_f32_16x16x32_bf16 v[20:23], v[120:123], v[196:199], v[20:23]
    ds_read_b128 v[172:175], v5 offset:37888
    v_mfma_f32_16x16x32_bf16 v[24:27], v[120:123], v[200:203], v[24:27]
    ds_read_b128 v[176:179], v5 offset:38912
    v_mfma_f32_16x16x32_bf16 v[28:31], v[120:123], v[204:207], v[28:31]
    ds_read_b128 v[180:183], v5 offset:39936
    buffer_load_dwordx4 a[24:27], v254, s[4:7], s101 offen offset:2048 sc1
    v_mfma_f32_16x16x32_bf16 v[32:35], v[120:123], v[208:211], v[32:35]
    ds_read_b128 v[184:187], v5 offset:40960
    v_mfma_f32_16x16x32_bf16 v[36:39], v[120:123], v[212:215], v[36:39]
    ds_read_b128 v[188:191], v5 offset:41984
    s_waitcnt lgkmcnt(6)
    v_mfma_f32_16x16x32_bf16 v[16:19], v[124:127], v[144:147], v[16:19]
    ds_read_b128 v[192:195], v5 offset:43008
    buffer_load_dwordx4 a[28:31], v254, s[4:7], s93 offen offset:2048 sc1
    v_mfma_f32_16x16x32_bf16 v[20:23], v[124:127], v[148:151], v[20:23]
    ds_read_b128 v[196:199], v5 offset:44032
    v_mfma_f32_16x16x32_bf16 v[24:27], v[124:127], v[152:155], v[24:27]
    ds_read_b128 v[200:203], v5 offset:45056
    v_mfma_f32_16x16x32_bf16 v[28:31], v[124:127], v[156:159], v[28:31]
    ds_read_b128 v[204:207], v5 offset:46080
    v_mfma_f32_16x16x32_bf16 v[32:35], v[124:127], v[160:163], v[32:35]
    ds_read_b128 v[208:211], v5 offset:47104
    v_mfma_f32_16x16x32_bf16 v[36:39], v[124:127], v[164:167], v[36:39]
    ds_read_b128 v[212:215], v5 offset:48128
    s_waitcnt lgkmcnt(6)
    v_mfma_f32_16x16x32_bf16 v[16:19], v[128:131], v[168:171], v[16:19]
    ds_read_b128 v[144:147], v5 offset:49152
    s_add_u32 s101, s101, 4096
    s_add_u32 s93, s93, 4096
    buffer_load_dwordx4 a[32:35], v254, s[4:7], s101 offen offset:0 sc1
    v_mfma_f32_16x16x32_bf16 v[20:23], v[128:131], v[172:175], v[20:23]
    ds_read_b128 v[148:151], v5 offset:50176
    v_mfma_f32_16x16x32_bf16 v[24:27], v[128:131], v[176:179], v[24:27]
    ds_read_b128 v[152:155], v5 offset:51200
    v_mfma_f32_16x16x32_bf16 v[28:31], v[128:131], v[180:183], v[28:31]
    ds_read_b128 v[156:159], v5 offset:52224
    buffer_load_dwordx4 a[36:39], v254, s[4:7], s93 offen offset:0 sc1
    v_mfma_f32_16x16x32_bf16 v[32:35], v[128:131], v[184:187], v[32:35]
    ds_read_b128 v[160:163], v5 offset:53248
    v_mfma_f32_16x16x32_bf16 v[36:39], v[128:131], v[188:191], v[36:39]
    ds_read_b128 v[164:167], v5 offset:54272
    s_waitcnt lgkmcnt(6)
    v_mfma_f32_16x16x32_bf16 v[16:19], v[132:135], v[192:195], v[16:19]
    ds_read_b128 v[168:171], v5 offset:55296
    buffer_load_dwordx4 a[40:43], v254, s[4:7], s101 offen offset:2048 sc1
    v_mfma_f32_16x16x32_bf16 v[20:23], v[132:135], v[196:199], v[20:23]
    ds_read_b128 v[172:175], v5 offset:56320
    v_mfma_f32_16x16x32_bf16 v[24:27], v[132:135], v[200:203], v[24:27]
    ds_read_b128 v[176:179], v5 offset:57344
    v_mfma_f32_16x16x32_bf16 v[28:31], v[132:135], v[204:207], v[28:31]
    ds_read_b128 v[180:183], v5 offset:58368
    buffer_load_dwordx4 a[44:47], v254, s[4:7], s93 offen offset:2048 sc1
    v_mfma_f32_16x16x32_bf16 v[32:35], v[132:135], v[208:211], v[32:35]
    ds_read_b128 v[184:187], v5 offset:59392
    v_mfma_f32_16x16x32_bf16 v[36:39], v[132:135], v[212:215], v[36:39]
    ds_read_b128 v[188:191], v5 offset:60416
    s_waitcnt lgkmcnt(6)
    v_mfma_f32_16x16x32_bf16 v[16:19], v[136:139], v[144:147], v[16:19]
    s_add_u32 s101, s101, 4096
    s_add_u32 s93, s93, 4096
    buffer_load_dwordx4 a[48:51], v254, s[4:7], s101 offen offset:0 sc1
    v_mfma_f32_16x16x32_bf16 v[20:23], v[136:139], v[148:151], v[20:23]
    v_mfma_f32_16x16x32_bf16 v[24:27], v[136:139], v[152:155], v[24:27]
    v_mfma_f32_16x16x32_bf16 v[28:31], v[136:139], v[156:159], v[28:31]
    v_mfma_f32_16x16x32_bf16 v[32:35], v[136:139], v[160:163], v[32:35]
    v_mfma_f32_16x16x32_bf16 v[36:39], v[136:139], v[164:167], v[36:39]
    s_waitcnt lgkmcnt(0)
    v_mfma_f32_16x16x32_bf16 v[16:19], v[140:143], v[168:171], v[16:19]
    buffer_load_dwordx4 a[52:55], v254, s[4:7], s93 offen offset:0 sc1
    v_mfma_f32_16x16x32_bf16 v[20:23], v[140:143], v[172:175], v[20:23]
    v_mfma_f32_16x16x32_bf16 v[24:27], v[140:143], v[176:179], v[24:27]
    v_mfma_f32_16x16x32_bf16 v[28:31], v[140:143], v[180:183], v[28:31]
    buffer_load_dwordx4 a[56:59], v254, s[4:7], s101 offen offset:2048 sc1
    v_mfma_f32_16x16x32_bf16 v[32:35], v[140:143], v[184:187], v[32:35]
    v_mfma_f32_16x16x32_bf16 v[36:39], v[140:143], v[188:191], v[36:39]
    buffer_load_dwordx4 a[60:63], v254, s[4:7], s93 offen offset:2048 sc1
    s_barrier
    s_mov_b32 s0, 0xbdd2d3e8
    s_mov_b32 s1, s0
    v_mov_b32 v252, 0xc0135761
    s_mul_i32 s81, s47, 10240
    s_add_u32 s80, s81, s25
    s_add_u32 s80, s80, 24576
    s_add_u32 s81, s81, 0
    s_mov_b32 m0, s81
    v_pk_mul_f32 v[144:145], v[16:17], v[16:17]
    buffer_load_dwordx4 v1, s[4:7], s80 offen offset:0 sc1 lds
    v_pk_mul_f32 v[146:147], v[18:19], v[18:19]
    v_pk_mul_f32 v[148:149], v[20:21], v[20:21]
    v_pk_mul_f32 v[150:151], v[22:23], v[22:23]
    buffer_load_dwordx4 v1, s[4:7], s80 offen offset:1024 sc1 lds
    v_pk_mul_f32 v[152:153], v[24:25], v[24:25]
    v_pk_mul_f32 v[154:155], v[26:27], v[26:27]
    v_pk_mul_f32 v[156:157], v[28:29], v[28:29]
    buffer_load_dwordx4 v1, s[4:7], s80 offen offset:2048 sc1 lds
    v_pk_mul_f32 v[158:159], v[30:31], v[30:31]
    v_pk_mul_f32 v[160:161], v[32:33], v[32:33]
    v_pk_mul_f32 v[162:163], v[34:35], v[34:35]
    buffer_load_dwordx4 v1, s[4:7], s80 offen offset:3072 sc1 lds
    v_pk_mul_f32 v[164:165], v[36:37], v[36:37]
    v_pk_mul_f32 v[166:167], v[38:39], v[38:39]
    v_pk_fma_f32 v[144:145], v[144:145], s[0:1], v[252:253] op_sel_hi:[1,1,0]
    v_pk_fma_f32 v[146:147], v[146:147], s[0:1], v[252:253] op_sel_hi:[1,1,0]
    v_pk_fma_f32 v[148:149], v[148:149], s[0:1], v[252:253] op_sel_hi:[1,1,0]
    v_pk_fma_f32 v[150:151], v[150:151], s[0:1], v[252:253] op_sel_hi:[1,1,0]
    v_pk_fma_f32 v[152:153], v[152:153], s[0:1], v[252:253] op_sel_hi:[1,1,0]
    v_pk_fma_f32 v[154:155], v[154:155], s[0:1], v[252:253] op_sel_hi:[1,1,0]
    v_pk_fma_f32 v[156:157], v[156:157], s[0:1], v[252:253] op_sel_hi:[1,1,0]
    v_pk_fma_f32 v[158:159], v[158:159], s[0:1], v[252:253] op_sel_hi:[1,1,0]
    v_pk_fma_f32 v[160:161], v[160:161], s[0:1], v[252:253] op_sel_hi:[1,1,0]
    v_pk_fma_f32 v[162:163], v[162:163], s[0:1], v[252:253] op_sel_hi:[1,1,0]
    v_pk_fma_f32 v[164:165], v[164:165], s[0:1], v[252:253] op_sel_hi:[1,1,0]
    v_pk_fma_f32 v[166:167], v[166:167], s[0:1], v[252:253] op_sel_hi:[1,1,0]
    v_pk_mul_f32 v[144:145], v[144:145], v[16:17]
    v_pk_mul_f32 v[146:147], v[146:147], v[18:19]
    v_pk_mul_f32 v[148:149], v[148:149], v[20:21]
    v_pk_mul_f32 v[150:151], v[150:151], v[22:23]
    v_pk_mul_f32 v[152:153], v[152:153], v[24:25]
    v_pk_mul_f32 v[154:155], v[154:155], v[26:27]
    v_pk_mul_f32 v[156:157], v[156:157], v[28:29]
    v_pk_mul_f32 v[158:159], v[158:159], v[30:31]
    v_pk_mul_f32 v[160:161], v[160:161], v[32:33]
    v_pk_mul_f32 v[162:163], v[162:163], v[34:35]
    v_pk_mul_f32 v[164:165], v[164:165], v[36:37]
    v_pk_mul_f32 v[166:167], v[166:167], v[38:39]
    s_add_u32 s80, s80, 4096
    s_add_u32 s81, s81, 4096
    s_mov_b32 m0, s81
    v_exp_f32 v144, v144
    buffer_load_dwordx4 v1, s[4:7], s80 offen offset:0 sc1 lds
    v_exp_f32 v145, v145
    v_exp_f32 v146, v146
    v_exp_f32 v147, v147
    buffer_load_dwordx4 v1, s[4:7], s80 offen offset:1024 sc1 lds
    v_exp_f32 v148, v148
    v_exp_f32 v149, v149
    v_exp_f32 v150, v150
    buffer_load_dwordx4 v1, s[4:7], s80 offen offset:2048 sc1 lds
    v_exp_f32 v151, v151
    v_exp_f32 v152, v152
    v_exp_f32 v153, v153
    buffer_load_dwordx4 v1, s[4:7], s80 offen offset:3072 sc1 lds
    v_exp_f32 v154, v154
    v_exp_f32 v155, v155
    s_add_u32 s80, s80, 4096
    s_add_u32 s81, s81, 4096
    s_mov_b32 m0, s81
    v_exp_f32 v156, v156
    buffer_load_dwordx4 v1, s[4:7], s80 offen offset:0 sc1 lds
    v_exp_f32 v157, v157
    v_exp_f32 v158, v158
    v_exp_f32 v159, v159
    buffer_load_dwordx4 v1, s[4:7], s80 offen offset:1024 sc1 lds
    v_exp_f32 v160, v160
    v_exp_f32 v161, v161
    s_mul_i32 s81, s47, 6144
    s_add_u32 s80, s81, s25
    s_add_u32 s80, s80, 65536
    s_add_u32 s81, s81, 40960
    s_mov_b32 m0, s81
    v_exp_f32 v162, v162
    buffer_load_dwordx4 v1, s[4:7], s80 offen offset:0 sc1 lds
    v_exp_f32 v163, v163
    v_exp_f32 v164, v164
    v_exp_f32 v165, v165
    buffer_load_dwordx4 v1, s[4:7], s80 offen offset:1024 sc1 lds
    v_exp_f32 v166, v166
    v_exp_f32 v167, v167
    v_pk_add_f32 v[144:145], v[144:145], 1.0 op_sel_hi:[1,0]
    v_pk_add_f32 v[146:147], v[146:147], 1.0 op_sel_hi:[1,0]
    v_pk_add_f32 v[148:149], v[148:149], 1.0 op_sel_hi:[1,0]
    v_pk_add_f32 v[150:151], v[150:151], 1.0 op_sel_hi:[1,0]
    v_pk_add_f32 v[152:153], v[152:153], 1.0 op_sel_hi:[1,0]
    v_pk_add_f32 v[154:155], v[154:155], 1.0 op_sel_hi:[1,0]
    v_pk_add_f32 v[156:157], v[156:157], 1.0 op_sel_hi:[1,0]
    v_pk_add_f32 v[158:159], v[158:159], 1.0 op_sel_hi:[1,0]
    v_pk_add_f32 v[160:161], v[160:161], 1.0 op_sel_hi:[1,0]
    v_pk_add_f32 v[162:163], v[162:163], 1.0 op_sel_hi:[1,0]
    v_pk_add_f32 v[164:165], v[164:165], 1.0 op_sel_hi:[1,0]
    v_pk_add_f32 v[166:167], v[166:167], 1.0 op_sel_hi:[1,0]
    v_rcp_f32 v144, v144
    buffer_load_dwordx4 v1, s[4:7], s80 offen offset:2048 sc1 lds
    v_rcp_f32 v145, v145
    v_rcp_f32 v146, v146
    v_rcp_f32 v147, v147
    buffer_load_dwordx4 v1, s[4:7], s80 offen offset:3072 sc1 lds
    v_rcp_f32 v148, v148
    v_rcp_f32 v149, v149
    s_add_u32 s80, s80, 4096
    s_add_u32 s81, s81, 4096
    s_mov_b32 m0, s81
    v_rcp_f32 v150, v150
    buffer_load_dwordx4 v1, s[4:7], s80 offen offset:0 sc1 lds
    v_rcp_f32 v151, v151
    v_rcp_f32 v152, v152
    v_rcp_f32 v153, v153
    buffer_load_dwordx4 v1, s[4:7], s80 offen offset:1024 sc1 lds
    v_rcp_f32 v154, v154
    v_rcp_f32 v155, v155
    v_rcp_f32 v156, v156
    v_rcp_f32 v157, v157
    v_rcp_f32 v158, v158
    v_rcp_f32 v159, v159
    v_rcp_f32 v160, v160
    v_rcp_f32 v161, v161
    v_rcp_f32 v162, v162
    v_rcp_f32 v163, v163
    v_rcp_f32 v164, v164
    v_rcp_f32 v165, v165
    v_rcp_f32 v166, v166
    v_rcp_f32 v167, v167
    v_pk_mul_f32 v[16:17], v[16:17], v[144:145]
    v_pk_mul_f32 v[18:19], v[18:19], v[146:147]
    v_pk_mul_f32 v[20:21], v[20:21], v[148:149]
    v_pk_mul_f32 v[22:23], v[22:23], v[150:151]
    v_pk_mul_f32 v[24:25], v[24:25], v[152:153]
    v_pk_mul_f32 v[26:27], v[26:27], v[154:155]
    v_pk_mul_f32 v[28:29], v[28:29], v[156:157]
    v_pk_mul_f32 v[30:31], v[30:31], v[158:159]
    v_pk_mul_f32 v[32:33], v[32:33], v[160:161]
    v_pk_mul_f32 v[34:35], v[34:35], v[162:163]
    v_pk_mul_f32 v[36:37], v[36:37], v[164:165]
    v_pk_mul_f32 v[38:39], v[38:39], v[166:167]
    v_pk_add_f32 v[40:41], v[16:17], v[20:21]
    v_pk_add_f32 v[42:43], v[18:19], v[22:23]
    v_pk_mul_f32 v[44:45], v[16:17], v[16:17]
    v_pk_mul_f32 v[46:47], v[18:19], v[18:19]
    v_pk_fma_f32 v[44:45], v[20:21], v[20:21], v[44:45]
    v_pk_fma_f32 v[46:47], v[22:23], v[22:23], v[46:47]
    v_pk_add_f32 v[40:41], v[40:41], v[24:25]
    v_pk_add_f32 v[42:43], v[42:43], v[26:27]
    v_pk_fma_f32 v[44:45], v[24:25], v[24:25], v[44:45]
    v_pk_fma_f32 v[46:47], v[26:27], v[26:27], v[46:47]
    v_pk_add_f32 v[40:41], v[40:41], v[28:29]
    v_pk_add_f32 v[42:43], v[42:43], v[30:31]
    v_pk_fma_f32 v[44:45], v[28:29], v[28:29], v[44:45]
    v_pk_fma_f32 v[46:47], v[30:31], v[30:31], v[46:47]
    v_pk_add_f32 v[40:41], v[40:41], v[32:33]
    v_pk_add_f32 v[42:43], v[42:43], v[34:35]
    v_pk_fma_f32 v[44:45], v[32:33], v[32:33], v[44:45]
    v_pk_fma_f32 v[46:47], v[34:35], v[34:35], v[46:47]
    v_pk_add_f32 v[40:41], v[40:41], v[36:37]
    v_pk_add_f32 v[42:43], v[42:43], v[38:39]
    v_pk_fma_f32 v[44:45], v[36:37], v[36:37], v[44:45]
    v_pk_fma_f32 v[46:47], v[38:39], v[38:39], v[46:47]
    s_mov_b32 vcc_lo, 0xaaaaaaaa
    s_mov_b32 vcc_hi, 0xaaaaaaaa
    v_cndmask_b32 v52, v41, v40, vcc
    v_cndmask_b32 v40, v40, v41, vcc
    v_cndmask_b32 v54, v43, v42, vcc
    v_cndmask_b32 v42, v42, v43, vcc
    v_cndmask_b32 v56, v45, v44, vcc
    v_cndmask_b32 v44, v44, v45, vcc
    v_cndmask_b32 v58, v47, v46, vcc
    v_cndmask_b32 v46, v46, v47, vcc
    v_add_f32_dpp v40, v52, v40 quad_perm:[1,0,3,2] row_mask:0xf bank_mask:0xf
    v_add_f32_dpp v42, v54, v42 quad_perm:[1,0,3,2] row_mask:0xf bank_mask:0xf
    v_add_f32_dpp v44, v56, v44 quad_perm:[1,0,3,2] row_mask:0xf bank_mask:0xf
    v_add_f32_dpp v46, v58, v46 quad_perm:[1,0,3,2] row_mask:0xf bank_mask:0xf
    s_mov_b32 vcc_lo, 0xcccccccc
    s_mov_b32 vcc_hi, 0xcccccccc
    v_cndmask_b32 v52, v42, v40, vcc
    v_cndmask_b32 v48, v40, v42, vcc
    v_cndmask_b32 v56, v46, v44, vcc
    v_cndmask_b32 v49, v44, v46, vcc
    v_add_f32_dpp v48, v52, v48 quad_perm:[2,3,0,1] row_mask:0xf bank_mask:0xf
    s_nop 0
    v_add_f32_dpp v49, v56, v49 quad_perm:[2,3,0,1] row_mask:0xf bank_mask:0xf
    v_add_f32_dpp v48, v48, v48 row_ror:4 row_mask:0xf bank_mask:0xf
    s_nop 0
    v_add_f32_dpp v49, v49, v49 row_ror:4 row_mask:0xf bank_mask:0xf
    v_add_f32_dpp v48, v48, v48 row_ror:8 row_mask:0xf bank_mask:0xf
    s_nop 0
    v_add_f32_dpp v49, v49, v49 row_ror:8 row_mask:0xf bank_mask:0xf
    v_mov_b32 v50, s44
    v_mov_b32 v51, 0
    s_mov_b32 exec_lo, 0x000f000f
    s_mov_b32 exec_hi, 0x000f000f
    s_cmp_eq_u32 s54, 0
    s_cbranch_scc1 L_glob_39
    buffer_store_dwordx4 v[48:51], v13, s[4:7], s84 offen
L_back_40:
    s_mov_b64 exec, -1
    s_mov_b32 s8, s30
    s_mov_b32 s9, s31
    s_mov_b32 s10, 4096
    s_mov_b32 s11, s96
    s_lshl_b32 s55, s52, 7
    s_lshl_b32 s56, s47, 5
    s_add_u32 s55, s55, s56
    s_and_b32 s56, s48, 1
    s_lshl_b32 s56, s56, 6
    s_add_u32 s88, s88, s56
    v_lshlrev_b32 v4, 1, v11
    s_waitcnt vmcnt(1)
    s_barrier
    buffer_load_dwordx4 v[216:219], v14, s[4:7], s58 offen offset:0 sc1
    buffer_load_dwordx4 v[220:223], v14, s[4:7], s58 offen offset:32 sc1
    buffer_load_ushort v253, v4, s[8:11], s55 offen
    ds_read_b128 v[144:147], v5 offset:61440
    ds_read_b128 v[148:151], v5 offset:62464
    ds_read_b128 v[152:155], v5 offset:63488
    ds_read_b128 v[156:159], v5 offset:64512
    ds_read_b128 v[160:163], v6 offset:0
    ds_read_b128 v[164:167], v6 offset:1024
    ds_read_b128 v[168:171], v6 offset:2048
    ds_read_b128 v[172:175], v6 offset:3072
    ds_read_b128 v[176:179], v6 offset:4096
    ds_read_b128 v[180:183], v6 offset:5120
    ds_read_b128 v[184:187], v6 offset:6144
    ds_read_b128 v[188:191], v6 offset:7168
    s_waitcnt lgkmcnt(6)
    v_mfma_f32_16x16x32_bf16 v[40:43], v[144:147], v[64:67], 0
    s_mul_i32 s81, s47, 8192
    s_add_u32 s80, s81, s25
    s_add_u32 s80, s80, 90112
    s_add_u32 s81, s81, 65536
    s_mov_b32 m0, s81
    ds_read_b128 v[192:195], v6 offset:8192
    buffer_load_dwordx4 v1, s[4:7], s80 offen offset:0 sc1 lds
    v_mfma_f32_16x16x32_bf16 v[44:47], v[148:151], v[64:67], 0
    ds_read_b128 v[196:199], v6 offset:9216
    v_mfma_f32_16x16x32_bf16 v[48:51], v[152:155], v[64:67], 0
    ds_read_b128 v[200:203], v6 offset:10240
    v_mfma_f32_16x16x32_bf16 v[52:55], v[156:159], v[64:67], 0
    ds_read_b128 v[204:207], v6 offset:11264
    v_mfma_f32_16x16x32_bf16 v[56:59], v[160:163], v[64:67], 0
    ds_read_b128 v[208:211], v6 offset:12288
    v_mfma_f32_16x16x32_bf16 v[60:63], v[164:167], v[64:67], 0
    ds_read_b128 v[212:215], v6 offset:13312
    s_waitcnt lgkmcnt(6)
    v_mfma_f32_16x16x32_bf16 v[40:43], v[168:171], v[68:71], v[40:43]
    ds_read_b128 v[144:147], v6 offset:14336
    buffer_load_dwordx4 v1, s[4:7], s80 offen offset:1024 sc1 lds
    v_mfma_f32_16x16x32_bf16 v[44:47], v[172:175], v[68:71], v[44:47]
    ds_read_b128 v[148:151], v6 offset:15360
    v_mfma_f32_16x16x32_bf16 v[48:51], v[176:179], v[68:71], v[48:51]
    ds_read_b128 v[152:155], v6 offset:16384
    v_mfma_f32_16x16x32_bf16 v[52:55], v[180:183], v[68:71], v[52:55]
    ds_read_b128 v[156:159], v6 offset:17408
    buffer_load_dwordx4 v1, s[4:7], s80 offen offset:2048 sc1 lds
    v_mfma_f32_16x16x32_bf16 v[56:59], v[184:187], v[68:71], v[56:59]
    ds_read_b128 v[160:163], v6 offset:18432
    v_mfma_f32_16x16x32_bf16 v[60:63], v[188:191], v[68:71], v[60:63]
    ds_read_b128 v[164:167], v6 offset:19456
    s_waitcnt lgkmcnt(6)
    v_mfma_f32_16x16x32_bf16 v[40:43], v[192:195], v[72:75], v[40:43]
    ds_read_b128 v[168:171], v1 offset:0
    buffer_load_dwordx4 v1, s[4:7], s80 offen offset:3072 sc1 lds
    v_mfma_f32_16x16x32_bf16 v[44:47], v[196:199], v[72:75], v[44:47]
    ds_read_b128 v[172:175], v1 offset:1024
    v_mfma_f32_16x16x32_bf16 v[48:51], v[200:203], v[72:75], v[48:51]
    ds_read_b128 v[176:179], v1 offset:2048
    v_mfma_f32_16x16x32_bf16 v[52:55], v[204:207], v[72:75], v[52:55]
    s_add_u32 s80, s80, 4096
    s_add_u32 s81, s81, 4096
    s_mov_b32 m0, s81
    ds_read_b128 v[180:183], v1 offset:3072
    buffer_load_dwordx4 v1, s[4:7], s80 offen offset:0 sc1 lds
    v_mfma_f32_16x16x32_bf16 v[56:59], v[208:211], v[72:75], v[56:59]
    ds_read_b128 v[184:187], v1 offset:4096
    v_mfma_f32_16x16x32_bf16 v[60:63], v[212:215], v[72:75], v[60:63]
    ds_read_b128 v[188:191], v1 offset:5120
    s_waitcnt lgkmcnt(6)
    v_mfma_f32_16x16x32_bf16 v[40:43], v[144:147], v[76:79], v[40:43]
    ds_read_b128 v[192:195], v1 offset:6144
    buffer_load_dwordx4 v1, s[4:7], s80 offen offset:1024 sc1 lds
    v_mfma_f32_16x16x32_bf16 v[44:47], v[148:151], v[76:79], v[44:47]
    ds_read_b128 v[196:199], v1 offset:7168
    v_mfma_f32_16x16x32_bf16 v[48:51], v[152:155], v[76:79], v[48:51]
    ds_read_b128 v[200:203], v1 offset:8192
    v_mfma_f32_16x16x32_bf16 v[52:55], v[156:159], v[76:79], v[52:55]
    ds_read_b128 v[204:207], v1 offset:9216
    v_mfma_f32_16x16x32_bf16 v[56:59], v[160:163], v[76:79], v[56:59]
    ds_read_b128 v[208:211], v1 offset:10240
    v_mfma_f32_16x16x32_bf16 v[60:63], v[164:167], v[76:79], v[60:63]
    ds_read_b128 v[212:215], v1 offset:11264
    s_waitcnt lgkmcnt(6)
    v_mfma_f32_16x16x32_bf16 v[40:43], v[168:171], v[80:83], v[40:43]
    ds_read_b128 v[144:147], v1 offset:12288
    buffer_load_dwordx4 v1, s[4:7], s80 offen offset:2048 sc1 lds
    v_mfma_f32_16x16x32_bf16 v[44:47], v[172:175], v[80:83], v[44:47]
    ds_read_b128 v[148:151], v1 offset:13312
    v_mfma_f32_16x16x32_bf16 v[48:51], v[176:179], v[80:83], v[48:51]
    ds_read_b128 v[152:155], v1 offset:14336
    v_mfma_f32_16x16x32_bf16 v[52:55], v[180:183], v[80:83], v[52:55]
    ds_read_b128 v[156:159], v1 offset:15360
    buffer_load_dwordx4 v1, s[4:7], s80 offen offset:3072 sc1 lds
    v_mfma_f32_16x16x32_bf16 v[56:59], v[184:187], v[80:83], v[56:59]
    ds_read_b128 v[160:163], v1 offset:16384
    v_mfma_f32_16x16x32_bf16 v[60:63], v[188:191], v[80:83], v[60:63]
    ds_read_b128 v[164:167], v1 offset:17408
    s_waitcnt vmcnt(9)
    v_cmp_ne_u32 vcc, s44, v218
    v_cmp_ne_u32 s[98:99], s44, v222
    s_nop 0
    s_or_b64 vcc, vcc, s[98:99]
    s_cmp_eq_u64 vcc, 0
    s_cbranch_scc1 L_std_42
L_st_41:
    buffer_load_dwordx4 v[216:219], v14, s[4:7], s58 offen offset:0 sc1
    buffer_load_dwordx4 v[220:223], v14, s[4:7], s58 offen offset:32 sc1
    s_waitcnt vmcnt(0)
    v_cmp_ne_u32 vcc, s44, v218
    v_cmp_ne_u32 s[98:99], s44, v222
    s_nop 0
    s_or_b64 vcc, vcc, s[98:99]
    s_cmp_eq_u64 vcc, 0
    s_cbranch_scc1 L_std_42
    s_sub_u32 s100, s100, 1
    s_cbranch_scc0 L_st_41
    s_mov_b32 s100, 0
L_std_42:
    v_add_f32_dpp v216, v216, v216 quad_perm:[1,0,3,2] row_mask:0xf bank_mask:0xf
    v_add_f32_dpp v217, v217, v217 quad_perm:[1,0,3,2] row_mask:0xf bank_mask:0xf
    v_add_f32_dpp v220, v220, v220 quad_perm:[1,0,3,2] row_mask:0xf bank_mask:0xf
    v_add_f32_dpp v221, v221, v221 quad_perm:[1,0,3,2] row_mask:0xf bank_mask:0xf
    v_add_f32_dpp v216, v216, v216 quad_perm:[2,3,0,1] row_mask:0xf bank_mask:0xf
    v_add_f32_dpp v217, v217, v217 quad_perm:[2,3,0,1] row_mask:0xf bank_mask:0xf
    v_add_f32_dpp v220, v220, v220 quad_perm:[2,3,0,1] row_mask:0xf bank_mask:0xf
    v_add_f32_dpp v221, v221, v221 quad_perm:[2,3,0,1] row_mask:0xf bank_mask:0xf
    v_add_f32_dpp v216, v216, v216 row_half_mirror row_mask:0xf bank_mask:0xf
    v_add_f32_dpp v217, v217, v217 row_half_mirror row_mask:0xf bank_mask:0xf
    v_add_f32_dpp v220, v220, v220 row_half_mirror row_mask:0xf bank_mask:0xf
    v_add_f32_dpp v221, v221, v221 row_half_mirror row_mask:0xf bank_mask:0xf
    s_mov_b32 s57, 0x3aaaaaab
    v_mul_f32 v216, s57, v216
    v_mul_f32 v4, v216, v216
    v_fma_f32 v217, v217, s57, -v4
    v_max_f32 v217, 0, v217
    v_add_f32 v217, 0x3727c5ac, v217
    v_rsq_f32 v217, v217
    s_nop 0
    v_mul_f32 v216, -v216, v217
    s_mov_b32 s57, 0x3aaaaaab
    v_mul_f32 v220, s57, v220
    v_mul_f32 v4, v220, v220
    v_fma_f32 v221, v221, s57, -v4
    v_max_f32 v221, 0, v221
    v_add_f32 v221, 0x3727c5ac, v221
    v_rsq_f32 v221, v221
    s_nop 0
    v_mul_f32 v220, -v220, v221
    v_mov_b32_dpp v224, v217 row_newbcast:0 row_mask:0xf bank_mask:0xf
    v_mov_b32_dpp v225, v217 row_newbcast:8 row_mask:0xf bank_mask:0xf
    v_mov_b32_dpp v226, v221 row_newbcast:0 row_mask:0xf bank_mask:0xf
    v_mov_b32_dpp v227, v221 row_newbcast:8 row_mask:0xf bank_mask:0xf
    v_mov_b32_dpp v228, v216 row_newbcast:0 row_mask:0xf bank_mask:0xf
    v_mov_b32_dpp v229, v216 row_newbcast:8 row_mask:0xf bank_mask:0xf
    v_mov_b32_dpp v230, v220 row_newbcast:0 row_mask:0xf bank_mask:0xf
    v_mov_b32_dpp v231, v220 row_newbcast:8 row_mask:0xf bank_mask:0xf
    v_pk_fma_f32 v[16:17], v[16:17], v[224:225], v[228:229]
    v_pk_fma_f32 v[18:19], v[18:19], v[226:227], v[230:231]
    v_pk_fma_f32 v[20:21], v[20:21], v[224:225], v[228:229]
    v_pk_fma_f32 v[22:23], v[22:23], v[226:227], v[230:231]
    v_pk_fma_f32 v[24:25], v[24:25], v[224:225], v[228:229]
    v_pk_fma_f32 v[26:27], v[26:27], v[226:227], v[230:231]
    v_pk_fma_f32 v[28:29], v[28:29], v[224:225], v[228:229]
    v_pk_fma_f32 v[30:31], v[30:31], v[226:227], v[230:231]
    v_pk_fma_f32 v[32:33], v[32:33], v[224:225], v[228:229]
    v_pk_fma_f32 v[34:35], v[34:35], v[226:227], v[230:231]
    v_pk_fma_f32 v[36:37], v[36:37], v[224:225], v[228:229]
    v_pk_fma_f32 v[38:39], v[38:39], v[226:227], v[230:231]
    v_cvt_pk_bf16_f32 v16, v16, v17
    v_cvt_pk_bf16_f32 v17, v18, v19
    v_cvt_pk_bf16_f32 v18, v20, v21
    v_cvt_pk_bf16_f32 v19, v22, v23
    v_cvt_pk_bf16_f32 v20, v24, v25
    v_cvt_pk_bf16_f32 v21, v26, v27
    v_cvt_pk_bf16_f32 v22, v28, v29
    v_cvt_pk_bf16_f32 v23, v30, v31
    v_cvt_pk_bf16_f32 v24, v32, v33
    v_cvt_pk_bf16_f32 v25, v34, v35
    v_cvt_pk_bf16_f32 v26, v36, v37
    v_cvt_pk_bf16_f32 v27, v38, v39
    v_permlane16_swap_b32 v16, v18
    v_permlane16_swap_b32 v17, v19
    v_permlane16_swap_b32 v20, v22
    v_permlane16_swap_b32 v21, v23
    v_permlane16_swap_b32 v24, v26
    v_permlane16_swap_b32 v25, v27
    buffer_store_dwordx4 v[16:19], v1, s[4:7], s59 offen offset:0 sc1
    buffer_store_dwordx4 v[20:23], v1, s[4:7], s59 offen offset:1024 sc1
    buffer_store_dwordx4 v[24:27], v1, s[4:7], s59 offen offset:2048 sc1
    s_waitcnt lgkmcnt(6)
    v_mfma_f32_16x16x32_bf16 v[40:43], v[192:195], v[84:87], v[40:43]
    ds_read_b128 v[168:171], v1 offset:18432
    s_add_u32 s101, s101, 4096
    s_add_u32 s93, s93, 4096
    buffer_load_dwordx4 a[64:67], v254, s[4:7], s101 offen offset:0 sc1
    v_mfma_f32_16x16x32_bf16 v[44:47], v[196:199], v[84:87], v[44:47]
    ds_read_b128 v[172:175], v1 offset:19456
    v_mfma_f32_16x16x32_bf16 v[48:51], v[200:203], v[84:87], v[48:51]
    ds_read_b128 v[176:179], v1 offset:20480
    v_mfma_f32_16x16x32_bf16 v[52:55], v[204:207], v[84:87], v[52:55]
    ds_read_b128 v[180:183], v1 offset:21504
    buffer_load_dwordx4 a[68:71], v254, s[4:7], s93 offen offset:0 sc1
    v_mfma_f32_16x16x32_bf16 v[56:59], v[208:211], v[84:87], v[56:59]
    ds_read_b128 v[184:187], v1 offset:22528
    v_mfma_f32_16x16x32_bf16 v[60:63], v[212:215], v[84:87], v[60:63]
    ds_read_b128 v[188:191], v1 offset:23552
    s_waitcnt lgkmcnt(6)
    v_mfma_f32_16x16x32_bf16 v[40:43], v[144:147], v[88:91], v[40:43]
    ds_read_b128 v[192:195], v1 offset:24576
    buffer_load_dwordx4 a[72:75], v254, s[4:7], s101 offen offset:2048 sc1
    v_mfma_f32_16x16x32_bf16 v[44:47], v[148:151], v[88:91], v[44:47]
    ds_read_b128 v[196:199], v1 offset:25600
    v_mfma_f32_16x16x32_bf16 v[48:51], v[152:155], v[88:91], v[48:51]
    ds_read_b128 v[200:203], v1 offset:26624
    v_mfma_f32_16x16x32_bf16 v[52:55], v[156:159], v[88:91], v[52:55]
    ds_read_b128 v[204:207], v1 offset:27648
    v_mfma_f32_16x16x32_bf16 v[56:59], v[160:163], v[88:91], v[56:59]
    ds_read_b128 v[208:211], v1 offset:28672
    v_mfma_f32_16x16x32_bf16 v[60:63], v[164:167], v[88:91], v[60:63]
    ds_read_b128 v[212:215], v1 offset:29696
    s_waitcnt lgkmcnt(6)
    v_mfma_f32_16x16x32_bf16 v[40:43], v[168:171], v[92:95], v[40:43]
    ds_read_b128 v[144:147], v1 offset:30720
    buffer_load_dwordx4 a[76:79], v254, s[4:7], s93 offen offset:2048 sc1
    v_mfma_f32_16x16x32_bf16 v[44:47], v[172:175], v[92:95], v[44:47]
    ds_read_b128 v[148:151], v1 offset:31744
    v_mfma_f32_16x16x32_bf16 v[48:51], v[176:179], v[92:95], v[48:51]
    ds_read_b128 v[152:155], v1 offset:32768
    v_mfma_f32_16x16x32_bf16 v[52:55], v[180:183], v[92:95], v[52:55]
    ds_read_b128 v[156:159], v1 offset:33792
    s_add_u32 s101, s101, 4096
    s_add_u32 s93, s93, 4096
    buffer_load_dwordx4 a[80:83], v254, s[4:7], s101 offen offset:0 sc1
    v_mfma_f32_16x16x32_bf16 v[56:59], v[184:187], v[92:95], v[56:59]
    ds_read_b128 v[160:163], v1 offset:34816
    v_mfma_f32_16x16x32_bf16 v[60:63], v[188:191], v[92:95], v[60:63]
    ds_read_b128 v[164:167], v1 offset:35840
    s_waitcnt lgkmcnt(6)
    v_mfma_f32_16x16x32_bf16 v[40:43], v[192:195], v[96:99], v[40:43]
    ds_read_b128 v[168:171], v1 offset:36864
    buffer_load_dwordx4 a[84:87], v254, s[4:7], s93 offen offset:0 sc1
    v_mfma_f32_16x16x32_bf16 v[44:47], v[196:199], v[96:99], v[44:47]
    ds_read_b128 v[172:175], v1 offset:37888
    v_mfma_f32_16x16x32_bf16 v[48:51], v[200:203], v[96:99], v[48:51]
    ds_read_b128 v[176:179], v1 offset:38912
    v_mfma_f32_16x16x32_bf16 v[52:55], v[204:207], v[96:99], v[52:55]
    ds_read_b128 v[180:183], v1 offset:39936
    buffer_load_dwordx4 a[88:91], v254, s[4:7], s101 offen offset:2048 sc1
    v_mfma_f32_16x16x32_bf16 v[56:59], v[208:211], v[96:99], v[56:59]
    ds_read_b128 v[184:187], v1 offset:40960
    v_mfma_f32_16x16x32_bf16 v[60:63], v[212:215], v[96:99], v[60:63]
    ds_read_b128 v[188:191], v1 offset:41984
    s_waitcnt lgkmcnt(6)
    v_mfma_f32_16x16x32_bf16 v[40:43], v[144:147], v[100:103], v[40:43]
    ds_read_b128 v[192:195], v1 offset:43008
    buffer_load_dwordx4 a[92:95], v254, s[4:7], s93 offen offset:2048 sc1
    v_mfma_f32_16x16x32_bf16 v[44:47], v[148:151], v[100:103], v[44:47]
    ds_read_b128 v[196:199], v1 offset:44032
    v_mfma_f32_16x16x32_bf16 v[48:51], v[152:155], v[100:103], v[48:51]
    ds_read_b128 v[200:203], v1 offset:45056
    v_mfma_f32_16x16x32_bf16 v[52:55], v[156:159], v[100:103], v[52:55]
    ds_read_b128 v[204:207], v1 offset:46080
    v_mfma_f32_16x16x32_bf16 v[56:59], v[160:163], v[100:103], v[56:59]
    ds_read_b128 v[208:211], v1 offset:47104
    v_mfma_f32_16x16x32_bf16 v[60:63], v[164:167], v[100:103], v[60:63]
    ds_read_b128 v[212:215], v1 offset:48128
    s_waitcnt lgkmcnt(6)
    v_mfma_f32_16x16x32_bf16 v[40:43], v[168:171], v[104:107], v[40:43]
    ds_read_b128 v[144:147], v1 offset:49152
    s_add_u32 s101, s101, 4096
    s_add_u32 s93, s93, 4096
    buffer_load_dwordx4 a[96:99], v254, s[4:7], s101 offen offset:0 sc1
    v_mfma_f32_16x16x32_bf16 v[44:47], v[172:175], v[104:107], v[44:47]
    ds_read_b128 v[148:151], v1 offset:50176
    v_mfma_f32_16x16x32_bf16 v[48:51], v[176:179], v[104:107], v[48:51]
    ds_read_b128 v[152:155], v1 offset:51200
    v_mfma_f32_16x16x32_bf16 v[52:55], v[180:183], v[104:107], v[52:55]
    ds_read_b128 v[156:159], v1 offset:52224
    buffer_load_dwordx4 a[100:103], v254, s[4:7], s93 offen offset:0 sc1
    v_mfma_f32_16x16x32_bf16 v[56:59], v[184:187], v[104:107], v[56:59]
    ds_read_b128 v[160:163], v1 offset:53248
    v_mfma_f32_16x16x32_bf16 v[60:63], v[188:191], v[104:107], v[60:63]
    ds_read_b128 v[164:167], v1 offset:54272
    s_waitcnt lgkmcnt(6)
    v_mfma_f32_16x16x32_bf16 v[40:43], v[192:195], v[108:111], v[40:43]
    ds_read_b128 v[168:171], v1 offset:55296
    buffer_load_dwordx4 a[104:107], v254, s[4:7], s101 offen offset:2048 sc1
    v_mfma_f32_16x16x32_bf16 v[44:47], v[196:199], v[108:111], v[44:47]
    ds_read_b128 v[172:175], v1 offset:56320
    v_mfma_f32_16x16x32_bf16 v[48:51], v[200:203], v[108:111], v[48:51]
    ds_read_b128 v[176:179], v1 offset:57344
    v_mfma_f32_16x16x32_bf16 v[52:55], v[204:207], v[108:111], v[52:55]
    ds_read_b128 v[180:183], v1 offset:58368
    buffer_load_dwordx4 a[108:111], v254, s[4:7], s93 offen offset:2048 sc1
    v_mfma_f32_16x16x32_bf16 v[56:59], v[208:211], v[108:111], v[56:59]
    ds_read_b128 v[184:187], v1 offset:59392
    v_mfma_f32_16x16x32_bf16 v[60:63], v[212:215], v[108:111], v[60:63]
    ds_read_b128 v[188:191], v1 offset:60416
    s_waitcnt vmcnt(12)
    s_barrier
    v_mov_b32 v216, s44
    v_mov_b32 v217, 0
    s_mov_b64 exec, 1
    buffer_store_dword v216, v217, s[4:7], s89 offen sc1
    s_mov_b64 exec, -1
    s_waitcnt lgkmcnt(6)
    v_mfma_f32_16x16x32_bf16 v[40:43], v[144:147], v[112:115], v[40:43]
    ds_read_b128 v[192:195], v1 offset:61440
    s_add_u32 s101, s101, 4096
    s_add_u32 s93, s93, 4096
    buffer_load_dwordx4 a[112:115], v254, s[4:7], s101 offen offset:0 sc1
    v_mfma_f32_16x16x32_bf16 v[44:47], v[148:151], v[112:115], v[44:47]
    ds_read_b128 v[196:199], v1 offset:62464
    v_mfma_f32_16x16x32_bf16 v[48:51], v[152:155], v[112:115], v[48:51]
    ds_read_b128 v[200:203], v1 offset:63488
    v_mfma_f32_16x16x32_bf16 v[52:55], v[156:159], v[112:115], v[52:55]
    ds_read_b128 v[204:207], v1 offset:64512
    v_mfma_f32_16x16x32_bf16 v[56:59], v[160:163], v[112:115], v[56:59]
    ds_read_b128 v[208:211], v5 offset:0
    v_mfma_f32_16x16x32_bf16 v[60:63], v[164:167], v[112:115], v[60:63]
    ds_read_b128 v[212:215], v5 offset:1024
    s_waitcnt lgkmcnt(6)
    v_mfma_f32_16x16x32_bf16 v[40:43], v[168:171], v[116:119], v[40:43]
    ds_read_b128 v[144:147], v5 offset:2048
    buffer_load_dwordx4 a[116:119], v254, s[4:7], s93 offen offset:0 sc1
    v_mfma_f32_16x16x32_bf16 v[44:47], v[172:175], v[116:119], v[44:47]
    ds_read_b128 v[148:151], v5 offset:3072
    v_mfma_f32_16x16x32_bf16 v[48:51], v[176:179], v[116:119], v[48:51]
    ds_read_b128 v[152:155], v5 offset:4096
    v_mfma_f32_16x16x32_bf16 v[52:55], v[180:183], v[116:119], v[52:55]
    ds_read_b128 v[156:159], v5 offset:5120
    buffer_load_dwordx4 a[120:123], v254, s[4:7], s101 offen offset:2048 sc1
    v_mfma_f32_16x16x32_bf16 v[56:59], v[184:187], v[116:119], v[56:59]
    ds_read_b128 v[160:163], v5 offset:6144
    v_mfma_f32_16x16x32_bf16 v[60:63], v[188:191], v[116:119], v[60:63]
    ds_read_b128 v[164:167], v5 offset:7168
    s_waitcnt lgkmcnt(6)
    v_mfma_f32_16x16x32_bf16 v[40:43], v[192:195], v[120:123], v[40:43]
    ds_read_b128 v[168:171], v5 offset:8192
    buffer_load_dwordx4 a[124:127], v254, s[4:7], s93 offen offset:2048 sc1
    v_mfma_f32_16x16x32_bf16 v[44:47], v[196:199], v[120:123], v[44:47]
    ds_read_b128 v[172:175], v5 offset:9216
    v_mfma_f32_16x16x32_bf16 v[48:51], v[200:203], v[120:123], v[48:51]
    ds_read_b128 v[176:179], v5 offset:10240
    v_mfma_f32_16x16x32_bf16 v[52:55], v[204:207], v[120:123], v[52:55]
    ds_read_b128 v[180:183], v5 offset:11264
    s_add_u32 s101, s101, 4096
    s_add_u32 s93, s93, 4096
    buffer_load_dwordx4 a[128:131], v254, s[4:7], s101 offen offset:0 sc1
    v_mfma_f32_16x16x32_bf16 v[56:59], v[208:211], v[120:123], v[56:59]
    ds_read_b128 v[184:187], v5 offset:12288
    v_mfma_f32_16x16x32_bf16 v[60:63], v[212:215], v[120:123], v[60:63]
    ds_read_b128 v[188:191], v5 offset:13312
    s_waitcnt lgkmcnt(6)
    v_mfma_f32_16x16x32_bf16 v[40:43], v[144:147], v[124:127], v[40:43]
    ds_read_b128 v[192:195], v5 offset:14336
    buffer_load_dwordx4 a[132:135], v254, s[4:7], s93 offen offset:0 sc1
    v_mfma_f32_16x16x32_bf16 v[44:47], v[148:151], v[124:127], v[44:47]
    ds_read_b128 v[196:199], v5 offset:15360
    v_mfma_f32_16x16x32_bf16 v[48:51], v[152:155], v[124:127], v[48:51]
    ds_read_b128 v[200:203], v5 offset:16384
    v_mfma_f32_16x16x32_bf16 v[52:55], v[156:159], v[124:127], v[52:55]
    ds_read_b128 v[204:207], v5 offset:17408
    v_mfma_f32_16x16x32_bf16 v[56:59], v[160:163], v[124:127], v[56:59]
    ds_read_b128 v[208:211], v5 offset:18432
    v_mfma_f32_16x16x32_bf16 v[60:63], v[164:167], v[124:127], v[60:63]
    ds_read_b128 v[212:215], v5 offset:19456
    s_waitcnt lgkmcnt(6)
    v_mfma_f32_16x16x32_bf16 v[40:43], v[168:171], v[128:131], v[40:43]
    ds_read_b128 v[144:147], v5 offset:20480
    buffer_load_dwordx4 a[136:139], v254, s[4:7], s101 offen offset:2048 sc1
    v_mfma_f32_16x16x32_bf16 v[44:47], v[172:175], v[128:131], v[44:47]
    ds_read_b128 v[148:151], v5 offset:21504
    v_mfma_f32_16x16x32_bf16 v[48:51], v[176:179], v[128:131], v[48:51]
    ds_read_b128 v[152:155], v5 offset:22528
    v_mfma_f32_16x16x32_bf16 v[52:55], v[180:183], v[128:131], v[52:55]
    ds_read_b128 v[156:159], v5 offset:23552
    buffer_load_dwordx4 a[140:143], v254, s[4:7], s93 offen offset:2048 sc1
    v_mfma_f32_16x16x32_bf16 v[56:59], v[184:187], v[128:131], v[56:59]
    ds_read_b128 v[160:163], v5 offset:24576
    v_mfma_f32_16x16x32_bf16 v[60:63], v[188:191], v[128:131], v[60:63]
    ds_read_b128 v[164:167], v5 offset:25600
    s_waitcnt lgkmcnt(6)
    v_mfma_f32_16x16x32_bf16 v[40:43], v[192:195], v[132:135], v[40:43]
    ds_read_b128 v[168:171], v5 offset:26624
    s_add_u32 s101, s101, 4096
    s_add_u32 s93, s93, 4096
    buffer_load_dwordx4 a[144:147], v254, s[4:7], s101 offen offset:0 sc1
    v_mfma_f32_16x16x32_bf16 v[44:47], v[196:199], v[132:135], v[44:47]
    ds_read_b128 v[172:175], v5 offset:27648
    v_mfma_f32_16x16x32_bf16 v[48:51], v[200:203], v[132:135], v[48:51]
    ds_read_b128 v[176:179], v5 offset:28672
    v_mfma_f32_16x16x32_bf16 v[52:55], v[204:207], v[132:135], v[52:55]
    ds_read_b128 v[180:183], v5 offset:29696
    buffer_load_dwordx4 a[148:151], v254, s[4:7], s93 offen offset:0 sc1
    v_mfma_f32_16x16x32_bf16 v[56:59], v[208:211], v[132:135], v[56:59]
    ds_read_b128 v[184:187], v5 offset:30720
    v_mfma_f32_16x16x32_bf16 v[60:63], v[212:215], v[132:135], v[60:63]
    ds_read_b128 v[188:191], v5 offset:31744
    s_waitcnt lgkmcnt(6)
    v_mfma_f32_16x16x32_bf16 v[40:43], v[144:147], v[136:139], v[40:43]
    buffer_load_dwordx4 a[152:155], v254, s[4:7], s101 offen offset:2048 sc1
    v_mfma_f32_16x16x32_bf16 v[44:47], v[148:151], v[136:139], v[44:47]
    v_mfma_f32_16x16x32_bf16 v[48:51], v[152:155], v[136:139], v[48:51]
    v_mfma_f32_16x16x32_bf16 v[52:55], v[156:159], v[136:139], v[52:55]
    v_mfma_f32_16x16x32_bf16 v[56:59], v[160:163], v[136:139], v[56:59]
    v_mfma_f32_16x16x32_bf16 v[60:63], v[164:167], v[136:139], v[60:63]
    s_waitcnt lgkmcnt(0)
    v_mfma_f32_16x16x32_bf16 v[40:43], v[168:171], v[140:143], v[40:43]
    buffer_load_dwordx4 a[156:159], v254, s[4:7], s93 offen offset:2048 sc1
    v_mfma_f32_16x16x32_bf16 v[44:47], v[172:175], v[140:143], v[44:47]
    v_mfma_f32_16x16x32_bf16 v[48:51], v[176:179], v[140:143], v[48:51]
    v_mfma_f32_16x16x32_bf16 v[52:55], v[180:183], v[140:143], v[52:55]
    s_add_u32 s101, s101, 4096
    s_add_u32 s93, s93, 4096
    buffer_load_dwordx4 a[160:163], v254, s[4:7], s101 offen offset:0 sc1
    v_mfma_f32_16x16x32_bf16 v[56:59], v[184:187], v[140:143], v[56:59]
    v_mfma_f32_16x16x32_bf16 v[60:63], v[188:191], v[140:143], v[60:63]
    s_add_u32 s98, s42, s88
    s_addc_u32 s99, s43, 0
    s_cmp_lg_u32 s47, 0
    s_cbranch_scc1 L_spi_43
    s_load_dwordx16 s[64:79], s[98:99], 0 glc
L_spi_43:
    s_mov_b32 s0, 0xbdd2d3e8
    s_mov_b32 s1, s0
    v_mov_b32 v252, 0xc0135761
    v_pk_mul_f32 v[144:145], v[40:41], v[40:41]
    buffer_load_dwordx4 a[164:167], v254, s[4:7], s93 offen offset:0 sc1
    v_pk_mul_f32 v[146:147], v[42:43], v[42:43]
    v_pk_mul_f32 v[148:149], v[44:45], v[44:45]
    v_pk_mul_f32 v[150:151], v[46:47], v[46:47]
    buffer_load_dwordx4 a[168:171], v254, s[4:7], s101 offen offset:2048 sc1
    v_pk_mul_f32 v[152:153], v[48:49], v[48:49]
    v_pk_mul_f32 v[154:155], v[50:51], v[50:51]
    v_pk_mul_f32 v[156:157], v[52:53], v[52:53]
    buffer_load_dwordx4 a[172:175], v254, s[4:7], s93 offen offset:2048 sc1
    v_pk_mul_f32 v[158:159], v[54:55], v[54:55]
    v_pk_mul_f32 v[160:161], v[56:57], v[56:57]
    v_pk_mul_f32 v[162:163], v[58:59], v[58:59]
    s_add_u32 s101, s101, 4096
    s_add_u32 s93, s93, 4096
    buffer_load_dwordx4 a[176:179], v254, s[4:7], s101 offen offset:0 sc1
    v_pk_mul_f32 v[164:165], v[60:61], v[60:61]
    v_pk_mul_f32 v[166:167], v[62:63], v[62:63]
    v_pk_fma_f32 v[144:145], v[144:145], s[0:1], v[252:253] op_sel_hi:[1,1,0]
    v_pk_fma_f32 v[146:147], v[146:147], s[0:1], v[252:253] op_sel_hi:[1,1,0]
    v_pk_fma_f32 v[148:149], v[148:149], s[0:1], v[252:253] op_sel_hi:[1,1,0]
    v_pk_fma_f32 v[150:151], v[150:151], s[0:1], v[252:253] op_sel_hi:[1,1,0]
    v_pk_fma_f32 v[152:153], v[152:153], s[0:1], v[252:253] op_sel_hi:[1,1,0]
    v_pk_fma_f32 v[154:155], v[154:155], s[0:1], v[252:253] op_sel_hi:[1,1,0]
    v_pk_fma_f32 v[156:157], v[156:157], s[0:1], v[252:253] op_sel_hi:[1,1,0]
    v_pk_fma_f32 v[158:159], v[158:159], s[0:1], v[252:253] op_sel_hi:[1,1,0]
    v_pk_fma_f32 v[160:161], v[160:161], s[0:1], v[252:253] op_sel_hi:[1,1,0]
    v_pk_fma_f32 v[162:163], v[162:163], s[0:1], v[252:253] op_sel_hi:[1,1,0]
    v_pk_fma_f32 v[164:165], v[164:165], s[0:1], v[252:253] op_sel_hi:[1,1,0]
    v_pk_fma_f32 v[166:167], v[166:167], s[0:1], v[252:253] op_sel_hi:[1,1,0]
    v_pk_mul_f32 v[144:145], v[144:145], v[40:41]
    v_pk_mul_f32 v[146:147], v[146:147], v[42:43]
    v_pk_mul_f32 v[148:149], v[148:149], v[44:45]
    v_pk_mul_f32 v[150:151], v[150:151], v[46:47]
    v_pk_mul_f32 v[152:153], v[152:153], v[48:49]
    v_pk_mul_f32 v[154:155], v[154:155], v[50:51]
    v_pk_mul_f32 v[156:157], v[156:157], v[52:53]
    v_pk_mul_f32 v[158:159], v[158:159], v[54:55]
    v_pk_mul_f32 v[160:161], v[160:161], v[56:57]
    v_pk_mul_f32 v[162:163], v[162:163], v[58:59]
    v_pk_mul_f32 v[164:165], v[164:165], v[60:61]
    v_pk_mul_f32 v[166:167], v[166:167], v[62:63]
    v_exp_f32 v144, v144
    buffer_load_dwordx4 a[180:183], v254, s[4:7], s93 offen offset:0 sc1
    v_exp_f32 v145, v145
    v_exp_f32 v146, v146
    v_exp_f32 v147, v147
    buffer_load_dwordx4 a[184:187], v254, s[4:7], s101 offen offset:2048 sc1
    v_exp_f32 v148, v148
    v_exp_f32 v149, v149
    v_exp_f32 v150, v150
    buffer_load_dwordx4 a[188:191], v254, s[4:7], s93 offen offset:2048 sc1
    v_exp_f32 v151, v151
    v_exp_f32 v152, v152
    v_exp_f32 v153, v153
    s_add_u32 s101, s101, 4096
    s_add_u32 s93, s93, 4096
    buffer_load_dwordx4 a[192:195], v254, s[4:7], s101 offen offset:0 sc1
    v_exp_f32 v154, v154
    v_exp_f32 v155, v155
    s_waitcnt lgkmcnt(0)
    s_cmp_lg_u32 s47, 0
    s_cbranch_scc1 L_spd_46
    s_xor_b64 s[64:65], s[64:65], s[44:45]
    s_xor_b64 s[66:67], s[66:67], s[44:45]
    s_or_b64 s[64:65], s[64:65], s[66:67]
    s_xor_b64 s[68:69], s[68:69], s[44:45]
    s_or_b64 s[64:65], s[64:65], s[68:69]
    s_xor_b64 s[70:71], s[70:71], s[44:45]
    s_or_b64 s[64:65], s[64:65], s[70:71]
    s_xor_b64 s[72:73], s[72:73], s[44:45]
    s_or_b64 s[64:65], s[64:65], s[72:73]
    s_xor_b64 s[74:75], s[74:75], s[44:45]
    s_or_b64 s[64:65], s[64:65], s[74:75]
    s_xor_b64 s[76:77], s[76:77], s[44:45]
    s_or_b64 s[64:65], s[64:65], s[76:77]
    s_xor_b64 s[78:79], s[78:79], s[44:45]
    s_or_b64 s[64:65], s[64:65], s[78:79]
    s_cmp_eq_u64 s[64:65], 0
    s_cbranch_scc1 L_spd_46
L_sp_44:
    s_sleep 4
    s_load_dwordx16 s[64:79], s[98:99], 0 glc
    s_waitcnt lgkmcnt(0)
    s_xor_b64 s[64:65], s[64:65], s[44:45]
    s_xor_b64 s[66:67], s[66:67], s[44:45]
    s_or_b64 s[64:65], s[64:65], s[66:67]
    s_xor_b64 s[68:69], s[68:69], s[44:45]
    s_or_b64 s[64:65], s[64:65], s[68:69]
    s_xor_b64 s[70:71], s[70:71], s[44:45]
    s_or_b64 s[64:65], s[64:65], s[70:71]
    s_xor_b64 s[72:73], s[72:73], s[44:45]
    s_or_b64 s[64:65], s[64:65], s[72:73]
    s_xor_b64 s[74:75], s[74:75], s[44:45]
    s_or_b64 s[64:65], s[64:65], s[74:75]
    s_xor_b64 s[76:77], s[76:77], s[44:45]
    s_or_b64 s[64:65], s[64:65], s[76:77]
    s_xor_b64 s[78:79], s[78:79], s[44:45]
    s_or_b64 s[64:65], s[64:65], s[78:79]
    s_cmp_eq_u64 s[64:65], 0
    s_cbranch_scc1 L_spd_46
    s_sub_u32 s100, s100, 1
    s_cbranch_scc0 L_sp_44
    s_mov_b32 s100, 0
L_spd_46:
    s_barrier
    s_and_b32 s55, s48, 1
    s_mul_i32 s62, s55, 196608
    s_add_u32 s62, s62, s87
    s_mul_i32 s60, s47, 3072
    s_add_u32 s55, s62, s60
    s_mul_i32 s19, s53, 0
    s_add_u32 s62, s55, s19
    s_add_u32 s19, s55, 196608
    v_lshrrev_b32 v4, 5, v2
    v_mul_u32_u24 v13, 3072, v4
    v_bfe_u32 v4, v2, 4, 1
    v_lshl_add_u32 v13, v4, 9, v13
    v_lshl_add_u32 v13, v11, 4, v13
    s_add_u32 s63, s60, 0
    s_mov_b32 m0, s63
    v_exp_f32 v156, v156
    buffer_load_dwordx4 v1, s[4:7], s62 offen offset:0 sc1 lds
    v_exp_f32 v157, v157
    v_exp_f32 v158, v158
    v_exp_f32 v159, v159
    buffer_load_dwordx4 v1, s[4:7], s62 offen offset:1024 sc1 lds
    v_exp_f32 v160, v160
    v_exp_f32 v161, v161
    v_exp_f32 v162, v162
    buffer_load_dwordx4 v1, s[4:7], s62 offen offset:2048 sc1 lds
    s_add_u32 s62, s62, 12288
    v_exp_f32 v163, v163
    v_exp_f32 v164, v164
    s_add_u32 s63, s60, 12288
    s_mov_b32 m0, s63
    v_exp_f32 v165, v165
    buffer_load_dwordx4 v1, s[4:7], s62 offen offset:0 sc1 lds
    v_exp_f32 v166, v166
    v_exp_f32 v167, v167
    v_pk_add_f32 v[144:145], v[144:145], 1.0 op_sel_hi:[1,0]
    v_pk_add_f32 v[146:147], v[146:147], 1.0 op_sel_hi:[1,0]
    v_pk_add_f32 v[148:149], v[148:149], 1.0 op_sel_hi:[1,0]
    v_pk_add_f32 v[150:151], v[150:151], 1.0 op_sel_hi:[1,0]
    v_pk_add_f32 v[152:153], v[152:153], 1.0 op_sel_hi:[1,0]
    v_pk_add_f32 v[154:155], v[154:155], 1.0 op_sel_hi:[1,0]
    v_pk_add_f32 v[156:157], v[156:157], 1.0 op_sel_hi:[1,0]
    v_pk_add_f32 v[158:159], v[158:159], 1.0 op_sel_hi:[1,0]
    v_pk_add_f32 v[160:161], v[160:161], 1.0 op_sel_hi:[1,0]
    v_pk_add_f32 v[162:163], v[162:163], 1.0 op_sel_hi:[1,0]
    v_pk_add_f32 v[164:165], v[164:165], 1.0 op_sel_hi:[1,0]
    v_pk_add_f32 v[166:167], v[166:167], 1.0 op_sel_hi:[1,0]
    v_rcp_f32 v144, v144
    buffer_load_dwordx4 v1, s[4:7], s62 offen offset:1024 sc1 lds
    v_rcp_f32 v145, v145
    v_rcp_f32 v146, v146
    v_rcp_f32 v147, v147
    buffer_load_dwordx4 v1, s[4:7], s62 offen offset:2048 sc1 lds
    s_add_u32 s62, s62, 12288
    v_rcp_f32 v148, v148
    v_rcp_f32 v149, v149
    s_add_u32 s63, s60, 24576
    s_mov_b32 m0, s63
    v_rcp_f32 v150, v150
    buffer_load_dwordx4 v1, s[4:7], s62 offen offset:0 sc1 lds
    v_rcp_f32 v151, v151
    v_rcp_f32 v152, v152
    v_rcp_f32 v153, v153
    buffer_load_dwordx4 v1, s[4:7], s62 offen offset:1024 sc1 lds
    v_rcp_f32 v154, v154
    v_rcp_f32 v155, v155
    v_rcp_f32 v156, v156
    buffer_load_dwordx4 v1, s[4:7], s62 offen offset:2048 sc1 lds
    s_add_u32 s62, s62, 12288
    v_rcp_f32 v157, v157
    v_rcp_f32 v158, v158
    s_add_u32 s63, s60, 36864
    s_mov_b32 m0, s63
    v_rcp_f32 v159, v159
    buffer_load_dwordx4 v1, s[4:7], s62 offen offset:0 sc1 lds
    v_rcp_f32 v160, v160
    v_rcp_f32 v161, v161
    v_rcp_f32 v162, v162
    buffer_load_dwordx4 v1, s[4:7], s62 offen offset:1024 sc1 lds
    v_rcp_f32 v163, v163
    v_rcp_f32 v164, v164
    v_rcp_f32 v165, v165
    buffer_load_dwordx4 v1, s[4:7], s62 offen offset:2048 sc1 lds
    s_add_u32 s62, s62, 12288
    v_rcp_f32 v166, v166
    v_rcp_f32 v167, v167
    v_pk_mul_f32 v[40:41], v[40:41], v[144:145]
    v_pk_mul_f32 v[42:43], v[42:43], v[146:147]
    v_pk_mul_f32 v[44:45], v[44:45], v[148:149]
    v_pk_mul_f32 v[46:47], v[46:47], v[150:151]
    v_pk_mul_f32 v[48:49], v[48:49], v[152:153]
    v_pk_mul_f32 v[50:51], v[50:51], v[154:155]
    v_pk_mul_f32 v[52:53], v[52:53], v[156:157]
    v_pk_mul_f32 v[54:55], v[54:55], v[158:159]
    v_pk_mul_f32 v[56:57], v[56:57], v[160:161]
    v_pk_mul_f32 v[58:59], v[58:59], v[162:163]
    v_pk_mul_f32 v[60:61], v[60:61], v[164:165]
    v_pk_mul_f32 v[62:63], v[62:63], v[166:167]
    s_waitcnt vmcnt(9)
    s_barrier
    ds_read_b128 v[64:67], v13 offset:0
    ds_read_b128 v[68:71], v13 offset:256
    ds_read_b128 v[72:75], v13 offset:1024
    ds_read_b128 v[76:79], v13 offset:1280
    ds_read_b128 v[80:83], v13 offset:2048
    ds_read_b128 v[84:87], v13 offset:2304
    ds_read_b128 v[88:91], v13 offset:6144
    ds_read_b128 v[92:95], v13 offset:6400
    ds_read_b128 v[96:99], v13 offset:7168
    ds_read_b128 v[100:103], v13 offset:7424
    ds_read_b128 v[104:107], v13 offset:8192
    ds_read_b128 v[108:111], v13 offset:8448
    s_waitcnt vmcnt(6)
    s_barrier
    s_waitcnt lgkmcnt(6)
    v_mfma_f32_16x16x32_bf16 v[136:139], v[64:67], a[0:3], 0
    ds_read_b128 v[112:115], v13 offset:12288
    s_add_u32 s63, s60, 49152
    s_mov_b32 m0, s63
    v_mfma_f32_16x16x32_bf16 v[160:163], v[64:67], a[4:7], 0
    buffer_load_dwordx4 v1, s[4:7], s62 offen offset:0 sc1 lds
    v_mfma_f32_16x16x32_bf16 v[140:143], v[68:71], a[0:3], 0
    ds_read_b128 v[116:119], v13 offset:12544
    v_mfma_f32_16x16x32_bf16 v[164:167], v[68:71], a[4:7], 0
    v_lshrrev_b32 v4, 4, v2
    v_mfma_f32_16x16x32_bf16 v[144:147], v[72:75], a[0:3], 0
    ds_read_b128 v[120:123], v13 offset:13312
    v_mfma_f32_16x16x32_bf16 v[168:171], v[72:75], a[4:7], 0
    buffer_load_dwordx4 v1, s[4:7], s62 offen offset:1024 sc1 lds
    v_mfma_f32_16x16x32_bf16 v[148:151], v[76:79], a[0:3], 0
    ds_read_b128 v[124:127], v13 offset:13568
    v_mfma_f32_16x16x32_bf16 v[172:175], v[76:79], a[4:7], 0
    v_mul_u32_u24 v12, 768, v4
    v_mfma_f32_16x16x32_bf16 v[152:155], v[80:83], a[0:3], 0
    ds_read_b128 v[128:131], v13 offset:14336
    v_mfma_f32_16x16x32_bf16 v[176:179], v[80:83], a[4:7], 0
    buffer_load_dwordx4 v1, s[4:7], s62 offen offset:2048 sc1 lds
    s_add_u32 s62, s62, 12288
    v_mfma_f32_16x16x32_bf16 v[156:159], v[84:87], a[0:3], 0
    ds_read_b128 v[132:135], v13 offset:14592
    v_mfma_f32_16x16x32_bf16 v[180:183], v[84:87], a[4:7], 0
    v_lshl_add_u32 v12, v11, 4, v12
    s_waitcnt lgkmcnt(6)
    v_mfma_f32_16x16x32_bf16 v[136:139], v[88:91], a[8:11], v[136:139]
    ds_read_b128 v[64:67], v13 offset:18432
    v_mfma_f32_16x16x32_bf16 v[160:163], v[88:91], a[12:15], v[160:163]
    s_lshl_b32 s59, s52, 2
    v_mfma_f32_16x16x32_bf16 v[140:143], v[92:95], a[8:11], v[140:143]
    ds_read_b128 v[68:71], v13 offset:18688
    v_mfma_f32_16x16x32_bf16 v[164:167], v[92:95], a[12:15], v[164:167]
    s_add_u32 s59, s59, s47
    v_mfma_f32_16x16x32_bf16 v[144:147], v[96:99], a[8:11], v[144:147]
    ds_read_b128 v[72:75], v13 offset:19456
    v_mfma_f32_16x16x32_bf16 v[168:171], v[96:99], a[12:15], v[168:171]
    s_mul_i32 s89, s59, 24576
    v_mfma_f32_16x16x32_bf16 v[148:151], v[100:103], a[8:11], v[148:151]
    ds_read_b128 v[76:79], v13 offset:19712
    v_mfma_f32_16x16x32_bf16 v[172:175], v[100:103], a[12:15], v[172:175]
    s_mul_i32 s56, s53, 3072
    v_mfma_f32_16x16x32_bf16 v[152:155], v[104:107], a[8:11], v[152:155]
    ds_read_b128 v[80:83], v13 offset:20480
    v_mfma_f32_16x16x32_bf16 v[176:179], v[104:107], a[12:15], v[176:179]
    s_add_u32 s59, s89, 13631488
    v_mfma_f32_16x16x32_bf16 v[156:159], v[108:111], a[8:11], v[156:159]
    ds_read_b128 v[84:87], v13 offset:20736
    v_mfma_f32_16x16x32_bf16 v[180:183], v[108:111], a[12:15], v[180:183]
    s_add_u32 s58, s59, s56
    s_waitcnt vmcnt(6)
    s_barrier
    s_waitcnt lgkmcnt(6)
    v_mfma_f32_16x16x32_bf16 v[136:139], v[112:115], a[16:19], v[136:139]
    ds_read_b128 v[88:91], v13 offset:24576
    s_add_u32 s63, s60, 0
    s_mov_b32 m0, s63
    v_mfma_f32_16x16x32_bf16 v[160:163], v[112:115], a[20:23], v[160:163]
    buffer_load_dwordx4 v1, s[4:7], s62 offen offset:0 sc1 lds
    v_mfma_f32_16x16x32_bf16 v[140:143], v[116:119], a[16:19], v[140:143]
    ds_read_b128 v[92:95], v13 offset:24832
    v_mfma_f32_16x16x32_bf16 v[164:167], v[116:119], a[20:23], v[164:167]
    s_lshl_b32 s89, s46, 2
    v_mfma_f32_16x16x32_bf16 v[144:147], v[120:123], a[16:19], v[144:147]
    ds_read_b128 v[96:99], v13 offset:25600
    v_mfma_f32_16x16x32_bf16 v[168:171], v[120:123], a[20:23], v[168:171]
    buffer_load_dwordx4 v1, s[4:7], s62 offen offset:1024 sc1 lds
    v_mfma_f32_16x16x32_bf16 v[148:151], v[124:127], a[16:19], v[148:151]
    ds_read_b128 v[100:103], v13 offset:25856
    v_mfma_f32_16x16x32_bf16 v[172:175], v[124:127], a[20:23], v[172:175]
    s_add_u32 s89, s89, s47
    v_mfma_f32_16x16x32_bf16 v[152:155], v[128:131], a[16:19], v[152:155]
    ds_read_b128 v[104:107], v13 offset:26624
    v_mfma_f32_16x16x32_bf16 v[176:179], v[128:131], a[20:23], v[176:179]
    buffer_load_dwordx4 v1, s[4:7], s62 offen offset:2048 sc1 lds
    s_add_u32 s62, s62, 12288
    v_mfma_f32_16x16x32_bf16 v[156:159], v[132:135], a[16:19], v[156:159]
    ds_read_b128 v[108:111], v13 offset:26880
    v_mfma_f32_16x16x32_bf16 v[180:183], v[132:135], a[20:23], v[180:183]
    s_lshl_b32 s89, s89, 12
    s_waitcnt lgkmcnt(6)
    v_mfma_f32_16x16x32_bf16 v[136:139], v[64:67], a[24:27], v[136:139]
    ds_read_b128 v[112:115], v13 offset:30720
    v_mfma_f32_16x16x32_bf16 v[160:163], v[64:67], a[28:31], v[160:163]
    s_xor_b32 s87, s89, 0x80000
    v_mfma_f32_16x16x32_bf16 v[140:143], v[68:71], a[24:27], v[140:143]
    ds_read_b128 v[116:119], v13 offset:30976
    v_mfma_f32_16x16x32_bf16 v[164:167], v[68:71], a[28:31], v[164:167]
    s_add_u32 s89, s89, 35651584
    v_mfma_f32_16x16x32_bf16 v[144:147], v[72:75], a[24:27], v[144:147]
    ds_read_b128 v[120:123], v13 offset:31744
    v_mfma_f32_16x16x32_bf16 v[168:171], v[72:75], a[28:31], v[168:171]
    s_add_u32 s87, s87, 35651584
    v_mfma_f32_16x16x32_bf16 v[148:151], v[76:79], a[24:27], v[148:151]
    ds_read_b128 v[124:127], v13 offset:32000
    v_mfma_f32_16x16x32_bf16 v[172:175], v[76:79], a[28:31], v[172:175]
    s_lshl_b32 s61, s52, 7
    v_mfma_f32_16x16x32_bf16 v[152:155], v[80:83], a[24:27], v[152:155]
    ds_read_b128 v[128:131], v13 offset:32768
    v_mfma_f32_16x16x32_bf16 v[176:179], v[80:83], a[28:31], v[176:179]
    s_lshl_b32 s56, s47, 5
    v_mfma_f32_16x16x32_bf16 v[156:159], v[84:87], a[24:27], v[156:159]
    ds_read_b128 v[132:135], v13 offset:33024
    v_mfma_f32_16x16x32_bf16 v[180:183], v[84:87], a[28:31], v[180:183]
    s_add_u32 s61, s61, s56
    s_waitcnt vmcnt(6)
    s_barrier
    s_waitcnt lgkmcnt(6)
    v_mfma_f32_16x16x32_bf16 v[136:139], v[88:91], a[32:35], v[136:139]
    ds_read_b128 v[64:67], v13 offset:36864
    s_add_u32 s63, s60, 12288
    s_mov_b32 m0, s63
    v_mfma_f32_16x16x32_bf16 v[160:163], v[88:91], a[36:39], v[160:163]
    buffer_load_dwordx4 v1, s[4:7], s62 offen offset:0 sc1 lds
    v_mfma_f32_16x16x32_bf16 v[140:143], v[92:95], a[32:35], v[140:143]
    ds_read_b128 v[68:71], v13 offset:37120
    v_mfma_f32_16x16x32_bf16 v[164:167], v[92:95], a[36:39], v[164:167]
    s_add_u32 s61, s61, 28672
    v_mfma_f32_16x16x32_bf16 v[144:147], v[96:99], a[32:35], v[144:147]
    ds_read_b128 v[72:75], v13 offset:37888
    v_mfma_f32_16x16x32_bf16 v[168:171], v[96:99], a[36:39], v[168:171]
    buffer_load_dwordx4 v1, s[4:7], s62 offen offset:1024 sc1 lds
    v_mfma_f32_16x16x32_bf16 v[148:151], v[100:103], a[32:35], v[148:151]
    ds_read_b128 v[76:79], v13 offset:38144
    v_mfma_f32_16x16x32_bf16 v[172:175], v[100:103], a[36:39], v[172:175]
    s_lshl_b32 s56, s53, 2
    v_mfma_f32_16x16x32_bf16 v[152:155], v[104:107], a[32:35], v[152:155]
    ds_read_b128 v[80:83], v13 offset:38912
    v_mfma_f32_16x16x32_bf16 v[176:179], v[104:107], a[36:39], v[176:179]
    buffer_load_dwordx4 v1, s[4:7], s62 offen offset:2048 sc1 lds
    s_add_u32 s62, s62, 12288
    v_mfma_f32_16x16x32_bf16 v[156:159], v[108:111], a[32:35], v[156:159]
    ds_read_b128 v[84:87], v13 offset:39168
    v_mfma_f32_16x16x32_bf16 v[180:183], v[108:111], a[36:39], v[180:183]
    s_add_u32 s91, s61, s56
    s_waitcnt lgkmcnt(6)
    v_mfma_f32_16x16x32_bf16 v[136:139], v[112:115], a[40:43], v[136:139]
    ds_read_b128 v[88:91], v13 offset:43008
    v_mfma_f32_16x16x32_bf16 v[160:163], v[112:115], a[44:47], v[160:163]
    s_mul_i32 s24, s53, 0x1e000
    v_mfma_f32_16x16x32_bf16 v[140:143], v[116:119], a[40:43], v[140:143]
    ds_read_b128 v[92:95], v13 offset:43264
    v_mfma_f32_16x16x32_bf16 v[164:167], v[116:119], a[44:47], v[164:167]
    s_add_u32 s24, s24, 8388608
    v_mfma_f32_16x16x32_bf16 v[144:147], v[120:123], a[40:43], v[144:147]
    ds_read_b128 v[96:99], v13 offset:44032
    v_mfma_f32_16x16x32_bf16 v[168:171], v[120:123], a[44:47], v[168:171]
    v_lshlrev_b32 v38, 16, v253
    v_mfma_f32_16x16x32_bf16 v[148:151], v[124:127], a[40:43], v[148:151]
    ds_read_b128 v[100:103], v13 offset:44288
    v_mfma_f32_16x16x32_bf16 v[172:175], v[124:127], a[44:47], v[172:175]
    v_and_b32 v4, 7, v2
    v_mfma_f32_16x16x32_bf16 v[152:155], v[128:131], a[40:43], v[152:155]
    ds_read_b128 v[104:107], v13 offset:45056
    v_mfma_f32_16x16x32_bf16 v[176:179], v[128:131], a[44:47], v[176:179]
    v_lshlrev_b32 v4, 2, v4
    v_mfma_f32_16x16x32_bf16 v[156:159], v[132:135], a[40:43], v[156:159]
    ds_read_b128 v[108:111], v13 offset:45312
    v_mfma_f32_16x16x32_bf16 v[180:183], v[132:135], a[44:47], v[180:183]
    v_min_u32 v14, 23, v2
    s_waitcnt vmcnt(6)
    s_barrier
    s_waitcnt lgkmcnt(6)
    v_mfma_f32_16x16x32_bf16 v[136:139], v[64:67], a[48:51], v[136:139]
    ds_read_b128 v[112:115], v13 offset:49152
    s_add_u32 s63, s60, 24576
    s_mov_b32 m0, s63
    v_mfma_f32_16x16x32_bf16 v[160:163], v[64:67], a[52:55], v[160:163]
    buffer_load_dwordx4 v1, s[4:7], s62 offen offset:0 sc1 lds
    v_mfma_f32_16x16x32_bf16 v[140:143], v[68:71], a[48:51], v[140:143]
    ds_read_b128 v[116:119], v13 offset:49408
    v_mfma_f32_16x16x32_bf16 v[164:167], v[68:71], a[52:55], v[164:167]
    v_lshlrev_b32 v14, 7, v14
    v_mfma_f32_16x16x32_bf16 v[144:147], v[72:75], a[48:51], v[144:147]
    ds_read_b128 v[120:123], v13 offset:50176
    v_mfma_f32_16x16x32_bf16 v[168:171], v[72:75], a[52:55], v[168:171]
    buffer_load_dwordx4 v1, s[4:7], s62 offen offset:1024 sc1 lds
    v_mfma_f32_16x16x32_bf16 v[148:151], v[76:79], a[48:51], v[148:151]
    ds_read_b128 v[124:127], v13 offset:50432
    v_mfma_f32_16x16x32_bf16 v[172:175], v[76:79], a[52:55], v[172:175]
    v_add_u32 v14, s58, v14
    v_mfma_f32_16x16x32_bf16 v[152:155], v[80:83], a[48:51], v[152:155]
    ds_read_b128 v[128:131], v13 offset:51200
    v_mfma_f32_16x16x32_bf16 v[176:179], v[80:83], a[52:55], v[176:179]
    buffer_load_dwordx4 v1, s[4:7], s62 offen offset:2048 sc1 lds
    s_add_u32 s62, s62, 12288
    v_mfma_f32_16x16x32_bf16 v[156:159], v[84:87], a[48:51], v[156:159]
    ds_read_b128 v[132:135], v13 offset:51456
    v_mfma_f32_16x16x32_bf16 v[180:183], v[84:87], a[52:55], v[180:183]
    v_mov_b32 v32, 0
    s_waitcnt lgkmcnt(6)
    v_mfma_f32_16x16x32_bf16 v[136:139], v[88:91], a[56:59], v[136:139]
    ds_read_b128 v[64:67], v13 offset:55296
    v_mfma_f32_16x16x32_bf16 v[160:163], v[88:91], a[60:63], v[160:163]
    v_mov_b32 v34, 0x3f80
    v_mfma_f32_16x16x32_bf16 v[140:143], v[92:95], a[56:59], v[140:143]
    ds_read_b128 v[68:71], v13 offset:55552
    v_mfma_f32_16x16x32_bf16 v[164:167], v[92:95], a[60:63], v[164:167]
    v_mov_b32 v35, 1.0
    v_mfma_f32_16x16x32_bf16 v[144:147], v[96:99], a[56:59], v[144:147]
    ds_read_b128 v[72:75], v13 offset:56320
    v_mfma_f32_16x16x32_bf16 v[168:171], v[96:99], a[60:63], v[168:171]
    v_mfma_f32_16x16x32_bf16 v[148:151], v[100:103], a[56:59], v[148:151]
    ds_read_b128 v[76:79], v13 offset:56576
    v_mfma_f32_16x16x32_bf16 v[172:175], v[100:103], a[60:63], v[172:175]
    v_mfma_f32_16x16x32_bf16 v[152:155], v[104:107], a[56:59], v[152:155]
    ds_read_b128 v[80:83], v13 offset:57344
    v_mfma_f32_16x16x32_bf16 v[176:179], v[104:107], a[60:63], v[176:179]
    v_mfma_f32_16x16x32_bf16 v[156:159], v[108:111], a[56:59], v[156:159]
    ds_read_b128 v[84:87], v13 offset:57600
    v_mfma_f32_16x16x32_bf16 v[180:183], v[108:111], a[60:63], v[180:183]
    s_waitcnt vmcnt(6)
    s_barrier
    s_waitcnt lgkmcnt(6)
    v_mfma_f32_16x16x32_bf16 v[136:139], v[112:115], a[64:67], v[136:139]
    ds_read_b128 v[88:91], v13 offset:0
    s_add_u32 s63, s60, 36864
    s_mov_b32 m0, s63
    v_mfma_f32_16x16x32_bf16 v[160:163], v[112:115], a[68:71], v[160:163]
    buffer_load_dwordx4 v1, s[4:7], s62 offen offset:0 sc1 lds
    v_mfma_f32_16x16x32_bf16 v[140:143], v[116:119], a[64:67], v[140:143]
    ds_read_b128 v[92:95], v13 offset:256
    v_mfma_f32_16x16x32_bf16 v[164:167], v[116:119], a[68:71], v[164:167]
    v_mfma_f32_16x16x32_bf16 v[144:147], v[120:123], a[64:67], v[144:147]
    ds_read_b128 v[96:99], v13 offset:1024
    v_mfma_f32_16x16x32_bf16 v[168:171], v[120:123], a[68:71], v[168:171]
    buffer_load_dwordx4 v1, s[4:7], s62 offen offset:1024 sc1 lds
    v_mfma_f32_16x16x32_bf16 v[148:151], v[124:127], a[64:67], v[148:151]
    ds_read_b128 v[100:103], v13 offset:1280
    v_mfma_f32_16x16x32_bf16 v[172:175], v[124:127], a[68:71], v[172:175]
    v_mfma_f32_16x16x32_bf16 v[152:155], v[128:131], a[64:67], v[152:155]
    ds_read_b128 v[104:107], v13 offset:2048
    v_mfma_f32_16x16x32_bf16 v[176:179], v[128:131], a[68:71], v[176:179]
    buffer_load_dwordx4 v1, s[4:7], s62 offen offset:2048 sc1 lds
    s_add_u32 s62, s62, 12288
    v_mfma_f32_16x16x32_bf16 v[156:159], v[132:135], a[64:67], v[156:159]
    ds_read_b128 v[108:111], v13 offset:2304
    v_mfma_f32_16x16x32_bf16 v[180:183], v[132:135], a[68:71], v[180:183]
    s_waitcnt lgkmcnt(6)
    v_mfma_f32_16x16x32_bf16 v[136:139], v[64:67], a[72:75], v[136:139]
    ds_read_b128 v[112:115], v13 offset:6144
    s_mul_i32 s81, s47, 22528
    s_add_u32 s80, s81, s24
    s_add_u32 s80, s80, 0
    s_add_u32 s81, s81, 61440
    s_mov_b32 m0, s81
    v_mfma_f32_16x16x32_bf16 v[160:163], v[64:67], a[76:79], v[160:163]
    buffer_load_dwordx4 v1, s[4:7], s80 offen offset:0 sc1 lds
    v_mfma_f32_16x16x32_bf16 v[140:143], v[68:71], a[72:75], v[140:143]
    ds_read_b128 v[116:119], v13 offset:6400
    v_mfma_f32_16x16x32_bf16 v[164:167], v[68:71], a[76:79], v[164:167]
    v_mfma_f32_16x16x32_bf16 v[144:147], v[72:75], a[72:75], v[144:147]
    ds_read_b128 v[120:123], v13 offset:7168
    v_mfma_f32_16x16x32_bf16 v[168:171], v[72:75], a[76:79], v[168:171]
    buffer_load_dwordx4 v1, s[4:7], s80 offen offset:1024 sc1 lds
    v_mfma_f32_16x16x32_bf16 v[148:151], v[76:79], a[72:75], v[148:151]
    ds_read_b128 v[124:127], v13 offset:7424
    v_mfma_f32_16x16x32_bf16 v[172:175], v[76:79], a[76:79], v[172:175]
    v_mfma_f32_16x16x32_bf16 v[152:155], v[80:83], a[72:75], v[152:155]
    ds_read_b128 v[128:131], v13 offset:8192
    v_mfma_f32_16x16x32_bf16 v[176:179], v[80:83], a[76:79], v[176:179]
    buffer_load_dwordx4 v1, s[4:7], s80 offen offset:2048 sc1 lds
    v_mfma_f32_16x16x32_bf16 v[156:159], v[84:87], a[72:75], v[156:159]
    ds_read_b128 v[132:135], v13 offset:8448
    v_mfma_f32_16x16x32_bf16 v[180:183], v[84:87], a[76:79], v[180:183]
    s_waitcnt vmcnt(9)
    s_barrier
    s_waitcnt lgkmcnt(6)
    v_mfma_f32_16x16x32_bf16 v[136:139], v[88:91], a[80:83], v[136:139]
    ds_read_b128 v[64:67], v13 offset:12288
    s_add_u32 s63, s60, 49152
    s_mov_b32 m0, s63
    v_mfma_f32_16x16x32_bf16 v[160:163], v[88:91], a[84:87], v[160:163]
    buffer_load_dwordx4 v1, s[4:7], s62 offen offset:0 sc1 lds
    v_mfma_f32_16x16x32_bf16 v[140:143], v[92:95], a[80:83], v[140:143]
    ds_read_b128 v[68:71], v13 offset:12544
    v_mfma_f32_16x16x32_bf16 v[164:167], v[92:95], a[84:87], v[164:167]
    v_mfma_f32_16x16x32_bf16 v[144:147], v[96:99], a[80:83], v[144:147]
    ds_read_b128 v[72:75], v13 offset:13312
    v_mfma_f32_16x16x32_bf16 v[168:171], v[96:99], a[84:87], v[168:171]
    buffer_load_dwordx4 v1, s[4:7], s62 offen offset:1024 sc1 lds
    v_mfma_f32_16x16x32_bf16 v[148:151], v[100:103], a[80:83], v[148:151]
    ds_read_b128 v[76:79], v13 offset:13568
    v_mfma_f32_16x16x32_bf16 v[172:175], v[100:103], a[84:87], v[172:175]
    v_mfma_f32_16x16x32_bf16 v[152:155], v[104:107], a[80:83], v[152:155]
    ds_read_b128 v[80:83], v13 offset:14336
    v_mfma_f32_16x16x32_bf16 v[176:179], v[104:107], a[84:87], v[176:179]
    buffer_load_dwordx4 v1, s[4:7], s62 offen offset:2048 sc1 lds
    s_add_u32 s62, s62, 12288
    v_mfma_f32_16x16x32_bf16 v[156:159], v[108:111], a[80:83], v[156:159]
    ds_read_b128 v[84:87], v13 offset:14592
    v_mfma_f32_16x16x32_bf16 v[180:183], v[108:111], a[84:87], v[180:183]
    s_waitcnt lgkmcnt(6)
    v_mfma_f32_16x16x32_bf16 v[136:139], v[112:115], a[88:91], v[136:139]
    ds_read_b128 v[88:91], v13 offset:18432
    s_mov_b32 m0, s81
    v_mfma_f32_16x16x32_bf16 v[160:163], v[112:115], a[92:95], v[160:163]
    buffer_load_dwordx4 v1, s[4:7], s80 offen offset:3072 sc1 lds
    v_mfma_f32_16x16x32_bf16 v[140:143], v[116:119], a[88:91], v[140:143]
    ds_read_b128 v[92:95], v13 offset:18688
    v_mfma_f32_16x16x32_bf16 v[164:167], v[116:119], a[92:95], v[164:167]
    v_mfma_f32_16x16x32_bf16 v[144:147], v[120:123], a[88:91], v[144:147]
    ds_read_b128 v[96:99], v13 offset:19456
    s_add_u32 s80, s80, 4096
    s_add_u32 s81, s81, 4096
    s_mov_b32 m0, s81
    v_mfma_f32_16x16x32_bf16 v[168:171], v[120:123], a[92:95], v[168:171]
    buffer_load_dwordx4 v1, s[4:7], s80 offen offset:0 sc1 lds
    v_mfma_f32_16x16x32_bf16 v[148:151], v[124:127], a[88:91], v[148:151]
    ds_read_b128 v[100:103], v13 offset:19712
    v_mfma_f32_16x16x32_bf16 v[172:175], v[124:127], a[92:95], v[172:175]
    v_mfma_f32_16x16x32_bf16 v[152:155], v[128:131], a[88:91], v[152:155]
    ds_read_b128 v[104:107], v13 offset:20480
    v_mfma_f32_16x16x32_bf16 v[176:179], v[128:131], a[92:95], v[176:179]
    buffer_load_dwordx4 v1, s[4:7], s80 offen offset:1024 sc1 lds
    v_mfma_f32_16x16x32_bf16 v[156:159], v[132:135], a[88:91], v[156:159]
    ds_read_b128 v[108:111], v13 offset:20736
    v_mfma_f32_16x16x32_bf16 v[180:183], v[132:135], a[92:95], v[180:183]
    s_waitcnt vmcnt(12)
    s_barrier
    s_waitcnt lgkmcnt(6)
    v_mfma_f32_16x16x32_bf16 v[136:139], v[64:67], a[96:99], v[136:139]
    ds_read_b128 v[112:115], v13 offset:24576
    s_add_u32 s63, s60, 0
    s_mov_b32 m0, s63
    v_mfma_f32_16x16x32_bf16 v[160:163], v[64:67], a[100:103], v[160:163]
    buffer_load_dwordx4 v1, s[4:7], s62 offen offset:0 sc1 lds
    v_mfma_f32_16x16x32_bf16 v[140:143], v[68:71], a[96:99], v[140:143]
    ds_read_b128 v[116:119], v13 offset:24832
    v_mfma_f32_16x16x32_bf16 v[164:167], v[68:71], a[100:103], v[164:167]
    v_mfma_f32_16x16x32_bf16 v[144:147], v[72:75], a[96:99], v[144:147]
    ds_read_b128 v[120:123], v13 offset:25600
    v_mfma_f32_16x16x32_bf16 v[168:171], v[72:75], a[100:103], v[168:171]
    buffer_load_dwordx4 v1, s[4:7], s62 offen offset:1024 sc1 lds
    v_mfma_f32_16x16x32_bf16 v[148:151], v[76:79], a[96:99], v[148:151]
    ds_read_b128 v[124:127], v13 offset:25856
    v_mfma_f32_16x16x32_bf16 v[172:175], v[76:79], a[100:103], v[172:175]
    v_mfma_f32_16x16x32_bf16 v[152:155], v[80:83], a[96:99], v[152:155]
    ds_read_b128 v[128:131], v13 offset:26624
    v_mfma_f32_16x16x32_bf16 v[176:179], v[80:83], a[100:103], v[176:179]
    buffer_load_dwordx4 v1, s[4:7], s62 offen offset:2048 sc1 lds
    s_add_u32 s62, s62, 12288
    v_mfma_f32_16x16x32_bf16 v[156:159], v[84:87], a[96:99], v[156:159]
    ds_read_b128 v[132:135], v13 offset:26880
    v_mfma_f32_16x16x32_bf16 v[180:183], v[84:87], a[100:103], v[180:183]
    s_waitcnt lgkmcnt(6)
    v_mfma_f32_16x16x32_bf16 v[136:139], v[88:91], a[104:107], v[136:139]
    ds_read_b128 v[64:67], v13 offset:30720
    s_mov_b32 m0, s81
    v_mfma_f32_16x16x32_bf16 v[160:163], v[88:91], a[108:111], v[160:163]
    buffer_load_dwordx4 v1, s[4:7], s80 offen offset:2048 sc1 lds
    v_mfma_f32_16x16x32_bf16 v[140:143], v[92:95], a[104:107], v[140:143]
    ds_read_b128 v[68:71], v13 offset:30976
    v_mfma_f32_16x16x32_bf16 v[164:167], v[92:95], a[108:111], v[164:167]
    v_mfma_f32_16x16x32_bf16 v[144:147], v[96:99], a[104:107], v[144:147]
    ds_read_b128 v[72:75], v13 offset:31744
    v_mfma_f32_16x16x32_bf16 v[168:171], v[96:99], a[108:111], v[168:171]
    buffer_load_dwordx4 v1, s[4:7], s80 offen offset:3072 sc1 lds
    v_mfma_f32_16x16x32_bf16 v[148:151], v[100:103], a[104:107], v[148:151]
    ds_read_b128 v[76:79], v13 offset:32000
    v_mfma_f32_16x16x32_bf16 v[172:175], v[100:103], a[108:111], v[172:175]
    v_mfma_f32_16x16x32_bf16 v[152:155], v[104:107], a[104:107], v[152:155]
    ds_read_b128 v[80:83], v13 offset:32768
    s_add_u32 s80, s80, 4096
    s_add_u32 s81, s81, 4096
    s_mov_b32 m0, s81
    v_mfma_f32_16x16x32_bf16 v[176:179], v[104:107], a[108:111], v[176:179]
    buffer_load_dwordx4 v1, s[4:7], s80 offen offset:0 sc1 lds
    v_mfma_f32_16x16x32_bf16 v[156:159], v[108:111], a[104:107], v[156:159]
    ds_read_b128 v[84:87], v13 offset:33024
    v_mfma_f32_16x16x32_bf16 v[180:183], v[108:111], a[108:111], v[180:183]
    s_waitcnt vmcnt(15)
    s_barrier
    s_waitcnt lgkmcnt(6)
    v_mfma_f32_16x16x32_bf16 v[136:139], v[112:115], a[112:115], v[136:139]
    ds_read_b128 v[88:91], v13 offset:36864
    s_add_u32 s63, s60, 12288
    s_mov_b32 m0, s63
    v_mfma_f32_16x16x32_bf16 v[160:163], v[112:115], a[116:119], v[160:163]
    buffer_load_dwordx4 v1, s[4:7], s62 offen offset:0 sc1 lds
    v_mfma_f32_16x16x32_bf16 v[140:143], v[116:119], a[112:115], v[140:143]
    ds_read_b128 v[92:95], v13 offset:37120
    v_mfma_f32_16x16x32_bf16 v[164:167], v[116:119], a[116:119], v[164:167]
    v_mfma_f32_16x16x32_bf16 v[144:147], v[120:123], a[112:115], v[144:147]
    ds_read_b128 v[96:99], v13 offset:37888
    v_mfma_f32_16x16x32_bf16 v[168:171], v[120:123], a[116:119], v[168:171]
    buffer_load_dwordx4 v1, s[4:7], s62 offen offset:1024 sc1 lds
    v_mfma_f32_16x16x32_bf16 v[148:151], v[124:127], a[112:115], v[148:151]
    ds_read_b128 v[100:103], v13 offset:38144
    v_mfma_f32_16x16x32_bf16 v[172:175], v[124:127], a[116:119], v[172:175]
    v_mfma_f32_16x16x32_bf16 v[152:155], v[128:131], a[112:115], v[152:155]
    ds_read_b128 v[104:107], v13 offset:38912
    v_mfma_f32_16x16x32_bf16 v[176:179], v[128:131], a[116:119], v[176:179]
    buffer_load_dwordx4 v1, s[4:7], s62 offen offset:2048 sc1 lds
    s_add_u32 s62, s62, 12288
    v_mfma_f32_16x16x32_bf16 v[156:159], v[132:135], a[112:115], v[156:159]
    ds_read_b128 v[108:111], v13 offset:39168
    v_mfma_f32_16x16x32_bf16 v[180:183], v[132:135], a[116:119], v[180:183]
    s_waitcnt lgkmcnt(6)
    v_mfma_f32_16x16x32_bf16 v[136:139], v[64:67], a[120:123], v[136:139]
    ds_read_b128 v[112:115], v13 offset:43008
    s_mov_b32 m0, s81
    v_mfma_f32_16x16x32_bf16 v[160:163], v[64:67], a[124:127], v[160:163]
    buffer_load_dwordx4 v1, s[4:7], s80 offen offset:1024 sc1 lds
    v_mfma_f32_16x16x32_bf16 v[140:143], v[68:71], a[120:123], v[140:143]
    ds_read_b128 v[116:119], v13 offset:43264
    v_mfma_f32_16x16x32_bf16 v[164:167], v[68:71], a[124:127], v[164:167]
    v_mfma_f32_16x16x32_bf16 v[144:147], v[72:75], a[120:123], v[144:147]
    ds_read_b128 v[120:123], v13 offset:44032
    v_mfma_f32_16x16x32_bf16 v[168:171], v[72:75], a[124:127], v[168:171]
    buffer_load_dword v36, v14, s[4:7], 0 offen sc1
    v_mfma_f32_16x16x32_bf16 v[148:151], v[76:79], a[120:123], v[148:151]
    ds_read_b128 v[124:127], v13 offset:44288
    v_mfma_f32_16x16x32_bf16 v[172:175], v[76:79], a[124:127], v[172:175]
    v_mfma_f32_16x16x32_bf16 v[152:155], v[80:83], a[120:123], v[152:155]
    ds_read_b128 v[128:131], v13 offset:45056
    v_mfma_f32_16x16x32_bf16 v[176:179], v[80:83], a[124:127], v[176:179]
    buffer_load_dwordx4 v1, s[4:7], s80 offen offset:2048 sc1 lds
    v_mfma_f32_16x16x32_bf16 v[156:159], v[84:87], a[120:123], v[156:159]
    ds_read_b128 v[132:135], v13 offset:45312
    v_mfma_f32_16x16x32_bf16 v[180:183], v[84:87], a[124:127], v[180:183]
    s_waitcnt vmcnt(15)
    s_barrier
    s_waitcnt lgkmcnt(6)
    v_mfma_f32_16x16x32_bf16 v[136:139], v[88:91], a[128:131], v[136:139]
    ds_read_b128 v[64:67], v13 offset:49152
    v_mfma_f32_16x16x32_bf16 v[160:163], v[88:91], a[132:135], v[160:163]
    buffer_load_dwordx4 a[196:199], v254, s[4:7], s93 offen offset:0 sc1
    v_mfma_f32_16x16x32_bf16 v[140:143], v[92:95], a[128:131], v[140:143]
    ds_read_b128 v[68:71], v13 offset:49408
    v_mfma_f32_16x16x32_bf16 v[164:167], v[92:95], a[132:135], v[164:167]
    v_mfma_f32_16x16x32_bf16 v[144:147], v[96:99], a[128:131], v[144:147]
    ds_read_b128 v[72:75], v13 offset:50176
    v_mfma_f32_16x16x32_bf16 v[168:171], v[96:99], a[132:135], v[168:171]
    buffer_load_dwordx4 a[200:203], v254, s[4:7], s101 offen offset:2048 sc1
    v_mfma_f32_16x16x32_bf16 v[148:151], v[100:103], a[128:131], v[148:151]
    ds_read_b128 v[76:79], v13 offset:50432
    v_mfma_f32_16x16x32_bf16 v[172:175], v[100:103], a[132:135], v[172:175]
    v_mfma_f32_16x16x32_bf16 v[152:155], v[104:107], a[128:131], v[152:155]
    ds_read_b128 v[80:83], v13 offset:51200
    v_mfma_f32_16x16x32_bf16 v[176:179], v[104:107], a[132:135], v[176:179]
    buffer_load_dwordx4 a[204:207], v254, s[4:7], s93 offen offset:2048 sc1
    v_mfma_f32_16x16x32_bf16 v[156:159], v[108:111], a[128:131], v[156:159]
    ds_read_b128 v[84:87], v13 offset:51456
    v_mfma_f32_16x16x32_bf16 v[180:183], v[108:111], a[132:135], v[180:183]
    s_waitcnt lgkmcnt(6)
    v_mfma_f32_16x16x32_bf16 v[136:139], v[112:115], a[136:139], v[136:139]
    ds_read_b128 v[88:91], v13 offset:55296
    s_add_u32 s63, s60, 24576
    s_mov_b32 m0, s63
    v_mfma_f32_16x16x32_bf16 v[160:163], v[112:115], a[140:143], v[160:163]
    buffer_load_dwordx4 v1, s[4:7], s62 offen offset:0 sc1 lds
    v_mfma_f32_16x16x32_bf16 v[140:143], v[116:119], a[136:139], v[140:143]
    ds_read_b128 v[92:95], v13 offset:55552
    v_mfma_f32_16x16x32_bf16 v[164:167], v[116:119], a[140:143], v[164:167]
    v_mfma_f32_16x16x32_bf16 v[144:147], v[120:123], a[136:139], v[144:147]
    ds_read_b128 v[96:99], v13 offset:56320
    v_mfma_f32_16x16x32_bf16 v[168:171], v[120:123], a[140:143], v[168:171]
    buffer_load_dwordx4 v1, s[4:7], s62 offen offset:1024 sc1 lds
    v_mfma_f32_16x16x32_bf16 v[148:151], v[124:127], a[136:139], v[148:151]
    ds_read_b128 v[100:103], v13 offset:56576
    v_mfma_f32_16x16x32_bf16 v[172:175], v[124:127], a[140:143], v[172:175]
    v_mfma_f32_16x16x32_bf16 v[152:155], v[128:131], a[136:139], v[152:155]
    ds_read_b128 v[104:107], v13 offset:57344
    v_mfma_f32_16x16x32_bf16 v[176:179], v[128:131], a[140:143], v[176:179]
    buffer_load_dwordx4 v1, s[4:7], s62 offen offset:2048 sc1 lds
    s_add_u32 s62, s62, 12288
    v_mfma_f32_16x16x32_bf16 v[156:159], v[132:135], a[136:139], v[156:159]
    ds_read_b128 v[108:111], v13 offset:57600
    v_mfma_f32_16x16x32_bf16 v[180:183], v[132:135], a[140:143], v[180:183]
    s_waitcnt vmcnt(15)
    s_barrier
    s_waitcnt lgkmcnt(6)
    v_mfma_f32_16x16x32_bf16 v[136:139], v[64:67], a[144:147], v[136:139]
    ds_read_b128 v[112:115], v13 offset:0
    v_mfma_f32_16x16x32_bf16 v[160:163], v[64:67], a[148:151], v[160:163]
    s_add_u32 s101, s101, 4096
    s_add_u32 s93, s93, 4096
    buffer_load_dwordx4 a[208:211], v254, s[4:7], s101 offen offset:0 sc1
    v_mfma_f32_16x16x32_bf16 v[140:143], v[68:71], a[144:147], v[140:143]
    ds_read_b128 v[116:119], v13 offset:256
    v_mfma_f32_16x16x32_bf16 v[164:167], v[68:71], a[148:151], v[164:167]
    v_mfma_f32_16x16x32_bf16 v[144:147], v[72:75], a[144:147], v[144:147]
    ds_read_b128 v[120:123], v13 offset:1024
    v_mfma_f32_16x16x32_bf16 v[168:171], v[72:75], a[148:151], v[168:171]
    buffer_load_dwordx4 a[212:215], v254, s[4:7], s93 offen offset:0 sc1
    v_mfma_f32_16x16x32_bf16 v[148:151], v[76:79], a[144:147], v[148:151]
    ds_read_b128 v[124:127], v13 offset:1280
    v_mfma_f32_16x16x32_bf16 v[172:175], v[76:79], a[148:151], v[172:175]
    v_mfma_f32_16x16x32_bf16 v[152:155], v[80:83], a[144:147], v[152:155]
    ds_read_b128 v[128:131], v13 offset:2048
    v_mfma_f32_16x16x32_bf16 v[176:179], v[80:83], a[148:151], v[176:179]
    buffer_load_dwordx4 a[216:219], v254, s[4:7], s101 offen offset:2048 sc1
    v_mfma_f32_16x16x32_bf16 v[156:159], v[84:87], a[144:147], v[156:159]
    ds_read_b128 v[132:135], v13 offset:2304
    v_mfma_f32_16x16x32_bf16 v[180:183], v[84:87], a[148:151], v[180:183]
    s_waitcnt lgkmcnt(6)
    v_mfma_f32_16x16x32_bf16 v[136:139], v[88:91], a[152:155], v[136:139]
    ds_read_b128 v[64:67], v13 offset:6144
    v_mfma_f32_16x16x32_bf16 v[160:163], v[88:91], a[156:159], v[160:163]
    buffer_load_dwordx4 a[220:223], v254, s[4:7], s93 offen offset:2048 sc1
    v_mfma_f32_16x16x32_bf16 v[140:143], v[92:95], a[152:155], v[140:143]
    ds_read_b128 v[68:71], v13 offset:6400
    v_mfma_f32_16x16x32_bf16 v[164:167], v[92:95], a[156:159], v[164:167]
    v_mfma_f32_16x16x32_bf16 v[144:147], v[96:99], a[152:155], v[144:147]
    ds_read_b128 v[72:75], v13 offset:7168
    s_add_u32 s63, s60, 36864
    s_mov_b32 m0, s63
    v_mfma_f32_16x16x32_bf16 v[168:171], v[96:99], a[156:159], v[168:171]
    buffer_load_dwordx4 v1, s[4:7], s62 offen offset:0 sc1 lds
    v_mfma_f32_16x16x32_bf16 v[148:151], v[100:103], a[152:155], v[148:151]
    ds_read_b128 v[76:79], v13 offset:7424
    v_mfma_f32_16x16x32_bf16 v[172:175], v[100:103], a[156:159], v[172:175]
    v_mfma_f32_16x16x32_bf16 v[152:155], v[104:107], a[152:155], v[152:155]
    ds_read_b128 v[80:83], v13 offset:8192
    v_mfma_f32_16x16x32_bf16 v[176:179], v[104:107], a[156:159], v[176:179]
    buffer_load_dwordx4 v1, s[4:7], s62 offen offset:1024 sc1 lds
    v_mfma_f32_16x16x32_bf16 v[156:159], v[108:111], a[152:155], v[156:159]
    ds_read_b128 v[84:87], v13 offset:8448
    v_mfma_f32_16x16x32_bf16 v[180:183], v[108:111], a[156:159], v[180:183]
    buffer_load_dwordx4 v1, s[4:7], s62 offen offset:2048 sc1 lds
    s_add_u32 s62, s62, 12288
    s_waitcnt vmcnt(16)
    s_barrier
    s_waitcnt lgkmcnt(6)
    v_mfma_f32_16x16x32_bf16 v[136:139], v[112:115], a[160:163], v[136:139]
    ds_read_b128 v[88:91], v13 offset:12288
    v_mfma_f32_16x16x32_bf16 v[160:163], v[112:115], a[164:167], v[160:163]
    s_add_u32 s101, s101, 4096
    s_add_u32 s93, s93, 4096
    buffer_load_dwordx4 a[224:227], v254, s[4:7], s101 offen offset:0 sc1
    v_mfma_f32_16x16x32_bf16 v[140:143], v[116:119], a[160:163], v[140:143]
    ds_read_b128 v[92:95], v13 offset:12544
    v_mfma_f32_16x16x32_bf16 v[164:167], v[116:119], a[164:167], v[164:167]
    v_mfma_f32_16x16x32_bf16 v[144:147], v[120:123], a[160:163], v[144:147]
    ds_read_b128 v[96:99], v13 offset:13312
    v_mfma_f32_16x16x32_bf16 v[168:171], v[120:123], a[164:167], v[168:171]
    buffer_load_dwordx4 a[228:231], v254, s[4:7], s93 offen offset:0 sc1
    v_mfma_f32_16x16x32_bf16 v[148:151], v[124:127], a[160:163], v[148:151]
    ds_read_b128 v[100:103], v13 offset:13568
    v_mfma_f32_16x16x32_bf16 v[172:175], v[124:127], a[164:167], v[172:175]
    v_mfma_f32_16x16x32_bf16 v[152:155], v[128:131], a[160:163], v[152:155]
    ds_read_b128 v[104:107], v13 offset:14336
    v_mfma_f32_16x16x32_bf16 v[176:179], v[128:131], a[164:167], v[176:179]
    buffer_load_dwordx4 a[232:235], v254, s[4:7], s101 offen offset:2048 sc1
    v_mfma_f32_16x16x32_bf16 v[156:159], v[132:135], a[160:163], v[156:159]
    ds_read_b128 v[108:111], v13 offset:14592
    v_mfma_f32_16x16x32_bf16 v[180:183], v[132:135], a[164:167], v[180:183]
    s_waitcnt lgkmcnt(6)
    v_mfma_f32_16x16x32_bf16 v[136:139], v[64:67], a[168:171], v[136:139]
    ds_read_b128 v[112:115], v13 offset:18432
    v_mfma_f32_16x16x32_bf16 v[160:163], v[64:67], a[172:175], v[160:163]
    buffer_load_dwordx4 a[236:239], v254, s[4:7], s93 offen offset:2048 sc1
    v_mfma_f32_16x16x32_bf16 v[140:143], v[68:71], a[168:171], v[140:143]
    ds_read_b128 v[116:119], v13 offset:18688
    v_mfma_f32_16x16x32_bf16 v[164:167], v[68:71], a[172:175], v[164:167]
    v_mfma_f32_16x16x32_bf16 v[144:147], v[72:75], a[168:171], v[144:147]
    ds_read_b128 v[120:123], v13 offset:19456
    s_add_u32 s63, s60, 49152
    s_mov_b32 m0, s63
    v_mfma_f32_16x16x32_bf16 v[168:171], v[72:75], a[172:175], v[168:171]
    buffer_load_dwordx4 v1, s[4:7], s62 offen offset:0 sc1 lds
    v_mfma_f32_16x16x32_bf16 v[148:151], v[76:79], a[168:171], v[148:151]
    ds_read_b128 v[124:127], v13 offset:19712
    v_mfma_f32_16x16x32_bf16 v[172:175], v[76:79], a[172:175], v[172:175]
    v_mfma_f32_16x16x32_bf16 v[152:155], v[80:83], a[168:171], v[152:155]
    ds_read_b128 v[128:131], v13 offset:20480
    v_mfma_f32_16x16x32_bf16 v[176:179], v[80:83], a[172:175], v[176:179]
    buffer_load_dwordx4 v1, s[4:7], s62 offen offset:1024 sc1 lds
    v_mfma_f32_16x16x32_bf16 v[156:159], v[84:87], a[168:171], v[156:159]
    ds_read_b128 v[132:135], v13 offset:20736
    v_mfma_f32_16x16x32_bf16 v[180:183], v[84:87], a[172:175], v[180:183]
    buffer_load_dwordx4 v1, s[4:7], s62 offen offset:2048 sc1 lds
    s_add_u32 s62, s62, 12288
    s_waitcnt vmcnt(14)
    s_barrier
    s_waitcnt lgkmcnt(6)
    v_mfma_f32_16x16x32_bf16 v[136:139], v[88:91], a[176:179], v[136:139]
    ds_read_b128 v[64:67], v13 offset:24576
    v_mfma_f32_16x16x32_bf16 v[160:163], v[88:91], a[180:183], v[160:163]
    s_add_u32 s101, s101, 4096
    s_add_u32 s93, s93, 4096
    buffer_load_dwordx4 a[240:243], v254, s[4:7], s101 offen offset:0 sc1
    v_mfma_f32_16x16x32_bf16 v[140:143], v[92:95], a[176:179], v[140:143]
    ds_read_b128 v[68:71], v13 offset:24832
    v_mfma_f32_16x16x32_bf16 v[164:167], v[92:95], a[180:183], v[164:167]
    v_mfma_f32_16x16x32_bf16 v[144:147], v[96:99], a[176:179], v[144:147]
    ds_read_b128 v[72:75], v13 offset:25600
    v_mfma_f32_16x16x32_bf16 v[168:171], v[96:99], a[180:183], v[168:171]
    buffer_load_dwordx4 a[244:247], v254, s[4:7], s93 offen offset:0 sc1
    v_mfma_f32_16x16x32_bf16 v[148:151], v[100:103], a[176:179], v[148:151]
    ds_read_b128 v[76:79], v13 offset:25856
    v_mfma_f32_16x16x32_bf16 v[172:175], v[100:103], a[180:183], v[172:175]
    v_mfma_f32_16x16x32_bf16 v[152:155], v[104:107], a[176:179], v[152:155]
    ds_read_b128 v[80:83], v13 offset:26624
    v_mfma_f32_16x16x32_bf16 v[176:179], v[104:107], a[180:183], v[176:179]
    buffer_load_dwordx4 a[248:251], v254, s[4:7], s101 offen offset:2048 sc1
    v_mfma_f32_16x16x32_bf16 v[156:159], v[108:111], a[176:179], v[156:159]
    ds_read_b128 v[84:87], v13 offset:26880
    v_mfma_f32_16x16x32_bf16 v[180:183], v[108:111], a[180:183], v[180:183]
    s_waitcnt lgkmcnt(6)
    v_mfma_f32_16x16x32_bf16 v[136:139], v[112:115], a[184:187], v[136:139]
    ds_read_b128 v[88:91], v13 offset:30720
    v_mfma_f32_16x16x32_bf16 v[160:163], v[112:115], a[188:191], v[160:163]
    buffer_load_dwordx4 a[252:255], v254, s[4:7], s93 offen offset:2048 sc1
    v_mfma_f32_16x16x32_bf16 v[140:143], v[116:119], a[184:187], v[140:143]
    ds_read_b128 v[92:95], v13 offset:30976
    v_mfma_f32_16x16x32_bf16 v[164:167], v[116:119], a[188:191], v[164:167]
    v_mfma_f32_16x16x32_bf16 v[144:147], v[120:123], a[184:187], v[144:147]
    ds_read_b128 v[96:99], v13 offset:31744
    s_add_u32 s63, s60, 0
    s_mov_b32 m0, s63
    v_mfma_f32_16x16x32_bf16 v[168:171], v[120:123], a[188:191], v[168:171]
    buffer_load_dwordx4 v1, s[4:7], s62 offen offset:0 sc1 lds
    v_mfma_f32_16x16x32_bf16 v[148:151], v[124:127], a[184:187], v[148:151]
    ds_read_b128 v[100:103], v13 offset:32000
    v_mfma_f32_16x16x32_bf16 v[172:175], v[124:127], a[188:191], v[172:175]
    v_mfma_f32_16x16x32_bf16 v[152:155], v[128:131], a[184:187], v[152:155]
    ds_read_b128 v[104:107], v13 offset:32768
    v_mfma_f32_16x16x32_bf16 v[176:179], v[128:131], a[188:191], v[176:179]
    buffer_load_dwordx4 v1, s[4:7], s62 offen offset:1024 sc1 lds
    v_mfma_f32_16x16x32_bf16 v[156:159], v[132:135], a[184:187], v[156:159]
    ds_read_b128 v[108:111], v13 offset:33024
    v_mfma_f32_16x16x32_bf16 v[180:183], v[132:135], a[188:191], v[180:183]
    buffer_load_dwordx4 v1, s[4:7], s62 offen offset:2048 sc1 lds
    s_add_u32 s62, s62, 12288
    s_waitcnt vmcnt(14)
    s_barrier
    s_waitcnt lgkmcnt(6)
    v_mfma_f32_16x16x32_bf16 v[160:163], v[64:67], a[196:199], v[160:163]
    ds_read_b128 v[112:115], v13 offset:36864
    v_mfma_f32_16x16x32_bf16 v[164:167], v[68:71], a[196:199], v[164:167]
    ds_read_b128 v[116:119], v13 offset:37120
    v_mfma_f32_16x16x32_bf16 v[168:171], v[72:75], a[196:199], v[168:171]
    ds_read_b128 v[120:123], v13 offset:37888
    v_mfma_f32_16x16x32_bf16 v[172:175], v[76:79], a[196:199], v[172:175]
    ds_read_b128 v[124:127], v13 offset:38144
    v_mfma_f32_16x16x32_bf16 v[176:179], v[80:83], a[196:199], v[176:179]
    ds_read_b128 v[128:131], v13 offset:38912
    v_mfma_f32_16x16x32_bf16 v[180:183], v[84:87], a[196:199], v[180:183]
    ds_read_b128 v[132:135], v13 offset:39168
    s_waitcnt lgkmcnt(6)
    v_mfma_f32_16x16x32_bf16 v[160:163], v[88:91], a[204:207], v[160:163]
    ds_read_b128 v[64:67], v13 offset:43008
    v_mfma_f32_16x16x32_bf16 v[164:167], v[92:95], a[204:207], v[164:167]
    ds_read_b128 v[68:71], v13 offset:43264
    v_mfma_f32_16x16x32_bf16 v[168:171], v[96:99], a[204:207], v[168:171]
    ds_read_b128 v[72:75], v13 offset:44032
    v_mfma_f32_16x16x32_bf16 v[172:175], v[100:103], a[204:207], v[172:175]
    ds_read_b128 v[76:79], v13 offset:44288
    v_mfma_f32_16x16x32_bf16 v[176:179], v[104:107], a[204:207], v[176:179]
    ds_read_b128 v[80:83], v13 offset:45056
    v_mfma_f32_16x16x32_bf16 v[180:183], v[108:111], a[204:207], v[180:183]
    ds_read_b128 v[84:87], v13 offset:45312
    s_waitcnt vmcnt(7)
    s_barrier
    s_waitcnt lgkmcnt(6)
    v_mfma_f32_16x16x32_bf16 v[160:163], v[112:115], a[212:215], v[160:163]
    ds_read_b128 v[88:91], v13 offset:49152
    v_mfma_f32_16x16x32_bf16 v[164:167], v[116:119], a[212:215], v[164:167]
    ds_read_b128 v[92:95], v13 offset:49408
    v_mfma_f32_16x16x32_bf16 v[168:171], v[120:123], a[212:215], v[168:171]
    ds_read_b128 v[96:99], v13 offset:50176
    v_mfma_f32_16x16x32_bf16 v[172:175], v[124:127], a[212:215], v[172:175]
    ds_read_b128 v[100:103], v13 offset:50432
    v_mfma_f32_16x16x32_bf16 v[176:179], v[128:131], a[212:215], v[176:179]
    ds_read_b128 v[104:107], v13 offset:51200
    v_mfma_f32_16x16x32_bf16 v[180:183], v[132:135], a[212:215], v[180:183]
    ds_read_b128 v[108:111], v13 offset:51456
    s_waitcnt lgkmcnt(6)
    v_mfma_f32_16x16x32_bf16 v[160:163], v[64:67], a[220:223], v[160:163]
    ds_read_b128 v[112:115], v13 offset:55296
    v_mfma_f32_16x16x32_bf16 v[164:167], v[68:71], a[220:223], v[164:167]
    ds_read_b128 v[116:119], v13 offset:55552
    v_mfma_f32_16x16x32_bf16 v[168:171], v[72:75], a[220:223], v[168:171]
    ds_read_b128 v[120:123], v13 offset:56320
    v_mfma_f32_16x16x32_bf16 v[172:175], v[76:79], a[220:223], v[172:175]
    ds_read_b128 v[124:127], v13 offset:56576
    v_mfma_f32_16x16x32_bf16 v[176:179], v[80:83], a[220:223], v[176:179]
    ds_read_b128 v[128:131], v13 offset:57344
    v_mfma_f32_16x16x32_bf16 v[180:183], v[84:87], a[220:223], v[180:183]
    ds_read_b128 v[132:135], v13 offset:57600
    s_waitcnt vmcnt(0)
    s_barrier
    s_waitcnt lgkmcnt(6)
    v_mfma_f32_16x16x32_bf16 v[160:163], v[88:91], a[228:231], v[160:163]
    ds_read_b128 v[64:67], v13 offset:0
    v_mfma_f32_16x16x32_bf16 v[164:167], v[92:95], a[228:231], v[164:167]
    ds_read_b128 v[68:71], v13 offset:256
    v_mfma_f32_16x16x32_bf16 v[168:171], v[96:99], a[228:231], v[168:171]
    ds_read_b128 v[72:75], v13 offset:1024
    v_mfma_f32_16x16x32_bf16 v[172:175], v[100:103], a[228:231], v[172:175]
    ds_read_b128 v[76:79], v13 offset:1280
    v_mfma_f32_16x16x32_bf16 v[176:179], v[104:107], a[228:231], v[176:179]
    ds_read_b128 v[80:83], v13 offset:2048
    v_mfma_f32_16x16x32_bf16 v[180:183], v[108:111], a[228:231], v[180:183]
    ds_read_b128 v[84:87], v13 offset:2304
    s_waitcnt lgkmcnt(6)
    v_mfma_f32_16x16x32_bf16 v[160:163], v[112:115], a[236:239], v[160:163]
    ds_read_b128 v[88:91], v13 offset:6144
    v_mfma_f32_16x16x32_bf16 v[164:167], v[116:119], a[236:239], v[164:167]
    ds_read_b128 v[92:95], v13 offset:6400
    v_mfma_f32_16x16x32_bf16 v[168:171], v[120:123], a[236:239], v[168:171]
    ds_read_b128 v[96:99], v13 offset:7168
    v_mfma_f32_16x16x32_bf16 v[172:175], v[124:127], a[236:239], v[172:175]
    ds_read_b128 v[100:103], v13 offset:7424
    v_mfma_f32_16x16x32_bf16 v[176:179], v[128:131], a[236:239], v[176:179]
    ds_read_b128 v[104:107], v13 offset:8192
    v_mfma_f32_16x16x32_bf16 v[180:183], v[132:135], a[236:239], v[180:183]
    ds_read_b128 v[108:111], v13 offset:8448
    s_waitcnt lgkmcnt(6)
    v_mfma_f32_16x16x32_bf16 v[160:163], v[64:67], a[244:247], v[160:163]
    ds_read_b128 v[112:115], v13 offset:24576
    v_mfma_f32_16x16x32_bf16 v[164:167], v[68:71], a[244:247], v[164:167]
    ds_read_b128 v[116:119], v13 offset:24832
    v_mfma_f32_16x16x32_bf16 v[168:171], v[72:75], a[244:247], v[168:171]
    ds_read_b128 v[120:123], v13 offset:25600
    v_mfma_f32_16x16x32_bf16 v[172:175], v[76:79], a[244:247], v[172:175]
    ds_read_b128 v[124:127], v13 offset:25856
    v_mfma_f32_16x16x32_bf16 v[176:179], v[80:83], a[244:247], v[176:179]
    ds_read_b128 v[128:131], v13 offset:26624
    v_mfma_f32_16x16x32_bf16 v[180:183], v[84:87], a[244:247], v[180:183]
    ds_read_b128 v[132:135], v13 offset:26880
    s_waitcnt lgkmcnt(6)
    v_mfma_f32_16x16x32_bf16 v[160:163], v[88:91], a[252:255], v[160:163]
    ds_read_b128 v[64:67], v13 offset:30720
    v_mfma_f32_16x16x32_bf16 v[164:167], v[92:95], a[252:255], v[164:167]
    ds_read_b128 v[68:71], v13 offset:30976
    v_mfma_f32_16x16x32_bf16 v[168:171], v[96:99], a[252:255], v[168:171]
    ds_read_b128 v[72:75], v13 offset:31744
    v_mfma_f32_16x16x32_bf16 v[172:175], v[100:103], a[252:255], v[172:175]
    ds_read_b128 v[76:79], v13 offset:32000
    v_mfma_f32_16x16x32_bf16 v[176:179], v[104:107], a[252:255], v[176:179]
    ds_read_b128 v[80:83], v13 offset:32768
    v_mfma_f32_16x16x32_bf16 v[180:183], v[108:111], a[252:255], v[180:183]
    ds_read_b128 v[84:87], v13 offset:33024
    s_waitcnt lgkmcnt(6)
    v_mfma_f32_16x16x32_bf16 v[136:139], v[112:115], a[192:195], v[136:139]
    ds_read_b128 v[88:91], v13 offset:36864
    v_mfma_f32_16x16x32_bf16 v[140:143], v[116:119], a[192:195], v[140:143]
    ds_read_b128 v[92:95], v13 offset:37120
    v_mfma_f32_16x16x32_bf16 v[144:147], v[120:123], a[192:195], v[144:147]
    ds_read_b128 v[96:99], v13 offset:37888
    v_mfma_f32_16x16x32_bf16 v[148:151], v[124:127], a[192:195], v[148:151]
    ds_read_b128 v[100:103], v13 offset:38144
    v_mfma_f32_16x16x32_bf16 v[152:155], v[128:131], a[192:195], v[152:155]
    ds_read_b128 v[104:107], v13 offset:38912
    v_mfma_f32_16x16x32_bf16 v[156:159], v[132:135], a[192:195], v[156:159]
    ds_read_b128 v[108:111], v13 offset:39168
    v_cvt_pk_bf16_f32 v184, v160, v161
    v_cvt_pk_bf16_f32 v185, v162, v163
    v_cvt_pk_bf16_f32 v186, v164, v165
    v_cvt_pk_bf16_f32 v188, v166, v167
    v_cvt_pk_bf16_f32 v189, v168, v169
    v_cvt_pk_bf16_f32 v190, v170, v171
    v_cvt_pk_bf16_f32 v192, v172, v173
    v_cvt_pk_bf16_f32 v193, v174, v175
    v_cvt_pk_bf16_f32 v194, v176, v177
    v_cvt_pk_bf16_f32 v196, v178, v179
    v_cvt_pk_bf16_f32 v197, v180, v181
    v_cvt_pk_bf16_f32 v198, v182, v183
    v_mov_b32 v187, s44
    v_mov_b32 v191, s44
    v_mov_b32 v195, s44
    v_mov_b32 v199, s44
    buffer_store_dwordx4 v[184:187], v1, s[4:7], s87 offen offset:0 sc1
    buffer_store_dwordx4 v[188:191], v1, s[4:7], s87 offen offset:1024 sc1
    buffer_store_dwordx4 v[192:195], v1, s[4:7], s87 offen offset:2048 sc1
    buffer_store_dwordx4 v[196:199], v1, s[4:7], s87 offen offset:3072 sc1
    s_waitcnt lgkmcnt(6)
    v_mfma_f32_16x16x32_bf16 v[136:139], v[64:67], a[200:203], v[136:139]
    ds_read_b128 v[112:115], v13 offset:43008
    v_mfma_f32_16x16x32_bf16 v[140:143], v[68:71], a[200:203], v[140:143]
    ds_read_b128 v[116:119], v13 offset:43264
    v_mfma_f32_16x16x32_bf16 v[144:147], v[72:75], a[200:203], v[144:147]
    ds_read_b128 v[120:123], v13 offset:44032
    v_mfma_f32_16x16x32_bf16 v[148:151], v[76:79], a[200:203], v[148:151]
    ds_read_b128 v[124:127], v13 offset:44288
    v_mfma_f32_16x16x32_bf16 v[152:155], v[80:83], a[200:203], v[152:155]
    ds_read_b128 v[128:131], v13 offset:45056
    v_mfma_f32_16x16x32_bf16 v[156:159], v[84:87], a[200:203], v[156:159]
    ds_read_b128 v[132:135], v13 offset:45312
    s_waitcnt lgkmcnt(6)
    v_mfma_f32_16x16x32_bf16 v[136:139], v[88:91], a[208:211], v[136:139]
    ds_read_b128 v[64:67], v13 offset:49152
    v_mfma_f32_16x16x32_bf16 v[140:143], v[92:95], a[208:211], v[140:143]
    ds_read_b128 v[68:71], v13 offset:49408
    v_mfma_f32_16x16x32_bf16 v[144:147], v[96:99], a[208:211], v[144:147]
    s_mov_b32 m0, s81
    ds_read_b128 v[72:75], v13 offset:50176
    buffer_load_dwordx4 v1, s[4:7], s80 offen offset:3072 sc1 lds
    v_mfma_f32_16x16x32_bf16 v[148:151], v[100:103], a[208:211], v[148:151]
    ds_read_b128 v[76:79], v13 offset:50432
    v_mfma_f32_16x16x32_bf16 v[152:155], v[104:107], a[208:211], v[152:155]
    ds_read_b128 v[80:83], v13 offset:51200
    v_mfma_f32_16x16x32_bf16 v[156:159], v[108:111], a[208:211], v[156:159]
    ds_read_b128 v[84:87], v13 offset:51456
    s_waitcnt lgkmcnt(6)
    v_mfma_f32_16x16x32_bf16 v[136:139], v[112:115], a[216:219], v[136:139]
    ds_read_b128 v[88:91], v13 offset:55296
    v_mfma_f32_16x16x32_bf16 v[140:143], v[116:119], a[216:219], v[140:143]
    ds_read_b128 v[92:95], v13 offset:55552
    v_mfma_f32_16x16x32_bf16 v[144:147], v[120:123], a[216:219], v[144:147]
    s_add_u32 s80, s80, 4096
    s_add_u32 s81, s81, 4096
    s_mov_b32 m0, s81
    ds_read_b128 v[96:99], v13 offset:56320
    buffer_load_dwordx4 v1, s[4:7], s80 offen offset:0 sc1 lds
    v_mfma_f32_16x16x32_bf16 v[148:151], v[124:127], a[216:219], v[148:151]
    ds_read_b128 v[100:103], v13 offset:56576
    v_mfma_f32_16x16x32_bf16 v[152:155], v[128:131], a[216:219], v[152:155]
    ds_read_b128 v[104:107], v13 offset:57344
    v_mfma_f32_16x16x32_bf16 v[156:159], v[132:135], a[216:219], v[156:159]
    ds_read_b128 v[108:111], v13 offset:57600
    s_waitcnt lgkmcnt(6)
    v_mfma_f32_16x16x32_bf16 v[136:139], v[64:67], a[224:227], v[136:139]
    ds_read_b128 v[112:115], v13 offset:0
    v_mfma_f32_16x16x32_bf16 v[140:143], v[68:71], a[224:227], v[140:143]
    ds_read_b128 v[116:119], v13 offset:256
    v_mfma_f32_16x16x32_bf16 v[144:147], v[72:75], a[224:227], v[144:147]
    ds_read_b128 v[120:123], v13 offset:1024
    buffer_load_dwordx4 v1, s[4:7], s80 offen offset:1024 sc1 lds
    v_mfma_f32_16x16x32_bf16 v[148:151], v[76:79], a[224:227], v[148:151]
    ds_read_b128 v[124:127], v13 offset:1280
    v_mfma_f32_16x16x32_bf16 v[152:155], v[80:83], a[224:227], v[152:155]
    ds_read_b128 v[128:131], v13 offset:2048
    v_mfma_f32_16x16x32_bf16 v[156:159], v[84:87], a[224:227], v[156:159]
    ds_read_b128 v[132:135], v13 offset:2304
    s_waitcnt lgkmcnt(6)
    v_mfma_f32_16x16x32_bf16 v[136:139], v[88:91], a[232:235], v[136:139]
    ds_read_b128 v[64:67], v13 offset:6144
    v_mfma_f32_16x16x32_bf16 v[140:143], v[92:95], a[232:235], v[140:143]
    ds_read_b128 v[68:71], v13 offset:6400
    v_mfma_f32_16x16x32_bf16 v[144:147], v[96:99], a[232:235], v[144:147]
    ds_read_b128 v[72:75], v13 offset:7168
    buffer_load_dwordx4 v1, s[4:7], s80 offen offset:2048 sc1 lds
    v_mfma_f32_16x16x32_bf16 v[148:151], v[100:103], a[232:235], v[148:151]
    ds_read_b128 v[76:79], v13 offset:7424
    v_mfma_f32_16x16x32_bf16 v[152:155], v[104:107], a[232:235], v[152:155]
    ds_read_b128 v[80:83], v13 offset:8192
    v_mfma_f32_16x16x32_bf16 v[156:159], v[108:111], a[232:235], v[156:159]
    ds_read_b128 v[84:87], v13 offset:8448
    s_waitcnt lgkmcnt(6)
    v_mfma_f32_16x16x32_bf16 v[136:139], v[112:115], a[240:243], v[136:139]
    v_mfma_f32_16x16x32_bf16 v[140:143], v[116:119], a[240:243], v[140:143]
    v_mfma_f32_16x16x32_bf16 v[144:147], v[120:123], a[240:243], v[144:147]
    buffer_load_dwordx4 v1, s[4:7], s80 offen offset:3072 sc1 lds
    v_mfma_f32_16x16x32_bf16 v[148:151], v[124:127], a[240:243], v[148:151]
    v_mfma_f32_16x16x32_bf16 v[152:155], v[128:131], a[240:243], v[152:155]
    v_mfma_f32_16x16x32_bf16 v[156:159], v[132:135], a[240:243], v[156:159]
    s_waitcnt lgkmcnt(0)
    v_mfma_f32_16x16x32_bf16 v[136:139], v[64:67], a[248:251], v[136:139]
    v_mfma_f32_16x16x32_bf16 v[140:143], v[68:71], a[248:251], v[140:143]
    s_add_u32 s80, s80, 4096
    s_add_u32 s81, s81, 4096
    s_mov_b32 m0, s81
    v_mfma_f32_16x16x32_bf16 v[144:147], v[72:75], a[248:251], v[144:147]
    buffer_load_dwordx4 v1, s[4:7], s80 offen offset:0 sc1 lds
    v_mfma_f32_16x16x32_bf16 v[148:151], v[76:79], a[248:251], v[148:151]
    v_mfma_f32_16x16x32_bf16 v[152:155], v[80:83], a[248:251], v[152:155]
    v_mfma_f32_16x16x32_bf16 v[156:159], v[84:87], a[248:251], v[156:159]
    ds_read_b128 v[112:115], v9 offset:864
    ds_read_b128 v[116:119], v9 offset:880
    ds_read_b64 v[120:121], v10 offset:864
    v_pk_add_f32 v[136:137], v[136:137], v[38:39] op_sel_hi:[1,0]
    v_pk_add_f32 v[138:139], v[138:139], v[38:39] op_sel_hi:[1,0]
    v_pk_add_f32 v[140:141], v[140:141], v[38:39] op_sel_hi:[1,0]
    v_pk_add_f32 v[142:143], v[142:143], v[38:39] op_sel_hi:[1,0]
    v_pk_add_f32 v[144:145], v[144:145], v[38:39] op_sel_hi:[1,0]
    v_pk_add_f32 v[146:147], v[146:147], v[38:39] op_sel_hi:[1,0]
    v_pk_add_f32 v[148:149], v[148:149], v[38:39] op_sel_hi:[1,0]
    v_pk_add_f32 v[150:151], v[150:151], v[38:39] op_sel_hi:[1,0]
    v_pk_add_f32 v[152:153], v[152:153], v[38:39] op_sel_hi:[1,0]
    v_pk_add_f32 v[154:155], v[154:155], v[38:39] op_sel_hi:[1,0]
    v_pk_add_f32 v[156:157], v[156:157], v[38:39] op_sel_hi:[1,0]
    v_pk_add_f32 v[158:159], v[158:159], v[38:39] op_sel_hi:[1,0]
    v_mov_b32 v33, s44
    s_waitcnt vmcnt(6)
L_xg_47:
    buffer_load_dwordx4 v[64:67], v1, s[4:7], s89 offen offset:0 sc1
    buffer_load_dwordx4 v[68:71], v1, s[4:7], s89 offen offset:1024 sc1
    buffer_load_dwordx4 v[72:75], v1, s[4:7], s89 offen offset:2048 sc1
    buffer_load_dwordx4 v[76:79], v1, s[4:7], s89 offen offset:3072 sc1
    s_waitcnt vmcnt(0)
    v_xor_b32 v32, v67, v33
    v_bitop3_b32 v32, v32, v71, v33 bitop3:0xf6
    v_bitop3_b32 v32, v32, v75, v33 bitop3:0xf6
    v_bitop3_b32 v32, v32, v79, v33 bitop3:0xf6
    v_cmp_ne_u32 vcc, 0, v32
    s_nop 0
    s_cmp_eq_u64 vcc, 0
    s_cbranch_scc1 L_xgd_48
    s_sleep 2
    s_sub_u32 s100, s100, 1
    s_cbranch_scc0 L_xg_47
    s_mov_b32 s100, 0
L_xgd_48:
    buffer_load_dwordx4 v1, s[4:7], s80 offen offset:1024 sc1 lds
    buffer_load_dwordx4 v1, s[4:7], s80 offen offset:2048 sc1 lds
    buffer_load_dwordx4 v1, s[4:7], s80 offen offset:3072 sc1 lds
    v_dot2c_f32_bf16 v136, v64, v34
    v_dot2c_f32_bf16 v137, v64, v35
    v_dot2c_f32_bf16 v138, v65, v34
    v_dot2c_f32_bf16 v139, v65, v35
    v_dot2c_f32_bf16 v140, v66, v34
    v_dot2c_f32_bf16 v141, v66, v35
    v_dot2c_f32_bf16 v142, v68, v34
    v_dot2c_f32_bf16 v143, v68, v35
    v_dot2c_f32_bf16 v144, v69, v34
    v_dot2c_f32_bf16 v145, v69, v35
    v_dot2c_f32_bf16 v146, v70, v34
    v_dot2c_f32_bf16 v147, v70, v35
    v_dot2c_f32_bf16 v148, v72, v34
    v_dot2c_f32_bf16 v149, v72, v35
    v_dot2c_f32_bf16 v150, v73, v34
    v_dot2c_f32_bf16 v151, v73, v35
    v_dot2c_f32_bf16 v152, v74, v34
    v_dot2c_f32_bf16 v153, v74, v35
    v_dot2c_f32_bf16 v154, v76, v34
    v_dot2c_f32_bf16 v155, v76, v35
    v_dot2c_f32_bf16 v156, v77, v34
    v_dot2c_f32_bf16 v157, v77, v35
    v_dot2c_f32_bf16 v158, v78, v34
    v_dot2c_f32_bf16 v159, v78, v35
    v_pk_mul_f32 v[136:137], v[136:137], v[40:41]
    v_pk_mul_f32 v[138:139], v[138:139], v[42:43]
    v_pk_mul_f32 v[140:141], v[140:141], v[44:45]
    v_pk_mul_f32 v[142:143], v[142:143], v[46:47]
    v_pk_mul_f32 v[144:145], v[144:145], v[48:49]
    v_pk_mul_f32 v[146:147], v[146:147], v[50:51]
    v_pk_mul_f32 v[148:149], v[148:149], v[52:53]
    v_pk_mul_f32 v[150:151], v[150:151], v[54:55]
    v_pk_mul_f32 v[152:153], v[152:153], v[56:57]
    v_pk_mul_f32 v[154:155], v[154:155], v[58:59]
    v_pk_mul_f32 v[156:157], v[156:157], v[60:61]
    v_pk_mul_f32 v[158:159], v[158:159], v[62:63]
    v_cvt_pk_bf16_f32 v100, v136, v137
    v_cvt_pk_bf16_f32 v101, v138, v139
    v_cvt_pk_bf16_f32 v102, v140, v141
    v_cvt_pk_bf16_f32 v103, v142, v143
    v_cvt_pk_bf16_f32 v104, v144, v145
    v_cvt_pk_bf16_f32 v105, v146, v147
    v_cvt_pk_bf16_f32 v106, v148, v149
    v_cvt_pk_bf16_f32 v107, v150, v151
    v_cvt_pk_bf16_f32 v108, v152, v153
    v_cvt_pk_bf16_f32 v109, v154, v155
    v_cvt_pk_bf16_f32 v110, v156, v157
    v_cvt_pk_bf16_f32 v111, v158, v159
    s_cmp_eq_u32 s54, 0
    s_cbranch_scc1 L_glob_49
    buffer_store_dwordx4 v[100:103], v12, s[4:7], s58 offen offset:0
    buffer_store_dwordx4 v[104:107], v12, s[4:7], s58 offen offset:256
    buffer_store_dwordx4 v[108:111], v12, s[4:7], s58 offen offset:512
L_back_50:
    s_waitcnt lgkmcnt(0)
    v_lshlrev_b32 v16, 16, v112
    v_and_b32 v17, 0xffff0000, v112
    v_lshlrev_b32 v18, 16, v113
    v_and_b32 v19, 0xffff0000, v113
    v_lshlrev_b32 v20, 16, v114
    v_and_b32 v21, 0xffff0000, v114
    v_lshlrev_b32 v22, 16, v115
    v_and_b32 v23, 0xffff0000, v115
    v_lshlrev_b32 v24, 16, v116
    v_and_b32 v25, 0xffff0000, v116
    v_lshlrev_b32 v26, 16, v117
    v_and_b32 v27, 0xffff0000, v117
    v_lshlrev_b32 v28, 16, v118
    v_and_b32 v29, 0xffff0000, v118
    v_lshlrev_b32 v30, 16, v119
    v_and_b32 v31, 0xffff0000, v119
    v_lshlrev_b32 v32, 16, v120
    v_and_b32 v33, 0xffff0000, v120
    v_lshlrev_b32 v34, 16, v121
    v_and_b32 v35, 0xffff0000, v121
    s_waitcnt vmcnt(0)
    v_mov_b32 v60, s44
    v_mov_b32 v61, 0
    s_mov_b64 exec, 1
    s_cmp_eq_u32 s54, 0
    s_cbranch_scc1 L_glob_51
    buffer_store_dword v60, v61, s[4:7], s91 offen
L_back_52:
    s_mov_b64 exec, -1
    s_barrier
    s_add_u32 s80, s80, 4096
    s_add_u32 s81, s81, 4096
    s_mov_b32 m0, s81
    s_nop 0
    buffer_load_dwordx4 v1, s[4:7], s80 offen offset:0 sc1 lds
    buffer_load_dwordx4 v1, s[4:7], s80 offen offset:1024 sc1 lds
    s_mul_i32 s81, s47, 4096
    s_add_u32 s80, s81, s24
    s_add_u32 s80, s80, 90112
    s_add_u32 s81, s81, 0
    s_mov_b32 m0, s81
    s_nop 0
    buffer_load_dwordx4 v1, s[4:7], s80 offen offset:0 sc1 lds
    buffer_load_dwordx4 v1, s[4:7], s80 offen offset:1024 sc1 lds
    buffer_load_dwordx4 v1, s[4:7], s80 offen offset:2048 sc1 lds
    buffer_load_dwordx4 v1, s[4:7], s80 offen offset:3072 sc1 lds
    s_mov_b32 s8, s38
    s_mov_b32 s9, s39
    s_mov_b32 s10, 2621440
    s_mov_b32 s11, s96
L_vp_53:
    buffer_load_dword v63, v4, s[4:7], s61 offen sc1
    s_waitcnt vmcnt(0)
    v_cmp_ne_u32 vcc, s44, v63
    s_nop 0
    s_cmp_eq_u64 vcc, 0
    s_cbranch_scc1 L_vpd_54
    s_sub_u32 s100, s100, 1
    s_cbranch_scc0 L_vp_53
    s_mov_b32 s100, 0
L_vpd_54:
    buffer_load_dwordx4 v[64:67], v1, s[4:7], s59 offen offset:0 sc1
    buffer_load_dwordx4 v[68:71], v1, s[4:7], s59 offen offset:1024 sc1
    buffer_load_dwordx4 v[72:75], v1, s[4:7], s59 offen offset:2048 sc1
    buffer_load_dwordx4 v[76:79], v1, s[4:7], s59 offen offset:3072 sc1
    s_add_u32 s59, s59, 4096
    buffer_load_dwordx4 v[80:83], v1, s[4:7], s59 offen offset:0 sc1
    buffer_load_dwordx4 v[84:87], v1, s[4:7], s59 offen offset:1024 sc1
    buffer_load_dwordx4 v[88:91], v1, s[4:7], s59 offen offset:2048 sc1
    buffer_load_dwordx4 v[92:95], v1, s[4:7], s59 offen offset:3072 sc1
    s_add_u32 s59, s59, 4096
    s_waitcnt lgkmcnt(0)
    s_barrier
    ds_read_b128 v[160:163], v1 offset:61440
    ds_read_b128 v[164:167], v1 offset:62464
    ds_read_b128 v[168:171], v1 offset:63488
    ds_read_b128 v[172:175], v1 offset:64512
    ds_read_b128 v[176:179], v5 offset:0
    ds_read_b128 v[180:183], v5 offset:1024
    ds_read_b128 v[184:187], v5 offset:2048
    ds_read_b128 v[188:191], v5 offset:3072
    ds_read_b128 v[192:195], v5 offset:4096
    ds_read_b128 v[196:199], v5 offset:5120
    s_waitcnt vmcnt(7) lgkmcnt(5)
    v_mfma_f32_16x16x32_bf16 v[36:39], v[160:163], v[64:67], 0
    ds_read_b128 v[200:203], v5 offset:6144
    buffer_load_dwordx4 v[96:99], v1, s[4:7], s59 offen offset:0 sc1
    v_mfma_f32_16x16x32_bf16 v[40:43], v[164:167], v[64:67], 0
    ds_read_b128 v[204:207], v5 offset:7168
    v_mfma_f32_16x16x32_bf16 v[44:47], v[168:171], v[64:67], 0
    ds_read_b128 v[208:211], v5 offset:8192
    v_mfma_f32_16x16x32_bf16 v[48:51], v[172:175], v[64:67], 0
    ds_read_b128 v[212:215], v5 offset:9216
    buffer_load_dwordx4 v[100:103], v1, s[4:7], s59 offen offset:1024 sc1
    v_mfma_f32_16x16x32_bf16 v[52:55], v[176:179], v[64:67], 0
    ds_read_b128 v[216:219], v5 offset:10240
    s_waitcnt vmcnt(8) lgkmcnt(5)
    v_mfma_f32_16x16x32_bf16 v[36:39], v[180:183], v[68:71], v[36:39]
    ds_read_b128 v[160:163], v5 offset:11264
    buffer_load_dwordx4 v[104:107], v1, s[4:7], s59 offen offset:2048 sc1
    v_mfma_f32_16x16x32_bf16 v[40:43], v[184:187], v[68:71], v[40:43]
    ds_read_b128 v[164:167], v5 offset:12288
    v_mfma_f32_16x16x32_bf16 v[44:47], v[188:191], v[68:71], v[44:47]
    ds_read_b128 v[168:171], v5 offset:13312
    v_mfma_f32_16x16x32_bf16 v[48:51], v[192:195], v[68:71], v[48:51]
    ds_read_b128 v[172:175], v5 offset:14336
    v_mfma_f32_16x16x32_bf16 v[52:55], v[196:199], v[68:71], v[52:55]
    ds_read_b128 v[176:179], v5 offset:15360
    s_waitcnt vmcnt(8) lgkmcnt(5)
    v_mfma_f32_16x16x32_bf16 v[36:39], v[200:203], v[72:75], v[36:39]
    ds_read_b128 v[180:183], v5 offset:16384
    buffer_load_dwordx4 v[108:111], v1, s[4:7], s59 offen offset:3072 sc1
    s_add_u32 s59, s59, 4096
    v_mfma_f32_16x16x32_bf16 v[40:43], v[204:207], v[72:75], v[40:43]
    ds_read_b128 v[184:187], v5 offset:17408
    v_mfma_f32_16x16x32_bf16 v[44:47], v[208:211], v[72:75], v[44:47]
    ds_read_b128 v[188:191], v5 offset:18432
    v_mfma_f32_16x16x32_bf16 v[48:51], v[212:215], v[72:75], v[48:51]
    ds_read_b128 v[192:195], v5 offset:19456
    buffer_load_dwordx4 v[112:115], v1, s[4:7], s59 offen offset:0 sc1
    v_mfma_f32_16x16x32_bf16 v[52:55], v[216:219], v[72:75], v[52:55]
    ds_read_b128 v[196:199], v5 offset:20480
    s_waitcnt vmcnt(9) lgkmcnt(5)
    v_mfma_f32_16x16x32_bf16 v[36:39], v[160:163], v[76:79], v[36:39]
    ds_read_b128 v[200:203], v5 offset:21504
    buffer_load_dwordx4 v[116:119], v1, s[4:7], s59 offen offset:1024 sc1
    v_mfma_f32_16x16x32_bf16 v[40:43], v[164:167], v[76:79], v[40:43]
    ds_read_b128 v[204:207], v5 offset:22528
    v_mfma_f32_16x16x32_bf16 v[44:47], v[168:171], v[76:79], v[44:47]
    ds_read_b128 v[208:211], v5 offset:23552
    v_mfma_f32_16x16x32_bf16 v[48:51], v[172:175], v[76:79], v[48:51]
    ds_read_b128 v[212:215], v5 offset:24576
    v_mfma_f32_16x16x32_bf16 v[52:55], v[176:179], v[76:79], v[52:55]
    ds_read_b128 v[216:219], v5 offset:25600
    s_waitcnt vmcnt(9) lgkmcnt(5)
    v_mfma_f32_16x16x32_bf16 v[36:39], v[180:183], v[80:83], v[36:39]
    ds_read_b128 v[160:163], v5 offset:26624
    buffer_load_dwordx4 v[120:123], v1, s[4:7], s59 offen offset:2048 sc1
    v_mfma_f32_16x16x32_bf16 v[40:43], v[184:187], v[80:83], v[40:43]
    ds_read_b128 v[164:167], v5 offset:27648
    v_mfma_f32_16x16x32_bf16 v[44:47], v[188:191], v[80:83], v[44:47]
    ds_read_b128 v[168:171], v5 offset:28672
    v_mfma_f32_16x16x32_bf16 v[48:51], v[192:195], v[80:83], v[48:51]
    ds_read_b128 v[172:175], v5 offset:29696
    buffer_load_dwordx4 v[124:127], v1, s[4:7], s59 offen offset:3072 sc1
    s_add_u32 s59, s59, 4096
    v_mfma_f32_16x16x32_bf16 v[52:55], v[196:199], v[80:83], v[52:55]
    ds_read_b128 v[176:179], v5 offset:30720
    s_waitcnt vmcnt(10) lgkmcnt(5)
    v_mfma_f32_16x16x32_bf16 v[36:39], v[200:203], v[84:87], v[36:39]
    ds_read_b128 v[180:183], v5 offset:31744
    buffer_load_dwordx4 v[128:131], v1, s[4:7], s59 offen offset:0 sc1
    v_mfma_f32_16x16x32_bf16 v[40:43], v[204:207], v[84:87], v[40:43]
    ds_read_b128 v[184:187], v5 offset:32768
    v_mfma_f32_16x16x32_bf16 v[44:47], v[208:211], v[84:87], v[44:47]
    ds_read_b128 v[188:191], v5 offset:33792
    v_mfma_f32_16x16x32_bf16 v[48:51], v[212:215], v[84:87], v[48:51]
    ds_read_b128 v[192:195], v5 offset:34816
    v_mfma_f32_16x16x32_bf16 v[52:55], v[216:219], v[84:87], v[52:55]
    ds_read_b128 v[196:199], v5 offset:35840
    s_waitcnt vmcnt(10) lgkmcnt(5)
    v_mfma_f32_16x16x32_bf16 v[36:39], v[160:163], v[88:91], v[36:39]
    ds_read_b128 v[200:203], v5 offset:36864
    buffer_load_dwordx4 v[132:135], v1, s[4:7], s59 offen offset:1024 sc1
    v_mfma_f32_16x16x32_bf16 v[40:43], v[164:167], v[88:91], v[40:43]
    ds_read_b128 v[204:207], v5 offset:37888
    v_mfma_f32_16x16x32_bf16 v[44:47], v[168:171], v[88:91], v[44:47]
    ds_read_b128 v[208:211], v5 offset:38912
    v_mfma_f32_16x16x32_bf16 v[48:51], v[172:175], v[88:91], v[48:51]
    ds_read_b128 v[212:215], v5 offset:39936
    buffer_load_dwordx4 v[136:139], v1, s[4:7], s59 offen offset:2048 sc1
    v_mfma_f32_16x16x32_bf16 v[52:55], v[176:179], v[88:91], v[52:55]
    ds_read_b128 v[216:219], v5 offset:40960
    s_waitcnt vmcnt(11) lgkmcnt(5)
    v_mfma_f32_16x16x32_bf16 v[36:39], v[180:183], v[92:95], v[36:39]
    ds_read_b128 v[160:163], v5 offset:41984
    buffer_load_dwordx4 v[140:143], v1, s[4:7], s59 offen offset:3072 sc1
    s_add_u32 s59, s59, 4096
    v_mfma_f32_16x16x32_bf16 v[40:43], v[184:187], v[92:95], v[40:43]
    ds_read_b128 v[164:167], v5 offset:43008
    v_mfma_f32_16x16x32_bf16 v[44:47], v[188:191], v[92:95], v[44:47]
    ds_read_b128 v[168:171], v5 offset:44032
    v_mfma_f32_16x16x32_bf16 v[48:51], v[192:195], v[92:95], v[48:51]
    ds_read_b128 v[172:175], v5 offset:45056
    v_mfma_f32_16x16x32_bf16 v[52:55], v[196:199], v[92:95], v[52:55]
    ds_read_b128 v[176:179], v5 offset:46080
    s_waitcnt vmcnt(11) lgkmcnt(5)
    v_mfma_f32_16x16x32_bf16 v[36:39], v[200:203], v[96:99], v[36:39]
    ds_read_b128 v[180:183], v5 offset:47104
    buffer_load_dwordx4 v[144:147], v1, s[4:7], s59 offen offset:0 sc1
    v_mfma_f32_16x16x32_bf16 v[40:43], v[204:207], v[96:99], v[40:43]
    ds_read_b128 v[184:187], v5 offset:48128
    v_mfma_f32_16x16x32_bf16 v[44:47], v[208:211], v[96:99], v[44:47]
    ds_read_b128 v[188:191], v5 offset:49152
    v_mfma_f32_16x16x32_bf16 v[48:51], v[212:215], v[96:99], v[48:51]
    ds_read_b128 v[192:195], v5 offset:50176
    buffer_load_dwordx4 v[148:151], v1, s[4:7], s59 offen offset:1024 sc1
    v_mfma_f32_16x16x32_bf16 v[52:55], v[216:219], v[96:99], v[52:55]
    ds_read_b128 v[196:199], v5 offset:51200
    s_waitcnt vmcnt(12) lgkmcnt(5)
    v_mfma_f32_16x16x32_bf16 v[36:39], v[160:163], v[100:103], v[36:39]
    ds_read_b128 v[200:203], v5 offset:52224
    buffer_load_dwordx4 v[152:155], v1, s[4:7], s59 offen offset:2048 sc1
    v_mfma_f32_16x16x32_bf16 v[40:43], v[164:167], v[100:103], v[40:43]
    ds_read_b128 v[204:207], v5 offset:53248
    v_mfma_f32_16x16x32_bf16 v[44:47], v[168:171], v[100:103], v[44:47]
    ds_read_b128 v[208:211], v5 offset:54272
    v_mfma_f32_16x16x32_bf16 v[48:51], v[172:175], v[100:103], v[48:51]
    ds_read_b128 v[212:215], v5 offset:55296
    v_mfma_f32_16x16x32_bf16 v[52:55], v[176:179], v[100:103], v[52:55]
    ds_read_b128 v[216:219], v5 offset:56320
    s_waitcnt vmcnt(12) lgkmcnt(5)
    v_mfma_f32_16x16x32_bf16 v[36:39], v[180:183], v[104:107], v[36:39]
    ds_read_b128 v[160:163], v5 offset:57344
    buffer_load_dwordx4 v[156:159], v1, s[4:7], s59 offen offset:3072 sc1
    v_mfma_f32_16x16x32_bf16 v[40:43], v[184:187], v[104:107], v[40:43]
    ds_read_b128 v[164:167], v5 offset:58368
    v_mfma_f32_16x16x32_bf16 v[44:47], v[188:191], v[104:107], v[44:47]
    ds_read_b128 v[168:171], v5 offset:59392
    v_mfma_f32_16x16x32_bf16 v[48:51], v[192:195], v[104:107], v[48:51]
    s_mul_i32 s81, s47, 4096
    s_add_u32 s80, s81, s24
    s_add_u32 s80, s80, 106496
    s_add_u32 s81, s81, 16384
    s_mov_b32 m0, s81
    ds_read_b128 v[172:175], v5 offset:60416
    buffer_load_dwordx4 v1, s[4:7], s80 offen offset:0 sc1 lds
    v_mfma_f32_16x16x32_bf16 v[52:55], v[196:199], v[104:107], v[52:55]
    ds_read_b128 v[176:179], v5 offset:61440
    s_waitcnt vmcnt(13) lgkmcnt(5)
    v_mfma_f32_16x16x32_bf16 v[36:39], v[200:203], v[108:111], v[36:39]
    ds_read_b128 v[180:183], v5 offset:62464
    buffer_load_dwordx4 v1, s[4:7], s80 offen offset:1024 sc1 lds
    v_mfma_f32_16x16x32_bf16 v[40:43], v[204:207], v[108:111], v[40:43]
    ds_read_b128 v[184:187], v5 offset:63488
    v_mfma_f32_16x16x32_bf16 v[44:47], v[208:211], v[108:111], v[44:47]
    ds_read_b128 v[188:191], v5 offset:64512
    v_mfma_f32_16x16x32_bf16 v[48:51], v[212:215], v[108:111], v[48:51]
    ds_read_b128 v[192:195], v6 offset:0
    buffer_load_dwordx4 v1, s[4:7], s80 offen offset:2048 sc1 lds
    v_mfma_f32_16x16x32_bf16 v[52:55], v[216:219], v[108:111], v[52:55]
    ds_read_b128 v[196:199], v6 offset:1024
    s_waitcnt vmcnt(14) lgkmcnt(5)
    v_mfma_f32_16x16x32_bf16 v[36:39], v[160:163], v[112:115], v[36:39]
    ds_read_b128 v[200:203], v6 offset:2048
    buffer_load_dwordx4 v1, s[4:7], s80 offen offset:3072 sc1 lds
    v_mfma_f32_16x16x32_bf16 v[40:43], v[164:167], v[112:115], v[40:43]
    ds_read_b128 v[204:207], v6 offset:3072
    v_mfma_f32_16x16x32_bf16 v[44:47], v[168:171], v[112:115], v[44:47]
    ds_read_b128 v[208:211], v6 offset:4096
    v_mfma_f32_16x16x32_bf16 v[48:51], v[172:175], v[112:115], v[48:51]
    ds_read_b128 v[212:215], v6 offset:5120
    v_mfma_f32_16x16x32_bf16 v[52:55], v[176:179], v[112:115], v[52:55]
    ds_read_b128 v[216:219], v6 offset:6144
    s_waitcnt vmcnt(14) lgkmcnt(5)
    v_mfma_f32_16x16x32_bf16 v[36:39], v[180:183], v[116:119], v[36:39]
    ds_read_b128 v[160:163], v6 offset:7168
    v_mfma_f32_16x16x32_bf16 v[40:43], v[184:187], v[116:119], v[40:43]
    ds_read_b128 v[164:167], v6 offset:8192
    v_mfma_f32_16x16x32_bf16 v[44:47], v[188:191], v[116:119], v[44:47]
    ds_read_b128 v[168:171], v6 offset:9216
    v_mfma_f32_16x16x32_bf16 v[48:51], v[192:195], v[116:119], v[48:51]
    ds_read_b128 v[172:175], v6 offset:10240
    v_mfma_f32_16x16x32_bf16 v[52:55], v[196:199], v[116:119], v[52:55]
    ds_read_b128 v[176:179], v6 offset:11264
    s_waitcnt vmcnt(13) lgkmcnt(5)
    v_mfma_f32_16x16x32_bf16 v[36:39], v[200:203], v[120:123], v[36:39]
    ds_read_b128 v[180:183], v6 offset:12288
    v_mfma_f32_16x16x32_bf16 v[40:43], v[204:207], v[120:123], v[40:43]
    ds_read_b128 v[184:187], v6 offset:13312
    v_mfma_f32_16x16x32_bf16 v[44:47], v[208:211], v[120:123], v[44:47]
    ds_read_b128 v[188:191], v6 offset:14336
    v_mfma_f32_16x16x32_bf16 v[48:51], v[212:215], v[120:123], v[48:51]
    ds_read_b128 v[192:195], v6 offset:15360
    v_mfma_f32_16x16x32_bf16 v[52:55], v[216:219], v[120:123], v[52:55]
    ds_read_b128 v[196:199], v6 offset:16384
    s_waitcnt vmcnt(12) lgkmcnt(5)
    v_mfma_f32_16x16x32_bf16 v[36:39], v[160:163], v[124:127], v[36:39]
    ds_read_b128 v[200:203], v6 offset:17408
    v_mfma_f32_16x16x32_bf16 v[40:43], v[164:167], v[124:127], v[40:43]
    ds_read_b128 v[204:207], v6 offset:18432
    v_mfma_f32_16x16x32_bf16 v[44:47], v[168:171], v[124:127], v[44:47]
    ds_read_b128 v[208:211], v6 offset:19456
    v_mfma_f32_16x16x32_bf16 v[48:51], v[172:175], v[124:127], v[48:51]
    ds_read_b128 v[212:215], v1 offset:0
    v_mfma_f32_16x16x32_bf16 v[52:55], v[176:179], v[124:127], v[52:55]
    ds_read_b128 v[216:219], v1 offset:1024
    s_waitcnt vmcnt(11) lgkmcnt(5)
    v_mfma_f32_16x16x32_bf16 v[36:39], v[180:183], v[128:131], v[36:39]
    ds_read_b128 v[160:163], v1 offset:2048
    v_mfma_f32_16x16x32_bf16 v[40:43], v[184:187], v[128:131], v[40:43]
    ds_read_b128 v[164:167], v1 offset:3072
    v_mfma_f32_16x16x32_bf16 v[44:47], v[188:191], v[128:131], v[44:47]
    ds_read_b128 v[168:171], v1 offset:4096
    v_mfma_f32_16x16x32_bf16 v[48:51], v[192:195], v[128:131], v[48:51]
    ds_read_b128 v[172:175], v1 offset:5120
    v_mfma_f32_16x16x32_bf16 v[52:55], v[196:199], v[128:131], v[52:55]
    ds_read_b128 v[176:179], v1 offset:6144
    s_waitcnt vmcnt(10) lgkmcnt(5)
    v_mfma_f32_16x16x32_bf16 v[36:39], v[200:203], v[132:135], v[36:39]
    ds_read_b128 v[180:183], v1 offset:7168
    v_mfma_f32_16x16x32_bf16 v[40:43], v[204:207], v[132:135], v[40:43]
    ds_read_b128 v[184:187], v1 offset:8192
    v_mfma_f32_16x16x32_bf16 v[44:47], v[208:211], v[132:135], v[44:47]
    ds_read_b128 v[188:191], v1 offset:9216
    v_mfma_f32_16x16x32_bf16 v[48:51], v[212:215], v[132:135], v[48:51]
    ds_read_b128 v[192:195], v1 offset:10240
    v_mfma_f32_16x16x32_bf16 v[52:55], v[216:219], v[132:135], v[52:55]
    ds_read_b128 v[196:199], v1 offset:11264
    s_waitcnt vmcnt(0)
    s_barrier
    s_waitcnt lgkmcnt(5)
    v_mfma_f32_16x16x32_bf16 v[36:39], v[160:163], v[136:139], v[36:39]
    ds_read_b128 v[200:203], v1 offset:12288
    v_mfma_f32_16x16x32_bf16 v[40:43], v[164:167], v[136:139], v[40:43]
    ds_read_b128 v[204:207], v1 offset:13312
    v_mfma_f32_16x16x32_bf16 v[44:47], v[168:171], v[136:139], v[44:47]
    ds_read_b128 v[208:211], v1 offset:14336
    v_mfma_f32_16x16x32_bf16 v[48:51], v[172:175], v[136:139], v[48:51]
    ds_read_b128 v[212:215], v1 offset:15360
    v_mfma_f32_16x16x32_bf16 v[52:55], v[176:179], v[136:139], v[52:55]
    ds_read_b128 v[216:219], v1 offset:16384
    s_waitcnt lgkmcnt(5)
    v_mfma_f32_16x16x32_bf16 v[36:39], v[180:183], v[140:143], v[36:39]
    ds_read_b128 v[160:163], v1 offset:17408
    v_mfma_f32_16x16x32_bf16 v[40:43], v[184:187], v[140:143], v[40:43]
    ds_read_b128 v[164:167], v1 offset:18432
    v_mfma_f32_16x16x32_bf16 v[44:47], v[188:191], v[140:143], v[44:47]
    ds_read_b128 v[168:171], v1 offset:19456
    v_mfma_f32_16x16x32_bf16 v[48:51], v[192:195], v[140:143], v[48:51]
    ds_read_b128 v[172:175], v1 offset:20480
    v_mfma_f32_16x16x32_bf16 v[52:55], v[196:199], v[140:143], v[52:55]
    ds_read_b128 v[176:179], v1 offset:21504
    s_waitcnt lgkmcnt(5)
    v_mfma_f32_16x16x32_bf16 v[36:39], v[200:203], v[144:147], v[36:39]
    ds_read_b128 v[180:183], v1 offset:22528
    v_mfma_f32_16x16x32_bf16 v[40:43], v[204:207], v[144:147], v[40:43]
    ds_read_b128 v[184:187], v1 offset:23552
    v_mfma_f32_16x16x32_bf16 v[44:47], v[208:211], v[144:147], v[44:47]
    ds_read_b128 v[188:191], v1 offset:24576
    v_mfma_f32_16x16x32_bf16 v[48:51], v[212:215], v[144:147], v[48:51]
    ds_read_b128 v[192:195], v1 offset:25600
    v_mfma_f32_16x16x32_bf16 v[52:55], v[216:219], v[144:147], v[52:55]
    ds_read_b128 v[196:199], v1 offset:26624
    s_waitcnt lgkmcnt(5)
    v_mfma_f32_16x16x32_bf16 v[36:39], v[160:163], v[148:151], v[36:39]
    ds_read_b128 v[200:203], v1 offset:27648
    v_mfma_f32_16x16x32_bf16 v[40:43], v[164:167], v[148:151], v[40:43]
    ds_read_b128 v[204:207], v1 offset:28672
    v_mfma_f32_16x16x32_bf16 v[44:47], v[168:171], v[148:151], v[44:47]
    ds_read_b128 v[208:211], v1 offset:29696
    v_mfma_f32_16x16x32_bf16 v[48:51], v[172:175], v[148:151], v[48:51]
    ds_read_b128 v[212:215], v1 offset:30720
    v_mfma_f32_16x16x32_bf16 v[52:55], v[176:179], v[148:151], v[52:55]
    ds_read_b128 v[216:219], v1 offset:31744
    s_waitcnt lgkmcnt(5)
    v_mfma_f32_16x16x32_bf16 v[36:39], v[180:183], v[152:155], v[36:39]
    v_mfma_f32_16x16x32_bf16 v[40:43], v[184:187], v[152:155], v[40:43]
    v_mfma_f32_16x16x32_bf16 v[44:47], v[188:191], v[152:155], v[44:47]
    v_mfma_f32_16x16x32_bf16 v[48:51], v[192:195], v[152:155], v[48:51]
    v_mfma_f32_16x16x32_bf16 v[52:55], v[196:199], v[152:155], v[52:55]
    s_waitcnt lgkmcnt(0)
    v_mfma_f32_16x16x32_bf16 v[36:39], v[200:203], v[156:159], v[36:39]
    v_mfma_f32_16x16x32_bf16 v[40:43], v[204:207], v[156:159], v[40:43]
    v_mfma_f32_16x16x32_bf16 v[44:47], v[208:211], v[156:159], v[44:47]
    v_mfma_f32_16x16x32_bf16 v[48:51], v[212:215], v[156:159], v[48:51]
    v_mfma_f32_16x16x32_bf16 v[52:55], v[216:219], v[156:159], v[52:55]
    s_nop 3
    v_pk_fma_f32 v[232:233], v[16:17], v[36:37], v[232:233]
    v_pk_fma_f32 v[234:235], v[18:19], v[38:39], v[234:235]
    v_pk_fma_f32 v[236:237], v[20:21], v[40:41], v[236:237]
    v_pk_fma_f32 v[238:239], v[22:23], v[42:43], v[238:239]
    v_pk_fma_f32 v[240:241], v[24:25], v[44:45], v[240:241]
    v_pk_fma_f32 v[242:243], v[26:27], v[46:47], v[242:243]
    v_pk_fma_f32 v[244:245], v[28:29], v[48:49], v[244:245]
    v_pk_fma_f32 v[246:247], v[30:31], v[50:51], v[246:247]
    v_pk_fma_f32 v[248:249], v[32:33], v[52:53], v[248:249]
    v_pk_fma_f32 v[250:251], v[34:35], v[54:55], v[250:251]
    v_cvt_pk_bf16_f32 v64, v232, v233
    v_cvt_pk_bf16_f32 v65, v234, v235
    v_cvt_pk_bf16_f32 v66, v236, v237
    v_cvt_pk_bf16_f32 v67, v238, v239
    v_cvt_pk_bf16_f32 v68, v240, v241
    v_cvt_pk_bf16_f32 v69, v242, v243
    v_cvt_pk_bf16_f32 v70, v244, v245
    v_cvt_pk_bf16_f32 v71, v246, v247
    v_cvt_pk_bf16_f32 v72, v248, v249
    v_cvt_pk_bf16_f32 v73, v250, v251
    buffer_store_dwordx4 v[64:67], v7, s[8:11], s97 offen
    buffer_store_dwordx4 v[68:71], v7, s[8:11], s97 offen offset:16
    buffer_store_dwordx2 v[72:73], v8, s[8:11], s97 offen
L_fin:
    s_or_b32 s55, s46, s47
    s_cmp_eq_u32 s55, 0
    s_cselect_b32 s55, 0, 1073741824
    v_mov_b32 v60, s44
    v_mov_b32 v61, 0
    s_mov_b64 exec, 1
    buffer_store_dword v60, v61, s[4:7], s55 offen sc1
    s_mov_b64 exec, -1
    s_endpgm
L_glob_3:
    buffer_store_dwordx4 v[128:131], v12, s[4:7], s82 offen sc1
    buffer_store_dwordx4 v[132:135], v12, s[4:7], s83 offen sc1
    buffer_store_dwordx4 v[136:139], v12, s[4:7], s84 offen sc1
    s_branch L_back_4
L_glob_5:
    buffer_store_dword v46, v47, s[4:7], s59 offen sc1
    s_branch L_back_6
L_glob_17:
    buffer_store_dwordx4 v[152:155], v29, s[4:7], s89 offen sc1
    buffer_store_dwordx4 v[156:159], v29, s[4:7], s89 offen offset:256 sc1
    buffer_store_dwordx2 v[160:161], v30, s[4:7], s89 offen offset:1024 sc1
    s_branch L_back_18
L_glob_19:
    buffer_store_dword v50, v51, s[4:7], s59 offen sc1
    s_branch L_back_20
L_glob_29:
    buffer_store_dwordx4 v[36:39], v45, s[4:7], s88 offen sc1
    s_branch L_back_30
L_glob_33:
    buffer_store_dwordx4 v[64:67], v43, s[4:7], s87 offen sc1
    buffer_store_dwordx4 v[68:71], v43, s[4:7], s87 offen offset:256 sc1
    buffer_store_dwordx2 v[72:73], v44, s[4:7], s87 offen offset:2048 sc1
    s_branch L_back_34
L_glob_35:
    buffer_store_dword v60, v61, s[4:7], s55 offen sc1
    s_branch L_back_36
L_glob_39:
    buffer_store_dwordx4 v[48:51], v13, s[4:7], s84 offen sc1
    s_branch L_back_40
L_glob_49:
    buffer_store_dwordx4 v[100:103], v12, s[4:7], s58 offen offset:0 sc1
    buffer_store_dwordx4 v[104:107], v12, s[4:7], s58 offen offset:256 sc1
    buffer_store_dwordx4 v[108:111], v12, s[4:7], s58 offen offset:512 sc1
    s_branch L_back_50
L_glob_51:
    buffer_store_dword v60, v61, s[4:7], s91 offen sc1
    s_branch L_back_52
L_end:
    s_endpgm
.section .rodata,"a"
.p2align 6
.amdhsa_kernel adaLN_cond__linear_kernel_hedgehog__mixer_gmlp__prompt_kernel
  .amdhsa_next_free_vgpr 512
  .amdhsa_next_free_sgpr 102
  .amdhsa_accum_offset 256
  .amdhsa_group_segment_fixed_size 0
  .amdhsa_kernarg_size 112
  .amdhsa_user_sgpr_count 2
  .amdhsa_user_sgpr_kernarg_segment_ptr 1
  .amdhsa_system_sgpr_workgroup_id_x 1
  .amdhsa_float_denorm_mode_32 3
.end_amdhsa_kernel
```
